```python
import torch

def _softmax(x, axis=-1):
    return torch.softmax(x, dim=axis)

def _gelu(x):
    return torch.nn.functional.gelu(x, approximate='tanh')

def _silu(x):
    return torch.nn.functional.silu(x)

def _sigmoid(x):
    return torch.sigmoid(x)

def _layernorm(x, axis=-1, eps=1e-05):
    m = x.mean(dim=axis, keepdim=True)
    v = x.var(dim=axis, keepdim=True, unbiased=False)
    return (x - m) / torch.sqrt(v + eps)

def _scatter_add(tgt, idx, src, axis=0):
    return tgt.clone().index_add_(axis, idx, src)

def _segment_sum(src, seg, n):
    out = torch.zeros((n,) + src.shape[1:], dtype=src.dtype)
    return out.index_add_(0, seg, src)

def _pad(x, pw):
    flat = tuple((v for pair in reversed(pw) for v in pair))
    return torch.nn.functional.pad(x, flat)
kernel_name = 'recurrent_scan__mha_block__mixer_gmlp__prompt'

def setup_inputs():

    _w = lambda a: (lambda t: t.to(torch.bfloat16) if t.is_floating_point() else t)(torch.as_tensor(a))

    def _A_setup():
        B, S, D, H = (1, 2048, 576, 32)
        return {'x': _w((lambda *s: torch.randn(*s, dtype=torch.bfloat16) * 0.05)(B, S, D)), 'wqkv': _w((lambda *s: torch.randn(*s, dtype=torch.bfloat16) * 0.05)(D, 3 * D)), 'wo': _w((lambda *s: torch.randn(*s, dtype=torch.bfloat16) * 0.05)(D, D))}
    _A_in = _A_setup()

    def _B_setup():
        B, S, D, F = (1, 2048, 576, 4608)
        Fh = F // 2
        return {'x': _w((lambda *s: torch.randn(*s, dtype=torch.bfloat16) * 0.05)(B, S, D)), 'w_in': _w((lambda *s: torch.randn(*s, dtype=torch.bfloat16) * 1.6)(D, 2 * Fh)), 'w_sp': _w(0.01 * (lambda *s: torch.randn(*s, dtype=torch.bfloat16) * 1.6)(S, S)), 'b_sp': _w(1.0 + 0.01 * (lambda *s: torch.randn(*s, dtype=torch.bfloat16) * 0.05)(S)), 'w_out': _w((lambda *s: torch.randn(*s, dtype=torch.bfloat16) * 0.05)(Fh, D))}
    _B_in = _B_setup()
    return {'A_x': _A_in['x'], 'A_wqkv': _A_in['wqkv'], 'A_wo': _A_in['wo'], 'B_x': _B_in['x'], 'B_w_in': _B_in['w_in'], 'B_w_sp': _B_in['w_sp'], 'B_b_sp': _B_in['b_sp'], 'B_w_out': _B_in['w_out']}

def reference(A_x, A_wqkv, A_wo, B_x, B_w_in, B_w_sp, B_b_sp, B_w_out):

    def _A_ref(x, wqkv, wo):
        B, S, D = x.shape
        H = 32
        Dh = D // H
        qkv = (lambda x, *d: x.permute(*d))((x @ wqkv).reshape(B, S, 3, H, Dh), 2, 0, 3, 1, 4)
        q, k, v = (qkv[0], qkv[1], qkv[2])
        scores = torch.einsum('bhqd,bhkd->bhqk', q, k) * Dh ** (-0.5)
        p = _softmax(scores, axis=-1)
        o = torch.einsum('bhqk,bhkd->bhqd', p, v)
        return (lambda x, *d: x.permute(*d))(o, 0, 2, 1, 3).reshape(B, S, D) @ wo

    def _B_ref(x, w_in, w_sp, b_sp, w_out):
        B, S, D = x.shape
        F = w_in.shape[-1]
        Fh = F // 2
        z = _gelu(torch.einsum('bsd,df->bsf', x, w_in))
        z1 = z[..., :Fh].clone()
        z2 = _layernorm(z[..., Fh:], axis=-1)
        g = torch.einsum('ts,bsf->btf', w_sp, z2) + b_sp[None, :, None]
        return torch.einsum('bsf,fd->bsd', z1 * g, w_out)
    x = A_x
    xn = _layernorm(x, axis=-1)
    s = _A_ref(xn, A_wqkv, A_wo)
    g = _silu(_B_ref(xn, B_w_in, B_w_sp, B_b_sp, B_w_out))
    return x + s * g
```

```asm
; @launch kernel=p1_kernel grid=(256,1,1) block=(512,1,1) lds=156736
; @launch kernel=p2_kernel grid=(256,1,1) block=(512,1,1) lds=163840
.amdgcn_target "amdgcn-amd-amdhsa--gfx950"
.text
.globl p1_kernel
.p2align 8
.type p1_kernel,@function
p1_kernel:
    s_cmp_ge_u32 s2, 256
    s_cbranch_scc1 p1_kernel_end_x
    s_load_dwordx2 s[4:5], s[0:1], 80
    s_load_dwordx4 s[44:47], s[0:1], 32
    s_load_dwordx2 s[40:41], s[0:1], 8
    s_load_dwordx2 s[6:7], s[0:1], 0
    s_load_dwordx2 s[36:37], s[0:1], 72
    s_memrealtime s[34:35]
    s_getpc_b64 s[8:9]
p1cp_1_pc:
    s_sub_u32 s8, s8, p1cp_1_pc-p1_kernel
    s_subb_u32 s9, s9, 0
    s_lshr_b32 s3, s2, 3
    s_lshl_b32 s3, s3, 11
    v_lshlrev_b32 v2, 6, v0
    v_add_u32 v2, s3, v2
    v_min_u32 v2, text_end-p1_kernel-4, v2
    v_mov_b32 v3, s9
    v_add_co_u32 v2, vcc, s8, v2
    s_nop 1
    v_addc_co_u32 v3, vcc, 0, v3, vcc
    v_cmp_gt_u32 vcc, 32, v0
    s_and_saveexec_b64 s[10:11], vcc
    s_cbranch_execz p1cp_1
    global_load_dword v247, v[2:3], off
p1cp_1:
    s_mov_b64 exec, s[10:11]
    s_and_b32 s3, s2, 7
    s_lshr_b32 s42, s2, 3
    s_lshr_b32 s20, s3, 2
    s_lshl_b32 s20, s20, 2
    s_lshr_b32 s43, s42, 3
    s_add_u32 s20, s20, s43
    s_and_b32 s21, s3, 3
    s_lshl_b32 s21, s21, 3
    s_and_b32 s43, s42, 7
    s_add_u32 s21, s21, s43
    v_lshrrev_b32 v1, 6, v0
    s_nop 0
    v_readfirstlane_b32 s22, v1
    v_and_b32 v1, 63, v0
    s_lshr_b32 s23, s22, 2
    v_and_b32 v16, 31, v1
    v_lshrrev_b32 v19, 5, v1
    s_lshl_b32 s25, s20, 8
    s_lshl_b32 s26, s21, 3
    s_add_u32 s25, s25, s26
    s_sub_u32 s26, s22, 4
    s_lshl_b32 s26, s26, 1
    s_add_u32 s28, s25, s26
    s_mul_i32 s28, s28, 1152
    v_mul_u32_u24 v20, 1152, v19
    v_lshl_add_u32 v20, v16, 4, v20
    s_mov_b32 s50, 2359296
    s_mov_b32 s51, 0x00020000
    s_cmp_eq_u32 s23, 0
    s_waitcnt lgkmcnt(0)
    s_cbranch_scc1 p1_kernel_nx
    s_mov_b32 s48, s6
    s_mov_b32 s49, s7
    s_mov_b32 exec_lo, 0x00ffffff
    s_mov_b32 exec_hi, 0x00ffffff
    buffer_load_dwordx4 v[96:99], v20, s[48:51], s28 offen
    buffer_load_dwordx4 v[100:103], v20, s[48:51], s28 offen offset:384
    buffer_load_dwordx4 v[104:107], v20, s[48:51], s28 offen offset:768
    s_mov_b64 exec, -1
p1_kernel_nx:
    s_and_b32 s43, s21, 1
    s_lshl_b32 s43, s43, 2
    s_xor_b32 s43, s43, s22
    s_lshl_b32 s24, s20, 3
    s_add_u32 s24, s24, s43
    v_lshrrev_b32 v17, 2, v16
    v_and_b32 v18, 3, v1
    v_lshlrev_b32 v18, 4, v18
    v_lshl_add_u32 v18, v19, 6, v18
    v_mul_u32_u24 v2, 9216, v17
    v_add_u32 v2, v2, v18
    v_mul_u32_u24 v3, 3456, v17
    v_add_u32 v3, v3, v18
    v_lshlrev_b32 v245, 4, v1
    s_mov_b32 s38, 0x80000
    s_mov_b32 s39, 0x40000
    v_mov_b32 v243, 1
    v_mov_b32 v246, 0
    v_mov_b32 v242, 156672
    v_lshlrev_b32 v20, 2, v1
    v_add_u32 v20, 156672, v20
    s_mov_b64 exec, 0xffff
    ds_write_b32 v20, v246
    s_mov_b64 exec, -1
    s_lshl_b32 s27, s21, 7
    s_add_u32 s27, s27, 4608
    s_cmp_eq_u32 s23, 0
    s_cselect_b64 s[52:53], -1, 0
    s_cselect_b64 s[54:55], 0, -1
    s_waitcnt lgkmcnt(0)
    s_mov_b32 s8, s4
    s_mov_b32 s9, s5
    s_mov_b32 s10, 0x2400000
    s_mov_b32 s11, 0x00020000
    s_mov_b32 s12, s44
    s_mov_b32 s13, s45
    s_mov_b32 s14, 0x510000
    s_mov_b32 s15, 0x00020000
    s_mov_b32 s16, s40
    s_mov_b32 s17, s41
    s_mov_b32 s18, 0x1e6000
    s_mov_b32 s19, 0x00020000
    s_mov_b32 s40, s36
    s_mov_b32 s41, s37
    s_mov_b32 s42, 0x100
    s_mov_b32 s43, 0x00020000
    s_mul_i32 s37, s24, 36864
    s_barrier
    s_cmp_eq_u32 s23, 0
    s_cbranch_scc1 p1g1_2
    s_setprio 3
    v_lshlrev_b32 v21, 7, v16
    v_add_u32 v22, s26, v19
    v_lshl_add_u32 v21, v22, 4, v21
    v_add_u32 v21, 147456, v21
    v_mov_b32 v136, 0
    v_mov_b32 v137, 0
    v_mov_b32 v138, 0
    v_mov_b32 v139, 0
    s_sub_u32 s26, s22, 4
    s_lshl_b32 s27, s26, 10
    s_add_u32 s27, s27, 147456
    v_add_u32 v24, s27, v245
    v_lshrrev_b32 v22, 3, v1
    v_lshlrev_b32 v22, 9, v22
    v_and_b32 v23, 7, v1
    v_lshl_add_u32 v22, v23, 4, v22
    s_lshr_b32 s27, s25, 5
    s_mul_i32 s28, s27, 36864
    s_and_b32 s29, s25, 31
    s_lshl_b32 s29, s29, 4
    s_add_u32 s28, s28, s29
    s_lshl_b32 s29, s26, 12
    s_add_u32 s28, s28, s29
    s_add_u32 s29, s28, 16384
    s_add_u32 s30, s28, 32768
    s_lshl_b32 s27, s27, 2
    s_and_b32 s33, s21, 3
    s_add_u32 s27, s27, s33
    s_lshl_b32 s27, s27, 2
    s_add_u32 s27, s27, s26
    s_lshl_b32 s27, s27, 7
    s_add_u32 s27, s27, 2359296
    s_mov_b32 s34, 0x00ffffff
    s_mov_b32 s35, 0x00ffffff
    s_mov_b64 s[6:7], -1
    s_waitcnt vmcnt(0)
p1ln_4:
    s_mov_b64 exec, s[34:35]
    v_lshlrev_b32 v108, 16, v96
    v_and_b32 v109, 0xffff0000, v96
    v_add_f32 v136, v136, v108
    v_add_f32 v137, v137, v109
    v_lshlrev_b32 v110, 16, v97
    v_and_b32 v111, 0xffff0000, v97
    v_add_f32 v136, v136, v110
    v_add_f32 v137, v137, v111
    v_lshlrev_b32 v112, 16, v98
    v_and_b32 v113, 0xffff0000, v98
    v_add_f32 v136, v136, v112
    v_add_f32 v137, v137, v113
    v_lshlrev_b32 v114, 16, v99
    v_and_b32 v115, 0xffff0000, v99
    v_add_f32 v136, v136, v114
    v_add_f32 v137, v137, v115
    v_lshlrev_b32 v116, 16, v100
    v_and_b32 v117, 0xffff0000, v100
    v_add_f32 v136, v136, v116
    v_add_f32 v137, v137, v117
    v_lshlrev_b32 v118, 16, v101
    v_and_b32 v119, 0xffff0000, v101
    v_add_f32 v136, v136, v118
    v_add_f32 v137, v137, v119
    v_lshlrev_b32 v120, 16, v102
    v_and_b32 v121, 0xffff0000, v102
    v_add_f32 v136, v136, v120
    v_add_f32 v137, v137, v121
    v_lshlrev_b32 v122, 16, v103
    v_and_b32 v123, 0xffff0000, v103
    v_add_f32 v136, v136, v122
    v_add_f32 v137, v137, v123
    v_lshlrev_b32 v124, 16, v104
    v_and_b32 v125, 0xffff0000, v104
    v_add_f32 v136, v136, v124
    v_add_f32 v137, v137, v125
    v_lshlrev_b32 v126, 16, v105
    v_and_b32 v127, 0xffff0000, v105
    v_add_f32 v136, v136, v126
    v_add_f32 v137, v137, v127
    v_lshlrev_b32 v128, 16, v106
    v_and_b32 v129, 0xffff0000, v106
    v_add_f32 v136, v136, v128
    v_add_f32 v137, v137, v129
    v_lshlrev_b32 v130, 16, v107
    v_and_b32 v131, 0xffff0000, v107
    v_add_f32 v136, v136, v130
    v_add_f32 v137, v137, v131
    s_mov_b64 exec, s[6:7]
    v_add_f32 v136, v136, v137
    s_nop 1
    v_add_f32_dpp v136, v136, v136 row_ror:8 row_mask:0xf bank_mask:0xf
    s_nop 1
    v_add_f32_dpp v136, v136, v136 row_ror:4 row_mask:0xf bank_mask:0xf
    s_nop 1
    v_add_f32_dpp v136, v136, v136 row_ror:2 row_mask:0xf bank_mask:0xf
    s_nop 1
    v_add_f32_dpp v136, v136, v136 row_ror:1 row_mask:0xf bank_mask:0xf
    v_mov_b32 v137, v136
    s_nop 1
    v_permlane16_swap_b32 v136, v137
    v_add_f32 v136, v136, v137
    v_mul_f32 v136, 0x3ae38e39, v136
    s_mov_b64 exec, s[34:35]
    v_sub_f32 v140, v108, v136
    v_sub_f32 v141, v109, v136
    v_fmac_f32 v138, v140, v140
    v_fmac_f32 v139, v141, v141
    v_sub_f32 v140, v110, v136
    v_sub_f32 v141, v111, v136
    v_fmac_f32 v138, v140, v140
    v_fmac_f32 v139, v141, v141
    v_sub_f32 v140, v112, v136
    v_sub_f32 v141, v113, v136
    v_fmac_f32 v138, v140, v140
    v_fmac_f32 v139, v141, v141
    v_sub_f32 v140, v114, v136
    v_sub_f32 v141, v115, v136
    v_fmac_f32 v138, v140, v140
    v_fmac_f32 v139, v141, v141
    v_sub_f32 v140, v116, v136
    v_sub_f32 v141, v117, v136
    v_fmac_f32 v138, v140, v140
    v_fmac_f32 v139, v141, v141
    v_sub_f32 v140, v118, v136
    v_sub_f32 v141, v119, v136
    v_fmac_f32 v138, v140, v140
    v_fmac_f32 v139, v141, v141
    v_sub_f32 v140, v120, v136
    v_sub_f32 v141, v121, v136
    v_fmac_f32 v138, v140, v140
    v_fmac_f32 v139, v141, v141
    v_sub_f32 v140, v122, v136
    v_sub_f32 v141, v123, v136
    v_fmac_f32 v138, v140, v140
    v_fmac_f32 v139, v141, v141
    v_sub_f32 v140, v124, v136
    v_sub_f32 v141, v125, v136
    v_fmac_f32 v138, v140, v140
    v_fmac_f32 v139, v141, v141
    v_sub_f32 v140, v126, v136
    v_sub_f32 v141, v127, v136
    v_fmac_f32 v138, v140, v140
    v_fmac_f32 v139, v141, v141
    v_sub_f32 v140, v128, v136
    v_sub_f32 v141, v129, v136
    v_fmac_f32 v138, v140, v140
    v_fmac_f32 v139, v141, v141
    v_sub_f32 v140, v130, v136
    v_sub_f32 v141, v131, v136
    v_fmac_f32 v138, v140, v140
    v_fmac_f32 v139, v141, v141
    s_mov_b64 exec, s[6:7]
    v_add_f32 v138, v138, v139
    s_nop 1
    v_add_f32_dpp v138, v138, v138 row_ror:8 row_mask:0xf bank_mask:0xf
    s_nop 1
    v_add_f32_dpp v138, v138, v138 row_ror:4 row_mask:0xf bank_mask:0xf
    s_nop 1
    v_add_f32_dpp v138, v138, v138 row_ror:2 row_mask:0xf bank_mask:0xf
    s_nop 1
    v_add_f32_dpp v138, v138, v138 row_ror:1 row_mask:0xf bank_mask:0xf
    v_mov_b32 v139, v138
    s_nop 1
    v_permlane16_swap_b32 v138, v139
    v_add_f32 v138, v138, v139
    v_mul_f32 v138, 0x3ae38e39, v138
    v_cvt_pk_bf16_f32 v136, v136, v138
    v_and_b32 v138, 0xffff0000, v136
    v_lshlrev_b32 v136, 16, v136
    v_add_f32 v138, 0x3727c5ac, v138
    v_cvt_pk_bf16_f32 v138, v138, v138
    v_lshlrev_b32 v138, 16, v138
    v_sqrt_f32 v138, v138
    s_nop 0
    v_cvt_pk_bf16_f32 v138, v138, v138
    v_lshlrev_b32 v138, 16, v138
    v_rcp_f32 v138, v138
    v_sub_f32 v108, v108, v136
    v_sub_f32 v109, v109, v136
    v_cvt_pk_bf16_f32 v96, v108, v109
    v_sub_f32 v110, v110, v136
    v_sub_f32 v111, v111, v136
    v_cvt_pk_bf16_f32 v97, v110, v111
    v_sub_f32 v112, v112, v136
    v_sub_f32 v113, v113, v136
    v_cvt_pk_bf16_f32 v98, v112, v113
    v_sub_f32 v114, v114, v136
    v_sub_f32 v115, v115, v136
    v_cvt_pk_bf16_f32 v99, v114, v115
    v_sub_f32 v116, v116, v136
    v_sub_f32 v117, v117, v136
    v_cvt_pk_bf16_f32 v100, v116, v117
    v_sub_f32 v118, v118, v136
    v_sub_f32 v119, v119, v136
    v_cvt_pk_bf16_f32 v101, v118, v119
    v_sub_f32 v120, v120, v136
    v_sub_f32 v121, v121, v136
    v_cvt_pk_bf16_f32 v102, v120, v121
    v_sub_f32 v122, v122, v136
    v_sub_f32 v123, v123, v136
    v_cvt_pk_bf16_f32 v103, v122, v123
    v_sub_f32 v124, v124, v136
    v_sub_f32 v125, v125, v136
    v_cvt_pk_bf16_f32 v104, v124, v125
    v_sub_f32 v126, v126, v136
    v_sub_f32 v127, v127, v136
    v_cvt_pk_bf16_f32 v105, v126, v127
    v_sub_f32 v128, v128, v136
    v_sub_f32 v129, v129, v136
    v_cvt_pk_bf16_f32 v106, v128, v129
    v_sub_f32 v130, v130, v136
    v_sub_f32 v131, v131, v136
    v_cvt_pk_bf16_f32 v107, v130, v131
    s_mov_b64 exec, s[34:35]
    v_lshlrev_b32 v108, 16, v96
    v_and_b32 v109, 0xffff0000, v96
    v_mul_f32 v108, v108, v138
    v_mul_f32 v109, v109, v138
    v_cvt_pk_bf16_f32 v96, v108, v109
    v_lshlrev_b32 v110, 16, v97
    v_and_b32 v111, 0xffff0000, v97
    v_mul_f32 v110, v110, v138
    v_mul_f32 v111, v111, v138
    v_cvt_pk_bf16_f32 v97, v110, v111
    v_lshlrev_b32 v112, 16, v98
    v_and_b32 v113, 0xffff0000, v98
    v_mul_f32 v112, v112, v138
    v_mul_f32 v113, v113, v138
    v_cvt_pk_bf16_f32 v98, v112, v113
    v_lshlrev_b32 v114, 16, v99
    v_and_b32 v115, 0xffff0000, v99
    v_mul_f32 v114, v114, v138
    v_mul_f32 v115, v115, v138
    v_cvt_pk_bf16_f32 v99, v114, v115
    ds_write_b128 v21, v[96:99] offset:0
    v_lshlrev_b32 v116, 16, v100
    v_and_b32 v117, 0xffff0000, v100
    v_mul_f32 v116, v116, v138
    v_mul_f32 v117, v117, v138
    v_cvt_pk_bf16_f32 v100, v116, v117
    v_lshlrev_b32 v118, 16, v101
    v_and_b32 v119, 0xffff0000, v101
    v_mul_f32 v118, v118, v138
    v_mul_f32 v119, v119, v138
    v_cvt_pk_bf16_f32 v101, v118, v119
    v_lshlrev_b32 v120, 16, v102
    v_and_b32 v121, 0xffff0000, v102
    v_mul_f32 v120, v120, v138
    v_mul_f32 v121, v121, v138
    v_cvt_pk_bf16_f32 v102, v120, v121
    v_lshlrev_b32 v122, 16, v103
    v_and_b32 v123, 0xffff0000, v103
    v_mul_f32 v122, v122, v138
    v_mul_f32 v123, v123, v138
    v_cvt_pk_bf16_f32 v103, v122, v123
    ds_write_b128 v21, v[100:103] offset:3072
    v_lshlrev_b32 v124, 16, v104
    v_and_b32 v125, 0xffff0000, v104
    v_mul_f32 v124, v124, v138
    v_mul_f32 v125, v125, v138
    v_cvt_pk_bf16_f32 v104, v124, v125
    v_lshlrev_b32 v126, 16, v105
    v_and_b32 v127, 0xffff0000, v105
    v_mul_f32 v126, v126, v138
    v_mul_f32 v127, v127, v138
    v_cvt_pk_bf16_f32 v105, v126, v127
    v_lshlrev_b32 v128, 16, v106
    v_and_b32 v129, 0xffff0000, v106
    v_mul_f32 v128, v128, v138
    v_mul_f32 v129, v129, v138
    v_cvt_pk_bf16_f32 v106, v128, v129
    v_lshlrev_b32 v130, 16, v107
    v_and_b32 v131, 0xffff0000, v107
    v_mul_f32 v130, v130, v138
    v_mul_f32 v131, v131, v138
    v_cvt_pk_bf16_f32 v107, v130, v131
    ds_write_b128 v21, v[104:107] offset:6144
    s_mov_b64 exec, s[6:7]
    s_mov_b64 exec, 1
    ds_add_u32 v242, v243 offset:32
    s_mov_b64 exec, -1
    buffer_load_dwordx2 v[248:249], v246, s[40:43], 0 offen sc1
p1fw_6:
    ds_read_b32 v244, v242 offset:32
    s_waitcnt lgkmcnt(0)
    v_readfirstlane_b32 s25, v244
    s_cmp_ge_u32 s25, 4
    s_cbranch_scc1 p1fd_7
    s_sleep 1
    s_sub_u32 s38, s38, 1
    s_cmp_gt_i32 s38, 0
    s_cbranch_scc1 p1fw_6
p1fd_7:
    ds_read_b128 v[96:99], v24
    ds_read_b128 v[100:103], v24 offset:4096
    ds_read_b128 v[104:107], v24 offset:8192
    s_waitcnt lgkmcnt(2)
    buffer_store_dwordx4 v[96:99], v22, s[8:11], s28 offen sc1
    s_waitcnt lgkmcnt(1)
    buffer_store_dwordx4 v[100:103], v22, s[8:11], s29 offen sc1
    s_waitcnt lgkmcnt(0)
    s_cmp_lg_u32 s22, 4
    s_cbranch_scc1 p1n9_8
    buffer_store_dwordx4 v[104:107], v22, s[8:11], s30 offen sc1
p1n9_8:
    s_waitcnt vmcnt(0)
    v_readfirstlane_b32 s101, v249
    v_readfirstlane_b32 s100, v248
    s_cmp_lt_i32 s101, 0
    s_cbranch_scc1 p1n9_8_t
p1tg_9:
    buffer_load_dwordx2 v[248:249], v246, s[40:43], 0 offen sc1
    s_waitcnt vmcnt(0)
    v_readfirstlane_b32 s101, v249
    v_readfirstlane_b32 s100, v248
    s_cmp_lt_i32 s101, 0
    s_cbranch_scc1 p1tgd_10
    s_sleep 2
    s_sub_u32 s39, s39, 1
    s_cmp_gt_i32 s39, 0
    s_cbranch_scc1 p1tg_9
p1tgd_10:
p1n9_8_t:
    v_lshrrev_b32 v247, 1, v245
    s_mov_b64 exec, 0xffff
    buffer_store_dwordx2 v[248:249], v247, s[8:11], s27 offen sc1
    s_mov_b64 exec, 1
    ds_add_u32 v242, v243 offset:40
    s_mov_b64 exec, -1
    s_setprio 0
    s_mov_b32 s48, s12
    s_mov_b32 s49, s13
    s_mov_b32 s50, s14
    s_mov_b32 s51, s15
    v_mov_b32 v241, v2
    s_branch p1c_3
p1g1_2:
    s_or_b32 s25, s2, s22
    s_cmp_lg_u32 s25, 0
    s_cbranch_scc1 p1nt_11
    v_mov_b32 v248, s34
    v_mov_b32 v249, s35
    v_or_b32 v249, 0x80000000, v249
    s_mov_b64 exec, 1
    buffer_store_dwordx2 v[248:249], v246, s[40:43], 0 offen sc1
    s_mov_b32 s25, 3571712
    buffer_store_dwordx2 v[248:249], v246, s[8:11], s25 offen sc1
    s_mov_b64 exec, -1
p1nt_11:
    s_cmp_lg_u32 s22, 3
    s_cbranch_scc1 p1tlb_12
    s_load_dwordx2 s[32:33], s[0:1], 64
    v_lshlrev_b32 v20, 21, v1
    buffer_load_dword v21, v20, s[8:11], 0 offen
    s_mov_b32 s48, s46
    s_mov_b32 s49, s47
    s_mov_b32 s50, 8388608
    s_mov_b32 s51, 0x00020000
    buffer_load_dword v21, v20, s[48:51], 0 offen
    buffer_load_dword v21, v20, s[16:19], 0 offen
    s_waitcnt lgkmcnt(0)
    s_mov_b32 s48, s32
    s_mov_b32 s49, s33
    s_mov_b32 s50, 2359296
    buffer_load_dword v21, v20, s[48:51], 0 offen
p1tlb_12:
    s_mov_b32 s48, s12
    s_mov_b32 s49, s13
    s_mov_b32 s50, s14
    s_mov_b32 s51, s15
    v_mov_b32 v241, v2
    s_mov_b32 s30, 73728
    s_mul_i32 s25, s22, 18
    s_mul_i32 s29, s25, s30
    s_add_u32 s29, s29, s27
    s_lshl_b32 s25, s25, 10
    s_add_u32 m0, s25, 0
    s_nop 0
    buffer_load_dwordx4 v241, s[48:51], s29 offen lds
    s_add_u32 s29, s29, s30
    s_add_u32 m0, m0, 1024
    s_nop 0
    buffer_load_dwordx4 v241, s[48:51], s29 offen lds
    s_add_u32 s29, s29, s30
    s_add_u32 m0, m0, 1024
    s_nop 0
    buffer_load_dwordx4 v241, s[48:51], s29 offen lds
    s_add_u32 s29, s29, s30
    s_add_u32 m0, m0, 1024
    s_nop 0
    buffer_load_dwordx4 v241, s[48:51], s29 offen lds
    s_add_u32 s29, s29, s30
    s_add_u32 m0, m0, 1024
    s_nop 0
    buffer_load_dwordx4 v241, s[48:51], s29 offen lds
    s_add_u32 s29, s29, s30
    s_add_u32 m0, m0, 1024
    s_nop 0
    buffer_load_dwordx4 v241, s[48:51], s29 offen lds
    s_add_u32 s29, s29, s30
    s_add_u32 m0, m0, 1024
    s_nop 0
    buffer_load_dwordx4 v241, s[48:51], s29 offen lds
    s_add_u32 s29, s29, s30
    s_add_u32 m0, m0, 1024
    s_nop 0
    buffer_load_dwordx4 v241, s[48:51], s29 offen lds
    s_add_u32 s29, s29, s30
    s_add_u32 m0, m0, 1024
    s_nop 0
    buffer_load_dwordx4 v241, s[48:51], s29 offen lds
    s_add_u32 s29, s29, s30
    s_add_u32 m0, m0, 1024
    s_nop 0
    buffer_load_dwordx4 v241, s[48:51], s29 offen lds
    s_add_u32 s29, s29, s30
    s_add_u32 m0, m0, 1024
    s_nop 0
    buffer_load_dwordx4 v241, s[48:51], s29 offen lds
    s_add_u32 s29, s29, s30
    s_add_u32 m0, m0, 1024
    s_nop 0
    buffer_load_dwordx4 v241, s[48:51], s29 offen lds
    s_add_u32 s29, s29, s30
    s_add_u32 m0, m0, 1024
    s_nop 0
    buffer_load_dwordx4 v241, s[48:51], s29 offen lds
    s_add_u32 s29, s29, s30
    s_add_u32 m0, m0, 1024
    s_nop 0
    buffer_load_dwordx4 v241, s[48:51], s29 offen lds
    s_add_u32 s29, s29, s30
    s_add_u32 m0, m0, 1024
    s_nop 0
    buffer_load_dwordx4 v241, s[48:51], s29 offen lds
    s_add_u32 s29, s29, s30
    s_add_u32 m0, m0, 1024
    s_nop 0
    buffer_load_dwordx4 v241, s[48:51], s29 offen lds
    s_add_u32 s29, s29, s30
    s_add_u32 m0, m0, 1024
    s_nop 0
    buffer_load_dwordx4 v241, s[48:51], s29 offen lds
    s_add_u32 s29, s29, s30
    s_add_u32 m0, m0, 1024
    s_nop 0
    buffer_load_dwordx4 v241, s[48:51], s29 offen lds
    s_add_u32 s29, s29, s30
    s_add_u32 m0, m0, 1024
    s_mul_i32 s34, s2, 3
    s_add_u32 s34, s34, s22
    s_cmp_ge_u32 s22, 3
    s_cselect_b32 s34, 1000, s34
    s_cmpk_ge_u32 s34, 720
    s_cbranch_scc1 wfl_13
    s_load_dwordx2 s[32:33], s[0:1], 56
    s_load_dwordx2 s[6:7], s[0:1], 16
    s_lshr_b32 s25, s34, 3
    s_and_b32 s26, s34, 7
    s_mul_i32 s27, s26, 90
    s_add_u32 s27, s27, s25
    s_mul_i32 s35, s27, 4608
    s_add_u32 s35, s35, 32505856
    s_mul_i32 s26, s26, 144
    s_sub_u32 s27, s25, 72
    s_cmp_ge_u32 s25, 72
    s_cselect_b32 s25, s27, s25
    s_cselect_b64 vcc, -1, 0
    s_lshl_b32 s25, s25, 5
    s_mul_i32 s28, s22, 5120
    s_add_u32 m0, s28, 73728
    s_waitcnt lgkmcnt(0)
    s_cmp_lg_u64 vcc, 0
    s_cselect_b32 s48, s6, s32
    s_cselect_b32 s49, s7, s33
    s_mov_b32 s50, 2654208
    s_cselect_b32 s50, 663552, s50
    s_mov_b32 s51, 0x00020000
    s_mov_b64 s[32:33], vcc
    v_add_u32 v192, 0, v1
    v_mul_u32_u24 v193, 7282, v192
    v_lshrrev_b32 v193, 16, v193
    v_mul_u32_u24 v194, 9, v193
    v_sub_u32 v194, v192, v194
    v_add_u32 v193, s25, v193
    v_lshrrev_b32 v195, 4, v193
    v_lshl_add_u32 v195, v195, 1, v193
    v_lshrrev_b32 v196, 1, v193
    v_lshl_add_u32 v196, v196, 4, v193
    v_subrev_u32 v196, 4592, v196
    v_cmp_lt_u32 vcc, 511, v193
    s_nop 1
    v_cndmask_b32 v195, v195, v196, vcc
    v_cndmask_b32 v193, v193, v195, s[32:33]
    v_mul_u32_u24 v193, 1152, v193
    v_lshl_add_u32 v197, v194, 4, v193
    buffer_load_dwordx4 v197, s[48:51], s26 offen lds
    s_add_u32 m0, m0, 1024
    v_add_u32 v192, 64, v1
    v_mul_u32_u24 v193, 7282, v192
    v_lshrrev_b32 v193, 16, v193
    v_mul_u32_u24 v194, 9, v193
    v_sub_u32 v194, v192, v194
    v_add_u32 v193, s25, v193
    v_lshrrev_b32 v195, 4, v193
    v_lshl_add_u32 v195, v195, 1, v193
    v_lshrrev_b32 v196, 1, v193
    v_lshl_add_u32 v196, v196, 4, v193
    v_subrev_u32 v196, 4592, v196
    v_cmp_lt_u32 vcc, 511, v193
    s_nop 1
    v_cndmask_b32 v195, v195, v196, vcc
    v_cndmask_b32 v193, v193, v195, s[32:33]
    v_mul_u32_u24 v193, 1152, v193
    v_lshl_add_u32 v198, v194, 4, v193
    buffer_load_dwordx4 v198, s[48:51], s26 offen lds
    s_add_u32 m0, m0, 1024
    v_add_u32 v192, 128, v1
    v_mul_u32_u24 v193, 7282, v192
    v_lshrrev_b32 v193, 16, v193
    v_mul_u32_u24 v194, 9, v193
    v_sub_u32 v194, v192, v194
    v_add_u32 v193, s25, v193
    v_lshrrev_b32 v195, 4, v193
    v_lshl_add_u32 v195, v195, 1, v193
    v_lshrrev_b32 v196, 1, v193
    v_lshl_add_u32 v196, v196, 4, v193
    v_subrev_u32 v196, 4592, v196
    v_cmp_lt_u32 vcc, 511, v193
    s_nop 1
    v_cndmask_b32 v195, v195, v196, vcc
    v_cndmask_b32 v193, v193, v195, s[32:33]
    v_mul_u32_u24 v193, 1152, v193
    v_lshl_add_u32 v199, v194, 4, v193
    buffer_load_dwordx4 v199, s[48:51], s26 offen lds
    s_add_u32 m0, m0, 1024
    v_add_u32 v192, 192, v1
    v_mul_u32_u24 v193, 7282, v192
    v_lshrrev_b32 v193, 16, v193
    v_mul_u32_u24 v194, 9, v193
    v_sub_u32 v194, v192, v194
    v_add_u32 v193, s25, v193
    v_lshrrev_b32 v195, 4, v193
    v_lshl_add_u32 v195, v195, 1, v193
    v_lshrrev_b32 v196, 1, v193
    v_lshl_add_u32 v196, v196, 4, v193
    v_subrev_u32 v196, 4592, v196
    v_cmp_lt_u32 vcc, 511, v193
    s_nop 1
    v_cndmask_b32 v195, v195, v196, vcc
    v_cndmask_b32 v193, v193, v195, s[32:33]
    v_mul_u32_u24 v193, 1152, v193
    v_lshl_add_u32 v200, v194, 4, v193
    buffer_load_dwordx4 v200, s[48:51], s26 offen lds
    s_add_u32 m0, m0, 1024
    v_add_u32 v192, 256, v1
    v_mul_u32_u24 v193, 7282, v192
    v_lshrrev_b32 v193, 16, v193
    v_mul_u32_u24 v194, 9, v193
    v_sub_u32 v194, v192, v194
    v_add_u32 v193, s25, v193
    v_lshrrev_b32 v195, 4, v193
    v_lshl_add_u32 v195, v195, 1, v193
    v_lshrrev_b32 v196, 1, v193
    v_lshl_add_u32 v196, v196, 4, v193
    v_subrev_u32 v196, 4592, v196
    v_cmp_lt_u32 vcc, 511, v193
    s_nop 1
    v_cndmask_b32 v195, v195, v196, vcc
    v_cndmask_b32 v193, v193, v195, s[32:33]
    v_mul_u32_u24 v193, 1152, v193
    v_lshl_add_u32 v201, v194, 4, v193
    s_mov_b64 exec, 0xffffffff
    buffer_load_dwordx4 v201, s[48:51], s26 offen lds
    s_mov_b64 exec, -1
wfl_13:
p1tg_14:
    buffer_load_dwordx2 v[248:249], v246, s[40:43], 0 offen sc1
    s_waitcnt vmcnt(0)
    v_readfirstlane_b32 s101, v249
    v_readfirstlane_b32 s100, v248
    s_cmp_lt_i32 s101, 0
    s_cbranch_scc1 p1tgd_15
    s_sleep 2
    s_sub_u32 s39, s39, 1
    s_cmp_gt_i32 s39, 0
    s_cbranch_scc1 p1tg_14
p1tgd_15:
p1fw_16:
    ds_read_b32 v244, v242 offset:40
    s_waitcnt lgkmcnt(0)
    v_readfirstlane_b32 s25, v244
    s_cmp_ge_u32 s25, 4
    s_cbranch_scc1 p1fd_17
    s_sleep 1
    s_sub_u32 s38, s38, 1
    s_cmp_gt_i32 s38, 0
    s_cbranch_scc1 p1fw_16
p1fd_17:
    s_cmpk_ge_u32 s34, 720
    s_cbranch_scc1 wfs_18
    s_mul_i32 s25, s22, 5120
    s_add_u32 s25, s25, 73728
    v_lshrrev_b32 v192, 4, v1
    v_lshlrev_b32 v193, 3, v192
    v_bfe_u32 v194, v1, 2, 2
    v_add_u32 v193, v193, v194
    v_mul_u32_u24 v193, 144, v193
    v_and_b32 v194, 3, v1
    v_lshl_add_u32 v193, v194, 3, v193
    v_add_u32 v193, s25, v193
    ds_read_b64_tr_b16 v[144:145], v193 offset:0
    ds_read_b64_tr_b16 v[146:147], v193 offset:576
    ds_read_b64_tr_b16 v[148:149], v193 offset:32
    ds_read_b64_tr_b16 v[150:151], v193 offset:608
    ds_read_b64_tr_b16 v[152:153], v193 offset:64
    ds_read_b64_tr_b16 v[154:155], v193 offset:640
    ds_read_b64_tr_b16 v[156:157], v193 offset:96
    ds_read_b64_tr_b16 v[158:159], v193 offset:672
    ds_read_b64_tr_b16 v[160:161], v193 offset:128
    ds_read_b64_tr_b16 v[162:163], v193 offset:704
    v_and_b32 v194, 15, v1
    v_lshlrev_b32 v195, 4, v194
    v_lshl_add_u32 v195, v192, 7, v195
    v_add_u32 v195, 4096, v195
    v_mov_b32 v196, 0x7f000000
    v_cmp_gt_u32 vcc, 8, v194
    s_nop 1
    v_cndmask_b32 v195, v196, v195, vcc
    s_waitcnt lgkmcnt(8)
    buffer_store_dwordx4 v[144:147], v245, s[8:11], s35 offen offset:0 sc1
    s_waitcnt lgkmcnt(6)
    buffer_store_dwordx4 v[148:151], v245, s[8:11], s35 offen offset:1024 sc1
    s_waitcnt lgkmcnt(4)
    buffer_store_dwordx4 v[152:155], v245, s[8:11], s35 offen offset:2048 sc1
    s_waitcnt lgkmcnt(2)
    buffer_store_dwordx4 v[156:159], v245, s[8:11], s35 offen offset:3072 sc1
    s_waitcnt lgkmcnt(0)
    buffer_store_dwordx4 v[160:163], v195, s[8:11], s35 offen sc1
wfs_18:
    s_mov_b64 exec, 1
    ds_add_u32 v242, v243 offset:0
    s_mov_b64 exec, -1
p1c_3:
    v_lshlrev_b32 v12, 4, v16
    v_lshlrev_b32 v13, 3, v19
    v_and_b32 v20, 0x13, v16
    v_and_b32 v21, 4, v16
    v_lshl_add_u32 v20, v21, 1, v20
    v_and_b32 v21, 8, v16
    v_lshrrev_b32 v21, 1, v21
    v_add_u32 v14, v20, v21
    v_lshlrev_b32 v20, 10, v19
    v_bfe_u32 v21, v1, 2, 2
    v_lshl_add_u32 v20, v21, 6, v20
    v_bfe_u32 v21, v1, 4, 1
    v_lshl_add_u32 v20, v21, 5, v20
    v_and_b32 v21, 1, v1
    v_lshl_add_u32 v20, v21, 4, v20
    v_bfe_u32 v21, v1, 1, 1
    v_lshl_add_u32 v4, v21, 3, v20
    v_add_u32 v5, 32768, v4
    v_add_u32 v6, 73728, v4
    v_add_u32 v7, 106496, v4
    v_lshrrev_b32 v20, 4, v16
    v_mul_u32_u24 v20, 92160, v20
    v_and_b32 v21, 15, v16
    v_lshl_add_u32 v20, v21, 4, v20
    v_lshl_add_u32 v8, v19, 8, v20
    s_mul_i32 s32, s24, 184320
    s_add_u32 s32, s32, 3670016
    v_mov_b32 v9, 0xbdd2d3e8
    v_mov_b32 v10, 0
    v_mov_b32 v11, 0
    v_mov_b32 v15, 0
    v_mov_b32 v240, 0
    s_cmp_ge_u32 s21, 20
    s_cselect_b32 s31, 1, 0
    s_cmp_eq_u32 s23, 0
    s_cselect_b32 s31, s31, 0
    s_lshr_b32 s6, s21, 3
    s_cmp_eq_u32 s6, 1
    s_cselect_b32 s6, 1, 0
    s_lshl_b32 s26, s24, 11
    s_add_u32 s26, s26, 2359296
    v_and_b32 v247, 15, v1
    v_lshlrev_b32 v247, 7, v247
    buffer_load_dwordx2 v[250:251], v247, s[8:11], s26 offen sc1
p1poll_19:
    s_waitcnt vmcnt(0)
    v_cmp_ne_u64 vcc, s[100:101], v[250:251]
    s_cbranch_vccz p1go_20
    s_sleep 4
    s_lshl_b32 s26, s24, 11
    s_add_u32 s26, s26, 2359296
    v_and_b32 v247, 15, v1
    v_lshlrev_b32 v247, 7, v247
    buffer_load_dwordx2 v[250:251], v247, s[8:11], s26 offen sc1
    s_sub_u32 s39, s39, 1
    s_cmp_gt_i32 s39, 0
    s_cbranch_scc1 p1poll_19
    s_waitcnt vmcnt(0)
p1go_20:
    buffer_load_dwordx4 v[96:99], v245, s[8:11], s37 offen offset:0 sc1
    buffer_load_dwordx4 v[100:103], v245, s[8:11], s37 offen offset:1024 sc1
    buffer_load_dwordx4 v[104:107], v245, s[8:11], s37 offen offset:2048 sc1
    buffer_load_dwordx4 v[108:111], v245, s[8:11], s37 offen offset:3072 sc1
    s_add_u32 s37, s37, 4096
    buffer_load_dwordx4 v[112:115], v245, s[8:11], s37 offen offset:0 sc1
    buffer_load_dwordx4 v[116:119], v245, s[8:11], s37 offen offset:1024 sc1
    buffer_load_dwordx4 v[120:123], v245, s[8:11], s37 offen offset:2048 sc1
    buffer_load_dwordx4 v[124:127], v245, s[8:11], s37 offen offset:3072 sc1
    s_add_u32 s37, s37, 4096
    buffer_load_dwordx4 v[128:131], v245, s[8:11], s37 offen offset:0 sc1
    buffer_load_dwordx4 v[132:135], v245, s[8:11], s37 offen offset:1024 sc1
    buffer_load_dwordx4 v[136:139], v245, s[8:11], s37 offen offset:2048 sc1
    buffer_load_dwordx4 v[140:143], v245, s[8:11], s37 offen offset:3072 sc1
    s_add_u32 s37, s37, 4096
p1fw_21:
    ds_read_b32 v244, v242 offset:0
    s_waitcnt lgkmcnt(0)
    v_readfirstlane_b32 s25, v244
    s_cmp_ge_u32 s25, 4
    s_cbranch_scc1 p1fd_22
    s_sleep 1
    s_sub_u32 s38, s38, 1
    s_cmp_gt_i32 s38, 0
    s_cbranch_scc1 p1fw_21
p1fd_22:
    s_setprio 1
    ds_read_b64_tr_b16 v[48:49], v4 offset:0
    ds_read_b64_tr_b16 v[50:51], v4 offset:256
    ds_read_b64_tr_b16 v[52:53], v4 offset:2048
    ds_read_b64_tr_b16 v[54:55], v4 offset:2304
    ds_read_b64_tr_b16 v[56:57], v4 offset:4096
    ds_read_b64_tr_b16 v[58:59], v4 offset:4352
    ds_read_b64_tr_b16 v[60:61], v4 offset:6144
    ds_read_b64_tr_b16 v[62:63], v4 offset:6400
    buffer_load_dwordx4 v[144:147], v245, s[8:11], s37 offen offset:0 sc1
    buffer_load_dwordx4 v[148:151], v245, s[8:11], s37 offen offset:1024 sc1
    s_waitcnt vmcnt(13) lgkmcnt(6)
    v_mfma_f32_32x32x16_bf16 v[32:47], v[48:51], v[96:99], 0
    ds_read_b64_tr_b16 v[48:49], v4 offset:8192
    ds_read_b64_tr_b16 v[50:51], v4 offset:8448
    buffer_load_dwordx4 v[152:155], v245, s[8:11], s37 offen offset:2048 sc1
    buffer_load_dwordx4 v[156:159], v245, s[8:11], s37 offen offset:3072 sc1
    s_add_u32 s37, s37, 4096
    s_waitcnt vmcnt(14) lgkmcnt(6)
    v_mfma_f32_32x32x16_bf16 v[32:47], v[52:55], v[100:103], v[32:47]
    ds_read_b64_tr_b16 v[52:53], v4 offset:10240
    ds_read_b64_tr_b16 v[54:55], v4 offset:10496
    buffer_load_dwordx4 v[160:163], v245, s[8:11], s37 offen offset:0 sc1
    buffer_load_dwordx4 v[164:167], v245, s[8:11], s37 offen offset:1024 sc1
    s_waitcnt vmcnt(15) lgkmcnt(6)
    v_mfma_f32_32x32x16_bf16 v[32:47], v[56:59], v[104:107], v[32:47]
    ds_read_b64_tr_b16 v[56:57], v4 offset:12288
    ds_read_b64_tr_b16 v[58:59], v4 offset:12544
    buffer_load_dwordx4 v[168:171], v245, s[8:11], s37 offen offset:2048 sc1
    buffer_load_dwordx4 v[172:175], v245, s[8:11], s37 offen offset:3072 sc1
    s_add_u32 s37, s37, 4096
    s_waitcnt vmcnt(16) lgkmcnt(6)
    v_mfma_f32_32x32x16_bf16 v[32:47], v[60:63], v[108:111], v[32:47]
    ds_read_b64_tr_b16 v[60:61], v4 offset:14336
    ds_read_b64_tr_b16 v[62:63], v4 offset:14592
    buffer_load_dwordx4 v[176:179], v245, s[8:11], s37 offen offset:0 sc1
    buffer_load_dwordx4 v[180:183], v245, s[8:11], s37 offen offset:1024 sc1
    s_waitcnt vmcnt(17) lgkmcnt(6)
    v_mfma_f32_32x32x16_bf16 v[32:47], v[48:51], v[112:115], v[32:47]
    ds_read_b64_tr_b16 v[48:49], v4 offset:16384
    ds_read_b64_tr_b16 v[50:51], v4 offset:16640
    buffer_load_dwordx4 v[184:187], v245, s[8:11], s37 offen offset:2048 sc1
    buffer_load_dwordx4 v[188:191], v245, s[8:11], s37 offen offset:3072 sc1
    s_add_u32 s37, s37, 4096
    s_waitcnt vmcnt(18) lgkmcnt(6)
    v_mfma_f32_32x32x16_bf16 v[32:47], v[52:55], v[116:119], v[32:47]
    ds_read_b64_tr_b16 v[52:53], v4 offset:18432
    ds_read_b64_tr_b16 v[54:55], v4 offset:18688
    buffer_load_dwordx4 v[192:195], v245, s[8:11], s37 offen offset:0 sc1
    buffer_load_dwordx4 v[196:199], v245, s[8:11], s37 offen offset:1024 sc1
    s_waitcnt vmcnt(19) lgkmcnt(6)
    v_mfma_f32_32x32x16_bf16 v[32:47], v[56:59], v[120:123], v[32:47]
    ds_read_b64_tr_b16 v[56:57], v4 offset:20480
    ds_read_b64_tr_b16 v[58:59], v4 offset:20736
    buffer_load_dwordx4 v[200:203], v245, s[8:11], s37 offen offset:2048 sc1
    buffer_load_dwordx4 v[204:207], v245, s[8:11], s37 offen offset:3072 sc1
    s_add_u32 s37, s37, 4096
    s_waitcnt vmcnt(20) lgkmcnt(6)
    v_mfma_f32_32x32x16_bf16 v[32:47], v[60:63], v[124:127], v[32:47]
    ds_read_b64_tr_b16 v[60:61], v4 offset:22528
    ds_read_b64_tr_b16 v[62:63], v4 offset:22784
    buffer_load_dwordx4 v[208:211], v245, s[8:11], s37 offen offset:0 sc1
    buffer_load_dwordx4 v[212:215], v245, s[8:11], s37 offen offset:1024 sc1
    s_waitcnt vmcnt(21) lgkmcnt(6)
    v_mfma_f32_32x32x16_bf16 v[32:47], v[48:51], v[128:131], v[32:47]
    ds_read_b64_tr_b16 v[48:49], v4 offset:24576
    ds_read_b64_tr_b16 v[50:51], v4 offset:24832
    buffer_load_dwordx4 v[216:219], v245, s[8:11], s37 offen offset:2048 sc1
    buffer_load_dwordx4 v[220:223], v245, s[8:11], s37 offen offset:3072 sc1
    s_add_u32 s37, s37, 4096
    s_waitcnt vmcnt(22) lgkmcnt(6)
    v_mfma_f32_32x32x16_bf16 v[32:47], v[52:55], v[132:135], v[32:47]
    ds_read_b64_tr_b16 v[52:53], v4 offset:26624
    ds_read_b64_tr_b16 v[54:55], v4 offset:26880
    buffer_load_dwordx4 v[224:227], v245, s[8:11], s37 offen offset:0 sc1
    buffer_load_dwordx4 v[228:231], v245, s[8:11], s37 offen offset:1024 sc1
    s_setprio 2
    s_waitcnt vmcnt(23) lgkmcnt(6)
    v_mfma_f32_32x32x16_bf16 v[32:47], v[56:59], v[136:139], v[32:47]
    ds_read_b64_tr_b16 v[56:57], v4 offset:28672
    ds_read_b64_tr_b16 v[58:59], v4 offset:28928
    buffer_load_dwordx4 v[232:235], v245, s[8:11], s37 offen offset:2048 sc1
    buffer_load_dwordx4 v[236:239], v245, s[8:11], s37 offen offset:3072 sc1
    s_add_u32 s37, s37, 4096
    s_waitcnt vmcnt(24) lgkmcnt(6)
    v_mfma_f32_32x32x16_bf16 v[32:47], v[60:63], v[140:143], v[32:47]
    ds_read_b64_tr_b16 v[60:61], v4 offset:30720
    ds_read_b64_tr_b16 v[62:63], v4 offset:30976
    s_waitcnt vmcnt(23) lgkmcnt(6)
    v_mfma_f32_32x32x16_bf16 v[32:47], v[48:51], v[144:147], v[32:47]
    ds_read_b64_tr_b16 v[48:49], v5 offset:0
    ds_read_b64_tr_b16 v[50:51], v5 offset:256
    s_waitcnt vmcnt(22) lgkmcnt(6)
    v_mfma_f32_32x32x16_bf16 v[32:47], v[52:55], v[148:151], v[32:47]
    ds_read_b64_tr_b16 v[52:53], v5 offset:2048
    ds_read_b64_tr_b16 v[54:55], v5 offset:2304
    s_waitcnt vmcnt(21) lgkmcnt(6)
    v_mfma_f32_32x32x16_bf16 v[32:47], v[56:59], v[152:155], v[32:47]
    ds_read_b64_tr_b16 v[56:57], v5 offset:4096
    ds_read_b64_tr_b16 v[58:59], v5 offset:4352
    s_waitcnt vmcnt(20) lgkmcnt(6)
    v_mfma_f32_32x32x16_bf16 v[32:47], v[60:63], v[156:159], v[32:47]
    ds_read_b64_tr_b16 v[60:61], v5 offset:6144
    ds_read_b64_tr_b16 v[62:63], v5 offset:6400
    s_waitcnt vmcnt(19) lgkmcnt(6)
    v_mfma_f32_32x32x16_bf16 v[32:47], v[48:51], v[160:163], v[32:47]
    ds_read_b64_tr_b16 v[48:49], v5 offset:8192
    ds_read_b64_tr_b16 v[50:51], v5 offset:8448
    s_waitcnt vmcnt(18) lgkmcnt(6)
    v_mfma_f32_32x32x16_bf16 v[32:47], v[52:55], v[164:167], v[32:47]
    ds_read_b64_tr_b16 v[52:53], v5 offset:10240
    ds_read_b64_tr_b16 v[54:55], v5 offset:10496
    s_waitcnt vmcnt(17) lgkmcnt(6)
    v_mfma_f32_32x32x16_bf16 v[32:47], v[56:59], v[168:171], v[32:47]
    ds_read_b64_tr_b16 v[56:57], v5 offset:12288
    ds_read_b64_tr_b16 v[58:59], v5 offset:12544
    s_waitcnt vmcnt(16) lgkmcnt(6)
    v_mfma_f32_32x32x16_bf16 v[32:47], v[60:63], v[172:175], v[32:47]
    ds_read_b64_tr_b16 v[60:61], v5 offset:14336
    ds_read_b64_tr_b16 v[62:63], v5 offset:14592
    s_setprio 3
    s_waitcnt vmcnt(15) lgkmcnt(6)
    v_mfma_f32_32x32x16_bf16 v[32:47], v[48:51], v[176:179], v[32:47]
    ds_read_b64_tr_b16 v[48:49], v5 offset:16384
    ds_read_b64_tr_b16 v[50:51], v5 offset:16640
    s_waitcnt vmcnt(14) lgkmcnt(6)
    v_mfma_f32_32x32x16_bf16 v[32:47], v[52:55], v[180:183], v[32:47]
    ds_read_b64_tr_b16 v[52:53], v5 offset:18432
    ds_read_b64_tr_b16 v[54:55], v5 offset:18688
    s_waitcnt vmcnt(13) lgkmcnt(6)
    v_mfma_f32_32x32x16_bf16 v[32:47], v[56:59], v[184:187], v[32:47]
    ds_read_b64_tr_b16 v[56:57], v5 offset:20480
    ds_read_b64_tr_b16 v[58:59], v5 offset:20736
    s_waitcnt vmcnt(12) lgkmcnt(6)
    v_mfma_f32_32x32x16_bf16 v[32:47], v[60:63], v[188:191], v[32:47]
    ds_read_b64_tr_b16 v[60:61], v5 offset:22528
    ds_read_b64_tr_b16 v[62:63], v5 offset:22784
    s_waitcnt vmcnt(11) lgkmcnt(6)
    v_mfma_f32_32x32x16_bf16 v[32:47], v[48:51], v[192:195], v[32:47]
    ds_read_b64_tr_b16 v[48:49], v5 offset:24576
    ds_read_b64_tr_b16 v[50:51], v5 offset:24832
    s_waitcnt vmcnt(10) lgkmcnt(6)
    v_mfma_f32_32x32x16_bf16 v[32:47], v[52:55], v[196:199], v[32:47]
    ds_read_b64_tr_b16 v[52:53], v5 offset:26624
    ds_read_b64_tr_b16 v[54:55], v5 offset:26880
    s_waitcnt vmcnt(9) lgkmcnt(6)
    v_mfma_f32_32x32x16_bf16 v[32:47], v[56:59], v[200:203], v[32:47]
    ds_read_b64_tr_b16 v[56:57], v5 offset:28672
    ds_read_b64_tr_b16 v[58:59], v5 offset:28928
    s_waitcnt vmcnt(8) lgkmcnt(6)
    v_mfma_f32_32x32x16_bf16 v[32:47], v[60:63], v[204:207], v[32:47]
    ds_read_b64_tr_b16 v[60:61], v5 offset:30720
    ds_read_b64_tr_b16 v[62:63], v5 offset:30976
    s_waitcnt vmcnt(7) lgkmcnt(6)
    v_mfma_f32_32x32x16_bf16 v[32:47], v[48:51], v[208:211], v[32:47]
    ds_read_b64_tr_b16 v[48:49], v5 offset:32768
    ds_read_b64_tr_b16 v[50:51], v5 offset:33024
    s_waitcnt vmcnt(6) lgkmcnt(6)
    v_mfma_f32_32x32x16_bf16 v[32:47], v[52:55], v[212:215], v[32:47]
    ds_read_b64_tr_b16 v[52:53], v5 offset:34816
    ds_read_b64_tr_b16 v[54:55], v5 offset:35072
    s_waitcnt vmcnt(5) lgkmcnt(6)
    v_mfma_f32_32x32x16_bf16 v[32:47], v[56:59], v[216:219], v[32:47]
    ds_read_b64_tr_b16 v[56:57], v5 offset:36864
    ds_read_b64_tr_b16 v[58:59], v5 offset:37120
    s_waitcnt vmcnt(4) lgkmcnt(6)
    v_mfma_f32_32x32x16_bf16 v[32:47], v[60:63], v[220:223], v[32:47]
    ds_read_b64_tr_b16 v[60:61], v5 offset:38912
    ds_read_b64_tr_b16 v[62:63], v5 offset:39168
    s_waitcnt vmcnt(3) lgkmcnt(6)
    v_mfma_f32_32x32x16_bf16 v[32:47], v[48:51], v[224:227], v[32:47]
    s_waitcnt vmcnt(2) lgkmcnt(4)
    v_mfma_f32_32x32x16_bf16 v[32:47], v[52:55], v[228:231], v[32:47]
    s_waitcnt vmcnt(1) lgkmcnt(2)
    v_mfma_f32_32x32x16_bf16 v[32:47], v[56:59], v[232:235], v[32:47]
    s_waitcnt vmcnt(0) lgkmcnt(0)
    v_mfma_f32_32x32x16_bf16 v[32:47], v[60:63], v[236:239], v[32:47]
    s_setprio 0
    s_nop 10
    s_add_u32 s27, s21, 4
    s_sub_u32 s28, s21, 4
    s_cmp_lt_u32 s21, 8
    s_cselect_b32 s27, s27, s28
    s_lshl_b32 s33, s27, 6
    s_lshl_b32 s27, s27, 7
    s_sub_u32 s28, s21, 8
    s_lshl_b32 s28, s28, 6
    s_lshr_b32 s26, s28, 1
    s_sub_u32 s26, s26, 32
    s_cmp_eq_u32 s6, 1
    s_cselect_b32 s27, s28, s27
    s_cselect_b32 s33, s26, s33
    s_mov_b32 s48, s12
    s_mov_b32 s49, s13
    s_mov_b32 s50, s14
    s_mov_b32 s51, s15
    v_mov_b32 v241, v2
    s_mov_b32 s30, 73728
    s_mul_i32 s25, s22, 9
    s_mul_i32 s29, s25, s30
    s_add_u32 s29, s29, s27
    s_lshl_b32 s25, s25, 10
    s_add_u32 m0, s25, 73728
    v_mul_u32_u24 v244, 1096, v13
    v_sub_u32 v244, 8704, v244
    v_mul_lo_u32 v244, v244, s6
    v_add_u32 v241, v241, v244
    buffer_load_dwordx4 v241, s[48:51], s29 offen lds
    s_add_u32 s29, s29, s30
    s_add_u32 m0, m0, 1024
    s_nop 0
    buffer_load_dwordx4 v241, s[48:51], s29 offen lds
    s_add_u32 s29, s29, s30
    s_add_u32 m0, m0, 1024
    s_nop 0
    buffer_load_dwordx4 v241, s[48:51], s29 offen lds
    s_add_u32 s29, s29, s30
    s_add_u32 m0, m0, 1024
    v_mul_f32 v16, v32, v32
    v_mul_f32 v17, v33, v33
    v_mul_f32 v18, v34, v34
    v_mul_f32 v19, v35, v35
    v_mul_f32 v20, v36, v36
    v_mul_f32 v21, v37, v37
    v_mul_f32 v22, v38, v38
    v_mul_f32 v23, v39, v39
    v_fmaak_f32 v16, v16, v9, 0xc0135761
    v_fmaak_f32 v17, v17, v9, 0xc0135761
    v_fmaak_f32 v18, v18, v9, 0xc0135761
    v_fmaak_f32 v19, v19, v9, 0xc0135761
    v_fmaak_f32 v20, v20, v9, 0xc0135761
    v_fmaak_f32 v21, v21, v9, 0xc0135761
    v_fmaak_f32 v22, v22, v9, 0xc0135761
    v_fmaak_f32 v23, v23, v9, 0xc0135761
    buffer_load_dwordx4 v241, s[48:51], s29 offen lds
    s_add_u32 s29, s29, s30
    s_add_u32 m0, m0, 1024
    s_nop 0
    buffer_load_dwordx4 v241, s[48:51], s29 offen lds
    s_add_u32 s29, s29, s30
    s_add_u32 m0, m0, 1024
    s_nop 0
    buffer_load_dwordx4 v241, s[48:51], s29 offen lds
    s_add_u32 s29, s29, s30
    s_add_u32 m0, m0, 1024
    v_mul_f32 v16, v16, v32
    v_mul_f32 v17, v17, v33
    v_mul_f32 v18, v18, v34
    v_mul_f32 v19, v19, v35
    v_mul_f32 v20, v20, v36
    v_mul_f32 v21, v21, v37
    v_mul_f32 v22, v22, v38
    v_mul_f32 v23, v23, v39
    v_exp_f32 v16, v16
    v_exp_f32 v17, v17
    v_exp_f32 v18, v18
    v_exp_f32 v19, v19
    v_exp_f32 v20, v20
    v_exp_f32 v21, v21
    v_exp_f32 v22, v22
    v_exp_f32 v23, v23
    buffer_load_dwordx4 v241, s[48:51], s29 offen lds
    s_add_u32 s29, s29, s30
    s_add_u32 m0, m0, 1024
    s_nop 0
    buffer_load_dwordx4 v241, s[48:51], s29 offen lds
    s_add_u32 s29, s29, s30
    s_add_u32 m0, m0, 1024
    s_nop 0
    buffer_load_dwordx4 v241, s[48:51], s29 offen lds
    s_add_u32 s29, s29, s30
    s_add_u32 m0, m0, 1024
    v_add_f32 v16, 1.0, v16
    v_add_f32 v17, 1.0, v17
    v_add_f32 v18, 1.0, v18
    v_add_f32 v19, 1.0, v19
    v_add_f32 v20, 1.0, v20
    v_add_f32 v21, 1.0, v21
    v_add_f32 v22, 1.0, v22
    v_add_f32 v23, 1.0, v23
    v_rcp_f32 v16, v16
    v_rcp_f32 v17, v17
    v_rcp_f32 v18, v18
    v_rcp_f32 v19, v19
    v_rcp_f32 v20, v20
    v_rcp_f32 v21, v21
    v_rcp_f32 v22, v22
    v_rcp_f32 v23, v23
    v_mul_f32 v32, v32, v16
    v_mul_f32 v33, v33, v17
    v_mul_f32 v34, v34, v18
    v_mul_f32 v35, v35, v19
    v_mul_f32 v36, v36, v20
    v_mul_f32 v37, v37, v21
    v_mul_f32 v38, v38, v22
    v_mul_f32 v39, v39, v23
    v_cvt_pk_bf16_f32 v64, v32, v33
    v_cvt_pk_bf16_f32 v65, v34, v35
    v_cvt_pk_bf16_f32 v66, v36, v37
    v_cvt_pk_bf16_f32 v67, v38, v39
    v_add_f32 v10, v10, v32
    v_fmac_f32 v11, v32, v32
    v_add_f32 v15, v15, v33
    v_fmac_f32 v240, v33, v33
    v_add_f32 v10, v10, v34
    v_fmac_f32 v11, v34, v34
    v_add_f32 v15, v15, v35
    v_fmac_f32 v240, v35, v35
    v_add_f32 v10, v10, v36
    v_fmac_f32 v11, v36, v36
    v_add_f32 v15, v15, v37
    v_fmac_f32 v240, v37, v37
    v_add_f32 v10, v10, v38
    v_fmac_f32 v11, v38, v38
    v_add_f32 v15, v15, v39
    v_fmac_f32 v240, v39, v39
    v_mul_f32 v16, v40, v40
    v_mul_f32 v17, v41, v41
    v_mul_f32 v18, v42, v42
    v_mul_f32 v19, v43, v43
    v_mul_f32 v20, v44, v44
    v_mul_f32 v21, v45, v45
    v_mul_f32 v22, v46, v46
    v_mul_f32 v23, v47, v47
    v_fmaak_f32 v16, v16, v9, 0xc0135761
    v_fmaak_f32 v17, v17, v9, 0xc0135761
    v_fmaak_f32 v18, v18, v9, 0xc0135761
    v_fmaak_f32 v19, v19, v9, 0xc0135761
    v_fmaak_f32 v20, v20, v9, 0xc0135761
    v_fmaak_f32 v21, v21, v9, 0xc0135761
    v_fmaak_f32 v22, v22, v9, 0xc0135761
    v_fmaak_f32 v23, v23, v9, 0xc0135761
    v_mul_f32 v16, v16, v40
    v_mul_f32 v17, v17, v41
    v_mul_f32 v18, v18, v42
    v_mul_f32 v19, v19, v43
    v_mul_f32 v20, v20, v44
    v_mul_f32 v21, v21, v45
    v_mul_f32 v22, v22, v46
    v_mul_f32 v23, v23, v47
    v_exp_f32 v16, v16
    v_exp_f32 v17, v17
    v_exp_f32 v18, v18
    v_exp_f32 v19, v19
    v_exp_f32 v20, v20
    v_exp_f32 v21, v21
    v_exp_f32 v22, v22
    v_exp_f32 v23, v23
    v_add_f32 v16, 1.0, v16
    v_add_f32 v17, 1.0, v17
    v_add_f32 v18, 1.0, v18
    v_add_f32 v19, 1.0, v19
    v_add_f32 v20, 1.0, v20
    v_add_f32 v21, 1.0, v21
    v_add_f32 v22, 1.0, v22
    v_add_f32 v23, 1.0, v23
    v_rcp_f32 v16, v16
    v_rcp_f32 v17, v17
    v_rcp_f32 v18, v18
    v_rcp_f32 v19, v19
    v_rcp_f32 v20, v20
    v_rcp_f32 v21, v21
    v_rcp_f32 v22, v22
    v_rcp_f32 v23, v23
    v_mul_f32 v40, v40, v16
    v_mul_f32 v41, v41, v17
    v_mul_f32 v42, v42, v18
    v_mul_f32 v43, v43, v19
    v_mul_f32 v44, v44, v20
    v_mul_f32 v45, v45, v21
    v_mul_f32 v46, v46, v22
    v_mul_f32 v47, v47, v23
    v_cvt_pk_bf16_f32 v68, v40, v41
    v_cvt_pk_bf16_f32 v69, v42, v43
    v_cvt_pk_bf16_f32 v70, v44, v45
    v_cvt_pk_bf16_f32 v71, v46, v47
    v_add_f32 v10, v10, v40
    v_fmac_f32 v11, v40, v40
    v_add_f32 v15, v15, v41
    v_fmac_f32 v240, v41, v41
    v_add_f32 v10, v10, v42
    v_fmac_f32 v11, v42, v42
    v_add_f32 v15, v15, v43
    v_fmac_f32 v240, v43, v43
    v_add_f32 v10, v10, v44
    v_fmac_f32 v11, v44, v44
    v_add_f32 v15, v15, v45
    v_fmac_f32 v240, v45, v45
    v_add_f32 v10, v10, v46
    v_fmac_f32 v11, v46, v46
    v_add_f32 v15, v15, v47
    v_fmac_f32 v240, v47, v47
    s_setprio 1
    ds_read_b64_tr_b16 v[48:49], v4 offset:512
    ds_read_b64_tr_b16 v[50:51], v4 offset:768
    ds_read_b64_tr_b16 v[52:53], v4 offset:2560
    ds_read_b64_tr_b16 v[54:55], v4 offset:2816
    ds_read_b64_tr_b16 v[56:57], v4 offset:4608
    ds_read_b64_tr_b16 v[58:59], v4 offset:4864
    ds_read_b64_tr_b16 v[60:61], v4 offset:6656
    ds_read_b64_tr_b16 v[62:63], v4 offset:6912
    s_waitcnt lgkmcnt(6)
    v_mfma_f32_32x32x16_bf16 v[32:47], v[48:51], v[96:99], 0
    ds_read_b64_tr_b16 v[48:49], v4 offset:8704
    ds_read_b64_tr_b16 v[50:51], v4 offset:8960
    s_waitcnt lgkmcnt(6)
    v_mfma_f32_32x32x16_bf16 v[32:47], v[52:55], v[100:103], v[32:47]
    ds_read_b64_tr_b16 v[52:53], v4 offset:10752
    ds_read_b64_tr_b16 v[54:55], v4 offset:11008
    s_waitcnt lgkmcnt(6)
    v_mfma_f32_32x32x16_bf16 v[32:47], v[56:59], v[104:107], v[32:47]
    ds_read_b64_tr_b16 v[56:57], v4 offset:12800
    ds_read_b64_tr_b16 v[58:59], v4 offset:13056
    s_waitcnt lgkmcnt(6)
    v_mfma_f32_32x32x16_bf16 v[32:47], v[60:63], v[108:111], v[32:47]
    ds_read_b64_tr_b16 v[60:61], v4 offset:14848
    ds_read_b64_tr_b16 v[62:63], v4 offset:15104
    s_waitcnt lgkmcnt(6)
    v_mfma_f32_32x32x16_bf16 v[32:47], v[48:51], v[112:115], v[32:47]
    ds_read_b64_tr_b16 v[48:49], v4 offset:16896
    ds_read_b64_tr_b16 v[50:51], v4 offset:17152
    s_waitcnt lgkmcnt(6)
    v_mfma_f32_32x32x16_bf16 v[32:47], v[52:55], v[116:119], v[32:47]
    ds_read_b64_tr_b16 v[52:53], v4 offset:18944
    ds_read_b64_tr_b16 v[54:55], v4 offset:19200
    s_waitcnt lgkmcnt(6)
    v_mfma_f32_32x32x16_bf16 v[32:47], v[56:59], v[120:123], v[32:47]
    ds_read_b64_tr_b16 v[56:57], v4 offset:20992
    ds_read_b64_tr_b16 v[58:59], v4 offset:21248
    s_waitcnt lgkmcnt(6)
    v_mfma_f32_32x32x16_bf16 v[32:47], v[60:63], v[124:127], v[32:47]
    ds_read_b64_tr_b16 v[60:61], v4 offset:23040
    ds_read_b64_tr_b16 v[62:63], v4 offset:23296
    s_waitcnt lgkmcnt(6)
    v_mfma_f32_32x32x16_bf16 v[32:47], v[48:51], v[128:131], v[32:47]
    ds_read_b64_tr_b16 v[48:49], v4 offset:25088
    ds_read_b64_tr_b16 v[50:51], v4 offset:25344
    s_waitcnt lgkmcnt(6)
    v_mfma_f32_32x32x16_bf16 v[32:47], v[52:55], v[132:135], v[32:47]
    ds_read_b64_tr_b16 v[52:53], v4 offset:27136
    ds_read_b64_tr_b16 v[54:55], v4 offset:27392
    s_setprio 2
    s_waitcnt lgkmcnt(6)
    v_mfma_f32_32x32x16_bf16 v[32:47], v[56:59], v[136:139], v[32:47]
    ds_read_b64_tr_b16 v[56:57], v4 offset:29184
    ds_read_b64_tr_b16 v[58:59], v4 offset:29440
    s_waitcnt lgkmcnt(6)
    v_mfma_f32_32x32x16_bf16 v[32:47], v[60:63], v[140:143], v[32:47]
    ds_read_b64_tr_b16 v[60:61], v4 offset:31232
    ds_read_b64_tr_b16 v[62:63], v4 offset:31488
    s_waitcnt lgkmcnt(6)
    v_mfma_f32_32x32x16_bf16 v[32:47], v[48:51], v[144:147], v[32:47]
    ds_read_b64_tr_b16 v[48:49], v5 offset:512
    ds_read_b64_tr_b16 v[50:51], v5 offset:768
    s_waitcnt lgkmcnt(6)
    v_mfma_f32_32x32x16_bf16 v[32:47], v[52:55], v[148:151], v[32:47]
    ds_read_b64_tr_b16 v[52:53], v5 offset:2560
    ds_read_b64_tr_b16 v[54:55], v5 offset:2816
    s_waitcnt lgkmcnt(6)
    v_mfma_f32_32x32x16_bf16 v[32:47], v[56:59], v[152:155], v[32:47]
    ds_read_b64_tr_b16 v[56:57], v5 offset:4608
    ds_read_b64_tr_b16 v[58:59], v5 offset:4864
    s_waitcnt lgkmcnt(6)
    v_mfma_f32_32x32x16_bf16 v[32:47], v[60:63], v[156:159], v[32:47]
    ds_read_b64_tr_b16 v[60:61], v5 offset:6656
    ds_read_b64_tr_b16 v[62:63], v5 offset:6912
    s_waitcnt lgkmcnt(6)
    v_mfma_f32_32x32x16_bf16 v[32:47], v[48:51], v[160:163], v[32:47]
    ds_read_b64_tr_b16 v[48:49], v5 offset:8704
    ds_read_b64_tr_b16 v[50:51], v5 offset:8960
    s_waitcnt lgkmcnt(6)
    v_mfma_f32_32x32x16_bf16 v[32:47], v[52:55], v[164:167], v[32:47]
    ds_read_b64_tr_b16 v[52:53], v5 offset:10752
    ds_read_b64_tr_b16 v[54:55], v5 offset:11008
    s_waitcnt lgkmcnt(6)
    v_mfma_f32_32x32x16_bf16 v[32:47], v[56:59], v[168:171], v[32:47]
    ds_read_b64_tr_b16 v[56:57], v5 offset:12800
    ds_read_b64_tr_b16 v[58:59], v5 offset:13056
    s_waitcnt lgkmcnt(6)
    v_mfma_f32_32x32x16_bf16 v[32:47], v[60:63], v[172:175], v[32:47]
    ds_read_b64_tr_b16 v[60:61], v5 offset:14848
    ds_read_b64_tr_b16 v[62:63], v5 offset:15104
    s_setprio 3
    s_waitcnt lgkmcnt(6)
    v_mfma_f32_32x32x16_bf16 v[32:47], v[48:51], v[176:179], v[32:47]
    ds_read_b64_tr_b16 v[48:49], v5 offset:16896
    ds_read_b64_tr_b16 v[50:51], v5 offset:17152
    s_nop 0
    s_waitcnt lgkmcnt(6)
    v_mfma_f32_32x32x16_bf16 v[32:47], v[52:55], v[180:183], v[32:47]
    ds_read_b64_tr_b16 v[52:53], v5 offset:18944
    ds_read_b64_tr_b16 v[54:55], v5 offset:19200
    s_waitcnt lgkmcnt(6)
    v_mfma_f32_32x32x16_bf16 v[32:47], v[56:59], v[184:187], v[32:47]
    ds_read_b64_tr_b16 v[56:57], v5 offset:20992
    ds_read_b64_tr_b16 v[58:59], v5 offset:21248
    s_waitcnt lgkmcnt(6)
    v_mfma_f32_32x32x16_bf16 v[32:47], v[60:63], v[188:191], v[32:47]
    ds_read_b64_tr_b16 v[60:61], v5 offset:23040
    ds_read_b64_tr_b16 v[62:63], v5 offset:23296
    s_waitcnt lgkmcnt(6)
    v_mfma_f32_32x32x16_bf16 v[32:47], v[48:51], v[192:195], v[32:47]
    ds_read_b64_tr_b16 v[48:49], v5 offset:25088
    ds_read_b64_tr_b16 v[50:51], v5 offset:25344
    s_waitcnt lgkmcnt(6)
    v_mfma_f32_32x32x16_bf16 v[32:47], v[52:55], v[196:199], v[32:47]
    ds_read_b64_tr_b16 v[52:53], v5 offset:27136
    ds_read_b64_tr_b16 v[54:55], v5 offset:27392
    s_waitcnt lgkmcnt(6)
    v_mfma_f32_32x32x16_bf16 v[32:47], v[56:59], v[200:203], v[32:47]
    ds_read_b64_tr_b16 v[56:57], v5 offset:29184
    ds_read_b64_tr_b16 v[58:59], v5 offset:29440
    s_waitcnt lgkmcnt(6)
    v_mfma_f32_32x32x16_bf16 v[32:47], v[60:63], v[204:207], v[32:47]
    ds_read_b64_tr_b16 v[60:61], v5 offset:31232
    ds_read_b64_tr_b16 v[62:63], v5 offset:31488
    s_waitcnt lgkmcnt(6)
    v_mfma_f32_32x32x16_bf16 v[32:47], v[48:51], v[208:211], v[32:47]
    ds_read_b64_tr_b16 v[48:49], v5 offset:33280
    ds_read_b64_tr_b16 v[50:51], v5 offset:33536
    s_waitcnt lgkmcnt(6)
    v_mfma_f32_32x32x16_bf16 v[32:47], v[52:55], v[212:215], v[32:47]
    ds_read_b64_tr_b16 v[52:53], v5 offset:35328
    ds_read_b64_tr_b16 v[54:55], v5 offset:35584
    s_waitcnt lgkmcnt(6)
    v_mfma_f32_32x32x16_bf16 v[32:47], v[56:59], v[216:219], v[32:47]
    ds_read_b64_tr_b16 v[56:57], v5 offset:37376
    ds_read_b64_tr_b16 v[58:59], v5 offset:37632
    s_waitcnt lgkmcnt(6)
    v_mfma_f32_32x32x16_bf16 v[32:47], v[60:63], v[220:223], v[32:47]
    ds_read_b64_tr_b16 v[60:61], v5 offset:39424
    ds_read_b64_tr_b16 v[62:63], v5 offset:39680
    s_waitcnt lgkmcnt(6)
    v_mfma_f32_32x32x16_bf16 v[32:47], v[48:51], v[224:227], v[32:47]
    s_waitcnt lgkmcnt(4)
    v_mfma_f32_32x32x16_bf16 v[32:47], v[52:55], v[228:231], v[32:47]
    s_waitcnt lgkmcnt(2)
    v_mfma_f32_32x32x16_bf16 v[32:47], v[56:59], v[232:235], v[32:47]
    s_waitcnt lgkmcnt(0)
    v_mfma_f32_32x32x16_bf16 v[32:47], v[60:63], v[236:239], v[32:47]
    s_setprio 0
    s_nop 10
    s_mov_b64 exec, 1
    ds_add_u32 v242, v243 offset:16
    s_mov_b64 exec, -1
    s_waitcnt vmcnt(0)
    s_mov_b64 exec, 1
    ds_add_u32 v242, v243 offset:4
    s_mov_b64 exec, -1
    v_mul_f32 v16, v32, v32
    v_mul_f32 v17, v33, v33
    v_mul_f32 v18, v34, v34
    v_mul_f32 v19, v35, v35
    v_mul_f32 v20, v36, v36
    v_mul_f32 v21, v37, v37
    v_mul_f32 v22, v38, v38
    v_mul_f32 v23, v39, v39
    v_fmaak_f32 v16, v16, v9, 0xc0135761
    v_fmaak_f32 v17, v17, v9, 0xc0135761
    v_fmaak_f32 v18, v18, v9, 0xc0135761
    v_fmaak_f32 v19, v19, v9, 0xc0135761
    v_fmaak_f32 v20, v20, v9, 0xc0135761
    v_fmaak_f32 v21, v21, v9, 0xc0135761
    v_fmaak_f32 v22, v22, v9, 0xc0135761
    v_fmaak_f32 v23, v23, v9, 0xc0135761
    v_mul_f32 v16, v16, v32
    v_mul_f32 v17, v17, v33
    v_mul_f32 v18, v18, v34
    v_mul_f32 v19, v19, v35
    v_mul_f32 v20, v20, v36
    v_mul_f32 v21, v21, v37
    v_mul_f32 v22, v22, v38
    v_mul_f32 v23, v23, v39
    v_exp_f32 v16, v16
    v_exp_f32 v17, v17
    v_exp_f32 v18, v18
    v_exp_f32 v19, v19
    v_exp_f32 v20, v20
    v_exp_f32 v21, v21
    v_exp_f32 v22, v22
    v_exp_f32 v23, v23
    v_add_f32 v16, 1.0, v16
    v_add_f32 v17, 1.0, v17
    v_add_f32 v18, 1.0, v18
    v_add_f32 v19, 1.0, v19
    v_add_f32 v20, 1.0, v20
    v_add_f32 v21, 1.0, v21
    v_add_f32 v22, 1.0, v22
    v_add_f32 v23, 1.0, v23
    v_rcp_f32 v16, v16
    v_rcp_f32 v17, v17
    v_rcp_f32 v18, v18
    v_rcp_f32 v19, v19
    v_rcp_f32 v20, v20
    v_rcp_f32 v21, v21
    v_rcp_f32 v22, v22
    v_rcp_f32 v23, v23
    v_mul_f32 v32, v32, v16
    v_mul_f32 v33, v33, v17
    v_mul_f32 v34, v34, v18
    v_mul_f32 v35, v35, v19
    v_mul_f32 v36, v36, v20
    v_mul_f32 v37, v37, v21
    v_mul_f32 v38, v38, v22
    v_mul_f32 v39, v39, v23
    v_cvt_pk_bf16_f32 v72, v32, v33
    v_cvt_pk_bf16_f32 v73, v34, v35
    v_cvt_pk_bf16_f32 v74, v36, v37
    v_cvt_pk_bf16_f32 v75, v38, v39
    v_add_f32 v10, v10, v32
    v_fmac_f32 v11, v32, v32
    v_add_f32 v15, v15, v33
    v_fmac_f32 v240, v33, v33
    v_add_f32 v10, v10, v34
    v_fmac_f32 v11, v34, v34
    v_add_f32 v15, v15, v35
    v_fmac_f32 v240, v35, v35
    v_add_f32 v10, v10, v36
    v_fmac_f32 v11, v36, v36
    v_add_f32 v15, v15, v37
    v_fmac_f32 v240, v37, v37
    v_add_f32 v10, v10, v38
    v_fmac_f32 v11, v38, v38
    v_add_f32 v15, v15, v39
    v_fmac_f32 v240, v39, v39
    v_mul_f32 v16, v40, v40
    v_mul_f32 v17, v41, v41
    v_mul_f32 v18, v42, v42
    v_mul_f32 v19, v43, v43
    v_mul_f32 v20, v44, v44
    v_mul_f32 v21, v45, v45
    v_mul_f32 v22, v46, v46
    v_mul_f32 v23, v47, v47
    v_fmaak_f32 v16, v16, v9, 0xc0135761
    v_fmaak_f32 v17, v17, v9, 0xc0135761
    v_fmaak_f32 v18, v18, v9, 0xc0135761
    v_fmaak_f32 v19, v19, v9, 0xc0135761
    v_fmaak_f32 v20, v20, v9, 0xc0135761
    v_fmaak_f32 v21, v21, v9, 0xc0135761
    v_fmaak_f32 v22, v22, v9, 0xc0135761
    v_fmaak_f32 v23, v23, v9, 0xc0135761
    v_mul_f32 v16, v16, v40
    v_mul_f32 v17, v17, v41
    v_mul_f32 v18, v18, v42
    v_mul_f32 v19, v19, v43
    v_mul_f32 v20, v20, v44
    v_mul_f32 v21, v21, v45
    v_mul_f32 v22, v22, v46
    v_mul_f32 v23, v23, v47
    v_exp_f32 v16, v16
    v_exp_f32 v17, v17
    v_exp_f32 v18, v18
    v_exp_f32 v19, v19
    v_exp_f32 v20, v20
    v_exp_f32 v21, v21
    v_exp_f32 v22, v22
    v_exp_f32 v23, v23
    v_add_f32 v16, 1.0, v16
    v_add_f32 v17, 1.0, v17
    v_add_f32 v18, 1.0, v18
    v_add_f32 v19, 1.0, v19
    v_add_f32 v20, 1.0, v20
    v_add_f32 v21, 1.0, v21
    v_add_f32 v22, 1.0, v22
    v_add_f32 v23, 1.0, v23
    v_rcp_f32 v16, v16
    v_rcp_f32 v17, v17
    v_rcp_f32 v18, v18
    v_rcp_f32 v19, v19
    v_rcp_f32 v20, v20
    v_rcp_f32 v21, v21
    v_rcp_f32 v22, v22
    v_rcp_f32 v23, v23
    v_mul_f32 v40, v40, v16
    v_mul_f32 v41, v41, v17
    v_mul_f32 v42, v42, v18
    v_mul_f32 v43, v43, v19
    v_mul_f32 v44, v44, v20
    v_mul_f32 v45, v45, v21
    v_mul_f32 v46, v46, v22
    v_mul_f32 v47, v47, v23
    v_cvt_pk_bf16_f32 v76, v40, v41
    v_cvt_pk_bf16_f32 v77, v42, v43
    v_cvt_pk_bf16_f32 v78, v44, v45
    v_cvt_pk_bf16_f32 v79, v46, v47
    v_add_f32 v10, v10, v40
    v_fmac_f32 v11, v40, v40
    v_add_f32 v15, v15, v41
    v_fmac_f32 v240, v41, v41
    v_add_f32 v10, v10, v42
    v_fmac_f32 v11, v42, v42
    v_add_f32 v15, v15, v43
    v_fmac_f32 v240, v43, v43
    v_add_f32 v10, v10, v44
    v_fmac_f32 v11, v44, v44
    v_add_f32 v15, v15, v45
    v_fmac_f32 v240, v45, v45
    v_add_f32 v10, v10, v46
    v_fmac_f32 v11, v46, v46
    v_add_f32 v15, v15, v47
    v_fmac_f32 v240, v47, v47
    s_cmp_eq_u32 s6, 1
    s_cbranch_scc1 p1z2_23
    v_add_f32 v10, v10, v15
    v_add_f32 v11, v11, v240
    s_nop 1
    v_permlane32_swap_b32 v10, v11
    v_lshlrev_b32 v16, 2, v1
    s_lshl_b32 s26, s24, 5
    s_add_u32 s26, s26, s21
    s_lshl_b32 s26, s26, 8
    s_add_u32 s26, s26, 2752512
    v_add_f32 v10, v10, v11
    buffer_store_dword v10, v16, s[8:11], s26 offen sc1
p1z2_23:
    s_add_u32 s27, s21, 28
    s_sub_u32 s28, s21, 8
    s_cmp_lt_u32 s21, 8
    s_cselect_b32 s27, s27, s28
    s_cselect_b32 s48, s12, s16
    s_cselect_b32 s49, s13, s17
    s_cselect_b32 s50, s14, s18
    s_mov_b32 s30, 27648
    s_cselect_b32 s30, 73728, s30
    s_cselect_b64 vcc, -1, 0
    v_cndmask_b32 v241, v3, v2, vcc
    s_lshl_b32 s27, s27, 7
    s_mul_i32 s25, s22, 9
    s_mul_i32 s29, s25, s30
    s_add_u32 s29, s29, s27
    s_lshl_b32 s25, s25, 10
    s_add_u32 m0, s25, 0
p1fw_24:
    ds_read_b32 v244, v242 offset:4
    s_waitcnt lgkmcnt(0)
    v_readfirstlane_b32 s25, v244
    s_cmp_ge_u32 s25, 8
    s_cbranch_scc1 p1fd_25
    s_sleep 1
    s_sub_u32 s38, s38, 1
    s_cmp_gt_i32 s38, 0
    s_cbranch_scc1 p1fw_24
p1fd_25:
    s_cmp_lg_u32 s23, 1
    s_cbranch_scc1 p1g_26
p1fw_27:
    ds_read_b32 v244, v242 offset:16
    s_waitcnt lgkmcnt(0)
    v_readfirstlane_b32 s25, v244
    s_cmp_ge_u32 s25, 8
    s_cbranch_scc1 p1fd_28
    s_sleep 1
    s_sub_u32 s38, s38, 1
    s_cmp_gt_i32 s38, 0
    s_cbranch_scc1 p1fw_27
p1fd_28:
p1g_26:
    s_mov_b64 vcc, s[54:55]
    s_cbranch_vccz p1n_29
    s_setprio 1
    ds_read_b64_tr_b16 v[48:49], v6 offset:0
    ds_read_b64_tr_b16 v[50:51], v6 offset:256
    ds_read_b64_tr_b16 v[52:53], v6 offset:2048
    ds_read_b64_tr_b16 v[54:55], v6 offset:2304
    ds_read_b64_tr_b16 v[56:57], v6 offset:4096
    ds_read_b64_tr_b16 v[58:59], v6 offset:4352
    ds_read_b64_tr_b16 v[60:61], v6 offset:6144
    ds_read_b64_tr_b16 v[62:63], v6 offset:6400
    buffer_load_dwordx4 v241, s[48:51], s29 offen lds
    s_add_u32 s29, s29, s30
    s_add_u32 m0, m0, 1024
    s_waitcnt lgkmcnt(6)
    v_mfma_f32_32x32x16_bf16 v[32:47], v[48:51], v[96:99], 0
    ds_read_b64_tr_b16 v[48:49], v6 offset:8192
    ds_read_b64_tr_b16 v[50:51], v6 offset:8448
    s_waitcnt lgkmcnt(6)
    v_mfma_f32_32x32x16_bf16 v[32:47], v[52:55], v[100:103], v[32:47]
    ds_read_b64_tr_b16 v[52:53], v6 offset:10240
    ds_read_b64_tr_b16 v[54:55], v6 offset:10496
    buffer_load_dwordx4 v241, s[48:51], s29 offen lds
    s_add_u32 s29, s29, s30
    s_add_u32 m0, m0, 1024
    s_waitcnt lgkmcnt(6)
    v_mfma_f32_32x32x16_bf16 v[32:47], v[56:59], v[104:107], v[32:47]
    ds_read_b64_tr_b16 v[56:57], v6 offset:12288
    ds_read_b64_tr_b16 v[58:59], v6 offset:12544
    s_waitcnt lgkmcnt(6)
    v_mfma_f32_32x32x16_bf16 v[32:47], v[60:63], v[108:111], v[32:47]
    ds_read_b64_tr_b16 v[60:61], v6 offset:14336
    ds_read_b64_tr_b16 v[62:63], v6 offset:14592
    buffer_load_dwordx4 v241, s[48:51], s29 offen lds
    s_add_u32 s29, s29, s30
    s_add_u32 m0, m0, 1024
    s_waitcnt lgkmcnt(6)
    v_mfma_f32_32x32x16_bf16 v[32:47], v[48:51], v[112:115], v[32:47]
    ds_read_b64_tr_b16 v[48:49], v6 offset:16384
    ds_read_b64_tr_b16 v[50:51], v6 offset:16640
    s_waitcnt lgkmcnt(6)
    v_mfma_f32_32x32x16_bf16 v[32:47], v[52:55], v[116:119], v[32:47]
    ds_read_b64_tr_b16 v[52:53], v6 offset:18432
    ds_read_b64_tr_b16 v[54:55], v6 offset:18688
    buffer_load_dwordx4 v241, s[48:51], s29 offen lds
    s_add_u32 s29, s29, s30
    s_add_u32 m0, m0, 1024
    s_waitcnt lgkmcnt(6)
    v_mfma_f32_32x32x16_bf16 v[32:47], v[56:59], v[120:123], v[32:47]
    ds_read_b64_tr_b16 v[56:57], v6 offset:20480
    ds_read_b64_tr_b16 v[58:59], v6 offset:20736
    s_waitcnt lgkmcnt(6)
    v_mfma_f32_32x32x16_bf16 v[32:47], v[60:63], v[124:127], v[32:47]
    ds_read_b64_tr_b16 v[60:61], v6 offset:22528
    ds_read_b64_tr_b16 v[62:63], v6 offset:22784
    buffer_load_dwordx4 v241, s[48:51], s29 offen lds
    s_add_u32 s29, s29, s30
    s_add_u32 m0, m0, 1024
    s_waitcnt lgkmcnt(6)
    v_mfma_f32_32x32x16_bf16 v[32:47], v[48:51], v[128:131], v[32:47]
    ds_read_b64_tr_b16 v[48:49], v6 offset:24576
    ds_read_b64_tr_b16 v[50:51], v6 offset:24832
    s_waitcnt lgkmcnt(6)
    v_mfma_f32_32x32x16_bf16 v[32:47], v[52:55], v[132:135], v[32:47]
    ds_read_b64_tr_b16 v[52:53], v6 offset:26624
    ds_read_b64_tr_b16 v[54:55], v6 offset:26880
    buffer_load_dwordx4 v241, s[48:51], s29 offen lds
    s_add_u32 s29, s29, s30
    s_add_u32 m0, m0, 1024
    s_setprio 2
    s_waitcnt lgkmcnt(6)
    v_mfma_f32_32x32x16_bf16 v[32:47], v[56:59], v[136:139], v[32:47]
    ds_read_b64_tr_b16 v[56:57], v6 offset:28672
    ds_read_b64_tr_b16 v[58:59], v6 offset:28928
    s_waitcnt lgkmcnt(6)
    v_mfma_f32_32x32x16_bf16 v[32:47], v[60:63], v[140:143], v[32:47]
    ds_read_b64_tr_b16 v[60:61], v6 offset:30720
    ds_read_b64_tr_b16 v[62:63], v6 offset:30976
    buffer_load_dwordx4 v241, s[48:51], s29 offen lds
    s_add_u32 s29, s29, s30
    s_add_u32 m0, m0, 1024
    s_waitcnt lgkmcnt(6)
    v_mfma_f32_32x32x16_bf16 v[32:47], v[48:51], v[144:147], v[32:47]
    ds_read_b64_tr_b16 v[48:49], v7 offset:0
    ds_read_b64_tr_b16 v[50:51], v7 offset:256
    s_waitcnt lgkmcnt(6)
    v_mfma_f32_32x32x16_bf16 v[32:47], v[52:55], v[148:151], v[32:47]
    ds_read_b64_tr_b16 v[52:53], v7 offset:2048
    ds_read_b64_tr_b16 v[54:55], v7 offset:2304
    buffer_load_dwordx4 v241, s[48:51], s29 offen lds
    s_add_u32 s29, s29, s30
    s_add_u32 m0, m0, 1024
    s_waitcnt lgkmcnt(6)
    v_mfma_f32_32x32x16_bf16 v[32:47], v[56:59], v[152:155], v[32:47]
    ds_read_b64_tr_b16 v[56:57], v7 offset:4096
    ds_read_b64_tr_b16 v[58:59], v7 offset:4352
    s_waitcnt lgkmcnt(6)
    v_mfma_f32_32x32x16_bf16 v[32:47], v[60:63], v[156:159], v[32:47]
    ds_read_b64_tr_b16 v[60:61], v7 offset:6144
    ds_read_b64_tr_b16 v[62:63], v7 offset:6400
    buffer_load_dwordx4 v241, s[48:51], s29 offen lds
    s_add_u32 s29, s29, s30
    s_add_u32 m0, m0, 1024
    s_waitcnt lgkmcnt(6)
    v_mfma_f32_32x32x16_bf16 v[32:47], v[48:51], v[160:163], v[32:47]
    ds_read_b64_tr_b16 v[48:49], v7 offset:8192
    ds_read_b64_tr_b16 v[50:51], v7 offset:8448
    s_waitcnt lgkmcnt(6)
    v_mfma_f32_32x32x16_bf16 v[32:47], v[52:55], v[164:167], v[32:47]
    ds_read_b64_tr_b16 v[52:53], v7 offset:10240
    ds_read_b64_tr_b16 v[54:55], v7 offset:10496
    s_waitcnt lgkmcnt(6)
    v_mfma_f32_32x32x16_bf16 v[32:47], v[56:59], v[168:171], v[32:47]
    ds_read_b64_tr_b16 v[56:57], v7 offset:12288
    ds_read_b64_tr_b16 v[58:59], v7 offset:12544
    s_cmp_eq_u32 s6, 0
    s_cbranch_scc0 p1s_31
    s_waitcnt vmcnt(9)
    s_lshl_b32 s26, s24, 5
    s_add_u32 s26, s26, s21
    s_lshl_b32 s26, s26, 7
    s_add_u32 s26, s26, 2490368
    v_lshrrev_b32 v247, 1, v245
    s_mov_b64 exec, 0xffff
    buffer_store_dwordx2 v[248:249], v247, s[8:11], s26 offen sc1
    s_mov_b64 exec, -1
p1s_31:
    s_waitcnt lgkmcnt(6)
    v_mfma_f32_32x32x16_bf16 v[32:47], v[60:63], v[172:175], v[32:47]
    ds_read_b64_tr_b16 v[60:61], v7 offset:14336
    ds_read_b64_tr_b16 v[62:63], v7 offset:14592
    s_setprio 3
    s_waitcnt lgkmcnt(6)
    v_mfma_f32_32x32x16_bf16 v[32:47], v[48:51], v[176:179], v[32:47]
    ds_read_b64_tr_b16 v[48:49], v7 offset:16384
    ds_read_b64_tr_b16 v[50:51], v7 offset:16640
    s_nop 0
    s_waitcnt lgkmcnt(6)
    v_mfma_f32_32x32x16_bf16 v[32:47], v[52:55], v[180:183], v[32:47]
    ds_read_b64_tr_b16 v[52:53], v7 offset:18432
    ds_read_b64_tr_b16 v[54:55], v7 offset:18688
    s_waitcnt lgkmcnt(6)
    v_mfma_f32_32x32x16_bf16 v[32:47], v[56:59], v[184:187], v[32:47]
    ds_read_b64_tr_b16 v[56:57], v7 offset:20480
    ds_read_b64_tr_b16 v[58:59], v7 offset:20736
    s_waitcnt lgkmcnt(6)
    v_mfma_f32_32x32x16_bf16 v[32:47], v[60:63], v[188:191], v[32:47]
    ds_read_b64_tr_b16 v[60:61], v7 offset:22528
    ds_read_b64_tr_b16 v[62:63], v7 offset:22784
    s_waitcnt lgkmcnt(6)
    v_mfma_f32_32x32x16_bf16 v[32:47], v[48:51], v[192:195], v[32:47]
    ds_read_b64_tr_b16 v[48:49], v7 offset:24576
    ds_read_b64_tr_b16 v[50:51], v7 offset:24832
    s_waitcnt lgkmcnt(6)
    v_mfma_f32_32x32x16_bf16 v[32:47], v[52:55], v[196:199], v[32:47]
    ds_read_b64_tr_b16 v[52:53], v7 offset:26624
    ds_read_b64_tr_b16 v[54:55], v7 offset:26880
    s_waitcnt lgkmcnt(6)
    v_mfma_f32_32x32x16_bf16 v[32:47], v[56:59], v[200:203], v[32:47]
    ds_read_b64_tr_b16 v[56:57], v7 offset:28672
    ds_read_b64_tr_b16 v[58:59], v7 offset:28928
    s_waitcnt lgkmcnt(6)
    v_mfma_f32_32x32x16_bf16 v[32:47], v[60:63], v[204:207], v[32:47]
    ds_read_b64_tr_b16 v[60:61], v7 offset:30720
    ds_read_b64_tr_b16 v[62:63], v7 offset:30976
    s_waitcnt lgkmcnt(6)
    v_mfma_f32_32x32x16_bf16 v[32:47], v[48:51], v[208:211], v[32:47]
    ds_read_b64_tr_b16 v[48:49], v7 offset:32768
    ds_read_b64_tr_b16 v[50:51], v7 offset:33024
    s_waitcnt lgkmcnt(6)
    v_mfma_f32_32x32x16_bf16 v[32:47], v[52:55], v[212:215], v[32:47]
    ds_read_b64_tr_b16 v[52:53], v7 offset:34816
    ds_read_b64_tr_b16 v[54:55], v7 offset:35072
    s_waitcnt lgkmcnt(6)
    v_mfma_f32_32x32x16_bf16 v[32:47], v[56:59], v[216:219], v[32:47]
    ds_read_b64_tr_b16 v[56:57], v7 offset:36864
    ds_read_b64_tr_b16 v[58:59], v7 offset:37120
    s_waitcnt lgkmcnt(6)
    v_mfma_f32_32x32x16_bf16 v[32:47], v[60:63], v[220:223], v[32:47]
    ds_read_b64_tr_b16 v[60:61], v7 offset:38912
    ds_read_b64_tr_b16 v[62:63], v7 offset:39168
    s_waitcnt lgkmcnt(6)
    v_mfma_f32_32x32x16_bf16 v[32:47], v[48:51], v[224:227], v[32:47]
    s_waitcnt lgkmcnt(4)
    v_mfma_f32_32x32x16_bf16 v[32:47], v[52:55], v[228:231], v[32:47]
    s_waitcnt lgkmcnt(2)
    v_mfma_f32_32x32x16_bf16 v[32:47], v[56:59], v[232:235], v[32:47]
    s_waitcnt lgkmcnt(0)
    v_mfma_f32_32x32x16_bf16 v[32:47], v[60:63], v[236:239], v[32:47]
    s_setprio 0
    s_nop 10
    s_branch p1e_30
p1n_29:
    s_setprio 1
    ds_read_b64_tr_b16 v[48:49], v6 offset:0
    ds_read_b64_tr_b16 v[50:51], v6 offset:256
    ds_read_b64_tr_b16 v[52:53], v6 offset:2048
    ds_read_b64_tr_b16 v[54:55], v6 offset:2304
    ds_read_b64_tr_b16 v[56:57], v6 offset:4096
    ds_read_b64_tr_b16 v[58:59], v6 offset:4352
    ds_read_b64_tr_b16 v[60:61], v6 offset:6144
    ds_read_b64_tr_b16 v[62:63], v6 offset:6400
    s_waitcnt lgkmcnt(6)
    v_mfma_f32_32x32x16_bf16 v[32:47], v[48:51], v[96:99], 0
    ds_read_b64_tr_b16 v[48:49], v6 offset:8192
    ds_read_b64_tr_b16 v[50:51], v6 offset:8448
    s_waitcnt lgkmcnt(6)
    v_mfma_f32_32x32x16_bf16 v[32:47], v[52:55], v[100:103], v[32:47]
    ds_read_b64_tr_b16 v[52:53], v6 offset:10240
    ds_read_b64_tr_b16 v[54:55], v6 offset:10496
    s_waitcnt lgkmcnt(6)
    v_mfma_f32_32x32x16_bf16 v[32:47], v[56:59], v[104:107], v[32:47]
    ds_read_b64_tr_b16 v[56:57], v6 offset:12288
    ds_read_b64_tr_b16 v[58:59], v6 offset:12544
    s_waitcnt lgkmcnt(6)
    v_mfma_f32_32x32x16_bf16 v[32:47], v[60:63], v[108:111], v[32:47]
    ds_read_b64_tr_b16 v[60:61], v6 offset:14336
    ds_read_b64_tr_b16 v[62:63], v6 offset:14592
    s_waitcnt lgkmcnt(6)
    v_mfma_f32_32x32x16_bf16 v[32:47], v[48:51], v[112:115], v[32:47]
    ds_read_b64_tr_b16 v[48:49], v6 offset:16384
    ds_read_b64_tr_b16 v[50:51], v6 offset:16640
    s_waitcnt lgkmcnt(6)
    v_mfma_f32_32x32x16_bf16 v[32:47], v[52:55], v[116:119], v[32:47]
    ds_read_b64_tr_b16 v[52:53], v6 offset:18432
    ds_read_b64_tr_b16 v[54:55], v6 offset:18688
    s_waitcnt lgkmcnt(6)
    v_mfma_f32_32x32x16_bf16 v[32:47], v[56:59], v[120:123], v[32:47]
    ds_read_b64_tr_b16 v[56:57], v6 offset:20480
    ds_read_b64_tr_b16 v[58:59], v6 offset:20736
    s_waitcnt lgkmcnt(6)
    v_mfma_f32_32x32x16_bf16 v[32:47], v[60:63], v[124:127], v[32:47]
    ds_read_b64_tr_b16 v[60:61], v6 offset:22528
    ds_read_b64_tr_b16 v[62:63], v6 offset:22784
    s_waitcnt lgkmcnt(6)
    v_mfma_f32_32x32x16_bf16 v[32:47], v[48:51], v[128:131], v[32:47]
    ds_read_b64_tr_b16 v[48:49], v6 offset:24576
    ds_read_b64_tr_b16 v[50:51], v6 offset:24832
    s_waitcnt lgkmcnt(6)
    v_mfma_f32_32x32x16_bf16 v[32:47], v[52:55], v[132:135], v[32:47]
    ds_read_b64_tr_b16 v[52:53], v6 offset:26624
    ds_read_b64_tr_b16 v[54:55], v6 offset:26880
    s_setprio 2
    s_waitcnt lgkmcnt(6)
    v_mfma_f32_32x32x16_bf16 v[32:47], v[56:59], v[136:139], v[32:47]
    ds_read_b64_tr_b16 v[56:57], v6 offset:28672
    ds_read_b64_tr_b16 v[58:59], v6 offset:28928
    s_waitcnt lgkmcnt(6)
    v_mfma_f32_32x32x16_bf16 v[32:47], v[60:63], v[140:143], v[32:47]
    ds_read_b64_tr_b16 v[60:61], v6 offset:30720
    ds_read_b64_tr_b16 v[62:63], v6 offset:30976
    s_waitcnt lgkmcnt(6)
    v_mfma_f32_32x32x16_bf16 v[32:47], v[48:51], v[144:147], v[32:47]
    ds_read_b64_tr_b16 v[48:49], v7 offset:0
    ds_read_b64_tr_b16 v[50:51], v7 offset:256
    s_waitcnt lgkmcnt(6)
    v_mfma_f32_32x32x16_bf16 v[32:47], v[52:55], v[148:151], v[32:47]
    ds_read_b64_tr_b16 v[52:53], v7 offset:2048
    ds_read_b64_tr_b16 v[54:55], v7 offset:2304
    s_waitcnt lgkmcnt(6)
    v_mfma_f32_32x32x16_bf16 v[32:47], v[56:59], v[152:155], v[32:47]
    ds_read_b64_tr_b16 v[56:57], v7 offset:4096
    ds_read_b64_tr_b16 v[58:59], v7 offset:4352
    s_waitcnt lgkmcnt(6)
    v_mfma_f32_32x32x16_bf16 v[32:47], v[60:63], v[156:159], v[32:47]
    ds_read_b64_tr_b16 v[60:61], v7 offset:6144
    ds_read_b64_tr_b16 v[62:63], v7 offset:6400
    s_waitcnt lgkmcnt(6)
    v_mfma_f32_32x32x16_bf16 v[32:47], v[48:51], v[160:163], v[32:47]
    ds_read_b64_tr_b16 v[48:49], v7 offset:8192
    ds_read_b64_tr_b16 v[50:51], v7 offset:8448
    s_waitcnt lgkmcnt(6)
    v_mfma_f32_32x32x16_bf16 v[32:47], v[52:55], v[164:167], v[32:47]
    ds_read_b64_tr_b16 v[52:53], v7 offset:10240
    ds_read_b64_tr_b16 v[54:55], v7 offset:10496
    s_waitcnt lgkmcnt(6)
    v_mfma_f32_32x32x16_bf16 v[32:47], v[56:59], v[168:171], v[32:47]
    ds_read_b64_tr_b16 v[56:57], v7 offset:12288
    ds_read_b64_tr_b16 v[58:59], v7 offset:12544
    s_cmp_eq_u32 s6, 0
    s_cbranch_scc0 p1s_32
    s_waitcnt vmcnt(0)
    s_lshl_b32 s26, s24, 5
    s_add_u32 s26, s26, s21
    s_lshl_b32 s26, s26, 7
    s_add_u32 s26, s26, 2490368
    v_lshrrev_b32 v247, 1, v245
    s_mov_b64 exec, 0xffff
    buffer_store_dwordx2 v[248:249], v247, s[8:11], s26 offen sc1
    s_mov_b64 exec, -1
p1s_32:
    s_waitcnt lgkmcnt(6)
    v_mfma_f32_32x32x16_bf16 v[32:47], v[60:63], v[172:175], v[32:47]
    ds_read_b64_tr_b16 v[60:61], v7 offset:14336
    ds_read_b64_tr_b16 v[62:63], v7 offset:14592
    s_setprio 3
    s_waitcnt lgkmcnt(6)
    v_mfma_f32_32x32x16_bf16 v[32:47], v[48:51], v[176:179], v[32:47]
    ds_read_b64_tr_b16 v[48:49], v7 offset:16384
    ds_read_b64_tr_b16 v[50:51], v7 offset:16640
    s_nop 0
    s_waitcnt lgkmcnt(6)
    v_mfma_f32_32x32x16_bf16 v[32:47], v[52:55], v[180:183], v[32:47]
    ds_read_b64_tr_b16 v[52:53], v7 offset:18432
    ds_read_b64_tr_b16 v[54:55], v7 offset:18688
    s_waitcnt lgkmcnt(6)
    v_mfma_f32_32x32x16_bf16 v[32:47], v[56:59], v[184:187], v[32:47]
    ds_read_b64_tr_b16 v[56:57], v7 offset:20480
    ds_read_b64_tr_b16 v[58:59], v7 offset:20736
    s_waitcnt lgkmcnt(6)
    v_mfma_f32_32x32x16_bf16 v[32:47], v[60:63], v[188:191], v[32:47]
    ds_read_b64_tr_b16 v[60:61], v7 offset:22528
    ds_read_b64_tr_b16 v[62:63], v7 offset:22784
    s_waitcnt lgkmcnt(6)
    v_mfma_f32_32x32x16_bf16 v[32:47], v[48:51], v[192:195], v[32:47]
    ds_read_b64_tr_b16 v[48:49], v7 offset:24576
    ds_read_b64_tr_b16 v[50:51], v7 offset:24832
    s_waitcnt lgkmcnt(6)
    v_mfma_f32_32x32x16_bf16 v[32:47], v[52:55], v[196:199], v[32:47]
    ds_read_b64_tr_b16 v[52:53], v7 offset:26624
    ds_read_b64_tr_b16 v[54:55], v7 offset:26880
    s_waitcnt lgkmcnt(6)
    v_mfma_f32_32x32x16_bf16 v[32:47], v[56:59], v[200:203], v[32:47]
    ds_read_b64_tr_b16 v[56:57], v7 offset:28672
    ds_read_b64_tr_b16 v[58:59], v7 offset:28928
    s_waitcnt lgkmcnt(6)
    v_mfma_f32_32x32x16_bf16 v[32:47], v[60:63], v[204:207], v[32:47]
    ds_read_b64_tr_b16 v[60:61], v7 offset:30720
    ds_read_b64_tr_b16 v[62:63], v7 offset:30976
    s_waitcnt lgkmcnt(6)
    v_mfma_f32_32x32x16_bf16 v[32:47], v[48:51], v[208:211], v[32:47]
    ds_read_b64_tr_b16 v[48:49], v7 offset:32768
    ds_read_b64_tr_b16 v[50:51], v7 offset:33024
    s_waitcnt lgkmcnt(6)
    v_mfma_f32_32x32x16_bf16 v[32:47], v[52:55], v[212:215], v[32:47]
    ds_read_b64_tr_b16 v[52:53], v7 offset:34816
    ds_read_b64_tr_b16 v[54:55], v7 offset:35072
    s_waitcnt lgkmcnt(6)
    v_mfma_f32_32x32x16_bf16 v[32:47], v[56:59], v[216:219], v[32:47]
    ds_read_b64_tr_b16 v[56:57], v7 offset:36864
    ds_read_b64_tr_b16 v[58:59], v7 offset:37120
    s_waitcnt lgkmcnt(6)
    v_mfma_f32_32x32x16_bf16 v[32:47], v[60:63], v[220:223], v[32:47]
    ds_read_b64_tr_b16 v[60:61], v7 offset:38912
    ds_read_b64_tr_b16 v[62:63], v7 offset:39168
    s_waitcnt lgkmcnt(6)
    v_mfma_f32_32x32x16_bf16 v[32:47], v[48:51], v[224:227], v[32:47]
    s_waitcnt lgkmcnt(4)
    v_mfma_f32_32x32x16_bf16 v[32:47], v[52:55], v[228:231], v[32:47]
    s_waitcnt lgkmcnt(2)
    v_mfma_f32_32x32x16_bf16 v[32:47], v[56:59], v[232:235], v[32:47]
    s_waitcnt lgkmcnt(0)
    v_mfma_f32_32x32x16_bf16 v[32:47], v[60:63], v[236:239], v[32:47]
    s_setprio 0
    s_nop 10
p1e_30:
    s_cmp_eq_u32 s6, 1
    s_cbranch_scc1 p1a_33
    v_mul_f32 v16, v32, v32
    v_mul_f32 v17, v33, v33
    v_mul_f32 v18, v34, v34
    v_mul_f32 v19, v35, v35
    v_mul_f32 v20, v36, v36
    v_mul_f32 v21, v37, v37
    v_mul_f32 v22, v38, v38
    v_mul_f32 v23, v39, v39
    v_fmaak_f32 v16, v16, v9, 0xc0135761
    v_fmaak_f32 v17, v17, v9, 0xc0135761
    v_fmaak_f32 v18, v18, v9, 0xc0135761
    v_fmaak_f32 v19, v19, v9, 0xc0135761
    v_fmaak_f32 v20, v20, v9, 0xc0135761
    v_fmaak_f32 v21, v21, v9, 0xc0135761
    v_fmaak_f32 v22, v22, v9, 0xc0135761
    v_fmaak_f32 v23, v23, v9, 0xc0135761
    v_mul_f32 v16, v16, v32
    v_mul_f32 v17, v17, v33
    v_mul_f32 v18, v18, v34
    v_mul_f32 v19, v19, v35
    v_mul_f32 v20, v20, v36
    v_mul_f32 v21, v21, v37
    v_mul_f32 v22, v22, v38
    v_mul_f32 v23, v23, v39
    v_exp_f32 v16, v16
    v_exp_f32 v17, v17
    v_exp_f32 v18, v18
    v_exp_f32 v19, v19
    v_exp_f32 v20, v20
    v_exp_f32 v21, v21
    v_exp_f32 v22, v22
    v_exp_f32 v23, v23
    v_add_f32 v16, 1.0, v16
    v_add_f32 v17, 1.0, v17
    v_add_f32 v18, 1.0, v18
    v_add_f32 v19, 1.0, v19
    v_add_f32 v20, 1.0, v20
    v_add_f32 v21, 1.0, v21
    v_add_f32 v22, 1.0, v22
    v_add_f32 v23, 1.0, v23
    v_rcp_f32 v16, v16
    v_rcp_f32 v17, v17
    v_rcp_f32 v18, v18
    v_rcp_f32 v19, v19
    v_rcp_f32 v20, v20
    v_rcp_f32 v21, v21
    v_rcp_f32 v22, v22
    v_rcp_f32 v23, v23
    v_mul_f32 v32, v32, v16
    v_mul_f32 v33, v33, v17
    v_mul_f32 v34, v34, v18
    v_mul_f32 v35, v35, v19
    v_mul_f32 v36, v36, v20
    v_mul_f32 v37, v37, v21
    v_mul_f32 v38, v38, v22
    v_mul_f32 v39, v39, v23
    v_cvt_pk_bf16_f32 v24, v32, v33
    v_cvt_pk_bf16_f32 v25, v34, v35
    v_cvt_pk_bf16_f32 v26, v36, v37
    v_cvt_pk_bf16_f32 v27, v38, v39
    v_mul_f32 v16, v40, v40
    v_mul_f32 v17, v41, v41
    v_mul_f32 v18, v42, v42
    v_mul_f32 v19, v43, v43
    v_mul_f32 v20, v44, v44
    v_mul_f32 v21, v45, v45
    v_mul_f32 v22, v46, v46
    v_mul_f32 v23, v47, v47
    v_fmaak_f32 v16, v16, v9, 0xc0135761
    v_fmaak_f32 v17, v17, v9, 0xc0135761
    v_fmaak_f32 v18, v18, v9, 0xc0135761
    v_fmaak_f32 v19, v19, v9, 0xc0135761
    v_fmaak_f32 v20, v20, v9, 0xc0135761
    v_fmaak_f32 v21, v21, v9, 0xc0135761
    v_fmaak_f32 v22, v22, v9, 0xc0135761
    v_fmaak_f32 v23, v23, v9, 0xc0135761
    v_mul_f32 v16, v16, v40
    v_mul_f32 v17, v17, v41
    v_mul_f32 v18, v18, v42
    v_mul_f32 v19, v19, v43
    v_mul_f32 v20, v20, v44
    v_mul_f32 v21, v21, v45
    v_mul_f32 v22, v22, v46
    v_mul_f32 v23, v23, v47
    v_exp_f32 v16, v16
    v_exp_f32 v17, v17
    v_exp_f32 v18, v18
    v_exp_f32 v19, v19
    v_exp_f32 v20, v20
    v_exp_f32 v21, v21
    v_exp_f32 v22, v22
    v_exp_f32 v23, v23
    v_add_f32 v16, 1.0, v16
    v_add_f32 v17, 1.0, v17
    v_add_f32 v18, 1.0, v18
    v_add_f32 v19, 1.0, v19
    v_add_f32 v20, 1.0, v20
    v_add_f32 v21, 1.0, v21
    v_add_f32 v22, 1.0, v22
    v_add_f32 v23, 1.0, v23
    v_rcp_f32 v16, v16
    v_rcp_f32 v17, v17
    v_rcp_f32 v18, v18
    v_rcp_f32 v19, v19
    v_rcp_f32 v20, v20
    v_rcp_f32 v21, v21
    v_rcp_f32 v22, v22
    v_rcp_f32 v23, v23
    v_mul_f32 v40, v40, v16
    v_mul_f32 v41, v41, v17
    v_mul_f32 v42, v42, v18
    v_mul_f32 v43, v43, v19
    v_mul_f32 v44, v44, v20
    v_mul_f32 v45, v45, v21
    v_mul_f32 v46, v46, v22
    v_mul_f32 v47, v47, v23
    v_cvt_pk_bf16_f32 v28, v40, v41
    v_cvt_pk_bf16_f32 v29, v42, v43
    v_cvt_pk_bf16_f32 v30, v44, v45
    v_cvt_pk_bf16_f32 v31, v46, v47
    s_cmp_lg_u32 s23, 1
    s_cbranch_scc1 p1g_35
    s_waitcnt vmcnt(0)
    s_mov_b64 exec, 1
    ds_add_u32 v242, v243 offset:8
    s_mov_b64 exec, -1
p1g_35:
    s_lshl_b32 s26, s33, 5
    s_add_u32 s26, s26, s32
    buffer_store_dwordx4 v[24:27], v8, s[8:11], s26 offen offset:0 sc1
    buffer_store_dwordx4 v[28:31], v8, s[8:11], s26 offen offset:512 sc1
    s_branch p1j_34
p1a_33:
    v_mul_f32 v16, v32, v32
    v_mul_f32 v17, v33, v33
    v_mul_f32 v18, v34, v34
    v_mul_f32 v19, v35, v35
    v_mul_f32 v20, v36, v36
    v_mul_f32 v21, v37, v37
    v_mul_f32 v22, v38, v38
    v_mul_f32 v23, v39, v39
    v_fmaak_f32 v16, v16, v9, 0xc0135761
    v_fmaak_f32 v17, v17, v9, 0xc0135761
    v_fmaak_f32 v18, v18, v9, 0xc0135761
    v_fmaak_f32 v19, v19, v9, 0xc0135761
    v_fmaak_f32 v20, v20, v9, 0xc0135761
    v_fmaak_f32 v21, v21, v9, 0xc0135761
    v_fmaak_f32 v22, v22, v9, 0xc0135761
    v_fmaak_f32 v23, v23, v9, 0xc0135761
    v_mul_f32 v16, v16, v32
    v_mul_f32 v17, v17, v33
    v_mul_f32 v18, v18, v34
    v_mul_f32 v19, v19, v35
    v_mul_f32 v20, v20, v36
    v_mul_f32 v21, v21, v37
    v_mul_f32 v22, v22, v38
    v_mul_f32 v23, v23, v39
    v_exp_f32 v16, v16
    v_exp_f32 v17, v17
    v_exp_f32 v18, v18
    v_exp_f32 v19, v19
    v_exp_f32 v20, v20
    v_exp_f32 v21, v21
    v_exp_f32 v22, v22
    v_exp_f32 v23, v23
    v_add_f32 v16, 1.0, v16
    v_add_f32 v17, 1.0, v17
    v_add_f32 v18, 1.0, v18
    v_add_f32 v19, 1.0, v19
    v_add_f32 v20, 1.0, v20
    v_add_f32 v21, 1.0, v21
    v_add_f32 v22, 1.0, v22
    v_add_f32 v23, 1.0, v23
    v_rcp_f32 v16, v16
    v_rcp_f32 v17, v17
    v_rcp_f32 v18, v18
    v_rcp_f32 v19, v19
    v_rcp_f32 v20, v20
    v_rcp_f32 v21, v21
    v_rcp_f32 v22, v22
    v_rcp_f32 v23, v23
    v_mul_f32 v32, v32, v16
    v_mul_f32 v33, v33, v17
    v_mul_f32 v34, v34, v18
    v_mul_f32 v35, v35, v19
    v_mul_f32 v36, v36, v20
    v_mul_f32 v37, v37, v21
    v_mul_f32 v38, v38, v22
    v_mul_f32 v39, v39, v23
    v_cvt_pk_bf16_f32 v80, v32, v33
    v_cvt_pk_bf16_f32 v81, v34, v35
    v_cvt_pk_bf16_f32 v82, v36, v37
    v_cvt_pk_bf16_f32 v83, v38, v39
    v_add_f32 v10, v10, v32
    v_fmac_f32 v11, v32, v32
    v_add_f32 v15, v15, v33
    v_fmac_f32 v240, v33, v33
    v_add_f32 v10, v10, v34
    v_fmac_f32 v11, v34, v34
    v_add_f32 v15, v15, v35
    v_fmac_f32 v240, v35, v35
    v_add_f32 v10, v10, v36
    v_fmac_f32 v11, v36, v36
    v_add_f32 v15, v15, v37
    v_fmac_f32 v240, v37, v37
    v_add_f32 v10, v10, v38
    v_fmac_f32 v11, v38, v38
    v_add_f32 v15, v15, v39
    v_fmac_f32 v240, v39, v39
    v_mul_f32 v16, v40, v40
    v_mul_f32 v17, v41, v41
    v_mul_f32 v18, v42, v42
    v_mul_f32 v19, v43, v43
    v_mul_f32 v20, v44, v44
    v_mul_f32 v21, v45, v45
    v_mul_f32 v22, v46, v46
    v_mul_f32 v23, v47, v47
    v_fmaak_f32 v16, v16, v9, 0xc0135761
    v_fmaak_f32 v17, v17, v9, 0xc0135761
    v_fmaak_f32 v18, v18, v9, 0xc0135761
    v_fmaak_f32 v19, v19, v9, 0xc0135761
    v_fmaak_f32 v20, v20, v9, 0xc0135761
    v_fmaak_f32 v21, v21, v9, 0xc0135761
    v_fmaak_f32 v22, v22, v9, 0xc0135761
    v_fmaak_f32 v23, v23, v9, 0xc0135761
    v_mul_f32 v16, v16, v40
    v_mul_f32 v17, v17, v41
    v_mul_f32 v18, v18, v42
    v_mul_f32 v19, v19, v43
    v_mul_f32 v20, v20, v44
    v_mul_f32 v21, v21, v45
    v_mul_f32 v22, v22, v46
    v_mul_f32 v23, v23, v47
    v_exp_f32 v16, v16
    v_exp_f32 v17, v17
    v_exp_f32 v18, v18
    v_exp_f32 v19, v19
    v_exp_f32 v20, v20
    v_exp_f32 v21, v21
    v_exp_f32 v22, v22
    v_exp_f32 v23, v23
    v_add_f32 v16, 1.0, v16
    v_add_f32 v17, 1.0, v17
    v_add_f32 v18, 1.0, v18
    v_add_f32 v19, 1.0, v19
    v_add_f32 v20, 1.0, v20
    v_add_f32 v21, 1.0, v21
    v_add_f32 v22, 1.0, v22
    v_add_f32 v23, 1.0, v23
    v_rcp_f32 v16, v16
    v_rcp_f32 v17, v17
    v_rcp_f32 v18, v18
    v_rcp_f32 v19, v19
    v_rcp_f32 v20, v20
    v_rcp_f32 v21, v21
    v_rcp_f32 v22, v22
    v_rcp_f32 v23, v23
    v_mul_f32 v40, v40, v16
    v_mul_f32 v41, v41, v17
    v_mul_f32 v42, v42, v18
    v_mul_f32 v43, v43, v19
    v_mul_f32 v44, v44, v20
    v_mul_f32 v45, v45, v21
    v_mul_f32 v46, v46, v22
    v_mul_f32 v47, v47, v23
    v_cvt_pk_bf16_f32 v84, v40, v41
    v_cvt_pk_bf16_f32 v85, v42, v43
    v_cvt_pk_bf16_f32 v86, v44, v45
    v_cvt_pk_bf16_f32 v87, v46, v47
    v_add_f32 v10, v10, v40
    v_fmac_f32 v11, v40, v40
    v_add_f32 v15, v15, v41
    v_fmac_f32 v240, v41, v41
    v_add_f32 v10, v10, v42
    v_fmac_f32 v11, v42, v42
    v_add_f32 v15, v15, v43
    v_fmac_f32 v240, v43, v43
    v_add_f32 v10, v10, v44
    v_fmac_f32 v11, v44, v44
    v_add_f32 v15, v15, v45
    v_fmac_f32 v240, v45, v45
    v_add_f32 v10, v10, v46
    v_fmac_f32 v11, v46, v46
    v_add_f32 v15, v15, v47
    v_fmac_f32 v240, v47, v47
    s_cmp_lg_u32 s23, 1
    s_cbranch_scc1 p1g_36
    s_waitcnt vmcnt(0)
    s_mov_b64 exec, 1
    ds_add_u32 v242, v243 offset:8
    s_mov_b64 exec, -1
p1g_36:
    v_add_f32 v10, v10, v15
    v_add_f32 v11, v11, v240
    s_nop 1
    v_permlane32_swap_b32 v10, v11
    v_lshlrev_b32 v16, 2, v1
    s_lshl_b32 s26, s24, 5
    s_add_u32 s26, s26, s21
    s_lshl_b32 s26, s26, 8
    s_add_u32 s26, s26, 2752512
    v_add_f32 v10, v10, v11
    buffer_store_dword v10, v16, s[8:11], s26 offen sc1
p1j_34:
    s_cmp_lg_u32 s23, 0
    s_cbranch_scc1 p1g_37
p1fw_38:
    ds_read_b32 v244, v242 offset:16
    s_waitcnt lgkmcnt(0)
    v_readfirstlane_b32 s25, v244
    s_cmp_ge_u32 s25, 8
    s_cbranch_scc1 p1fd_39
    s_sleep 1
    s_sub_u32 s38, s38, 1
    s_cmp_gt_i32 s38, 0
    s_cbranch_scc1 p1fw_38
p1fd_39:
p1g_37:
    s_mov_b64 vcc, s[52:53]
    s_cbranch_vccz p1n_40
    s_setprio 1
    ds_read_b64_tr_b16 v[48:49], v6 offset:512
    ds_read_b64_tr_b16 v[50:51], v6 offset:768
    ds_read_b64_tr_b16 v[52:53], v6 offset:2560
    ds_read_b64_tr_b16 v[54:55], v6 offset:2816
    ds_read_b64_tr_b16 v[56:57], v6 offset:4608
    ds_read_b64_tr_b16 v[58:59], v6 offset:4864
    ds_read_b64_tr_b16 v[60:61], v6 offset:6656
    ds_read_b64_tr_b16 v[62:63], v6 offset:6912
    buffer_load_dwordx4 v241, s[48:51], s29 offen lds
    s_add_u32 s29, s29, s30
    s_add_u32 m0, m0, 1024
    s_waitcnt lgkmcnt(6)
    v_mfma_f32_32x32x16_bf16 v[32:47], v[48:51], v[96:99], 0
    ds_read_b64_tr_b16 v[48:49], v6 offset:8704
    ds_read_b64_tr_b16 v[50:51], v6 offset:8960
    s_waitcnt lgkmcnt(6)
    v_mfma_f32_32x32x16_bf16 v[32:47], v[52:55], v[100:103], v[32:47]
    ds_read_b64_tr_b16 v[52:53], v6 offset:10752
    ds_read_b64_tr_b16 v[54:55], v6 offset:11008
    buffer_load_dwordx4 v241, s[48:51], s29 offen lds
    s_add_u32 s29, s29, s30
    s_add_u32 m0, m0, 1024
    s_waitcnt lgkmcnt(6)
    v_mfma_f32_32x32x16_bf16 v[32:47], v[56:59], v[104:107], v[32:47]
    ds_read_b64_tr_b16 v[56:57], v6 offset:12800
    ds_read_b64_tr_b16 v[58:59], v6 offset:13056
    s_waitcnt lgkmcnt(6)
    v_mfma_f32_32x32x16_bf16 v[32:47], v[60:63], v[108:111], v[32:47]
    ds_read_b64_tr_b16 v[60:61], v6 offset:14848
    ds_read_b64_tr_b16 v[62:63], v6 offset:15104
    buffer_load_dwordx4 v241, s[48:51], s29 offen lds
    s_add_u32 s29, s29, s30
    s_add_u32 m0, m0, 1024
    s_waitcnt lgkmcnt(6)
    v_mfma_f32_32x32x16_bf16 v[32:47], v[48:51], v[112:115], v[32:47]
    ds_read_b64_tr_b16 v[48:49], v6 offset:16896
    ds_read_b64_tr_b16 v[50:51], v6 offset:17152
    s_waitcnt lgkmcnt(6)
    v_mfma_f32_32x32x16_bf16 v[32:47], v[52:55], v[116:119], v[32:47]
    ds_read_b64_tr_b16 v[52:53], v6 offset:18944
    ds_read_b64_tr_b16 v[54:55], v6 offset:19200
    buffer_load_dwordx4 v241, s[48:51], s29 offen lds
    s_add_u32 s29, s29, s30
    s_add_u32 m0, m0, 1024
    s_waitcnt lgkmcnt(6)
    v_mfma_f32_32x32x16_bf16 v[32:47], v[56:59], v[120:123], v[32:47]
    ds_read_b64_tr_b16 v[56:57], v6 offset:20992
    ds_read_b64_tr_b16 v[58:59], v6 offset:21248
    s_waitcnt lgkmcnt(6)
    v_mfma_f32_32x32x16_bf16 v[32:47], v[60:63], v[124:127], v[32:47]
    ds_read_b64_tr_b16 v[60:61], v6 offset:23040
    ds_read_b64_tr_b16 v[62:63], v6 offset:23296
    buffer_load_dwordx4 v241, s[48:51], s29 offen lds
    s_add_u32 s29, s29, s30
    s_add_u32 m0, m0, 1024
    s_waitcnt lgkmcnt(6)
    v_mfma_f32_32x32x16_bf16 v[32:47], v[48:51], v[128:131], v[32:47]
    ds_read_b64_tr_b16 v[48:49], v6 offset:25088
    ds_read_b64_tr_b16 v[50:51], v6 offset:25344
    s_waitcnt lgkmcnt(6)
    v_mfma_f32_32x32x16_bf16 v[32:47], v[52:55], v[132:135], v[32:47]
    ds_read_b64_tr_b16 v[52:53], v6 offset:27136
    ds_read_b64_tr_b16 v[54:55], v6 offset:27392
    buffer_load_dwordx4 v241, s[48:51], s29 offen lds
    s_add_u32 s29, s29, s30
    s_add_u32 m0, m0, 1024
    s_setprio 2
    s_waitcnt lgkmcnt(6)
    v_mfma_f32_32x32x16_bf16 v[32:47], v[56:59], v[136:139], v[32:47]
    ds_read_b64_tr_b16 v[56:57], v6 offset:29184
    ds_read_b64_tr_b16 v[58:59], v6 offset:29440
    s_waitcnt lgkmcnt(6)
    v_mfma_f32_32x32x16_bf16 v[32:47], v[60:63], v[140:143], v[32:47]
    ds_read_b64_tr_b16 v[60:61], v6 offset:31232
    ds_read_b64_tr_b16 v[62:63], v6 offset:31488
    buffer_load_dwordx4 v241, s[48:51], s29 offen lds
    s_add_u32 s29, s29, s30
    s_add_u32 m0, m0, 1024
    s_waitcnt lgkmcnt(6)
    v_mfma_f32_32x32x16_bf16 v[32:47], v[48:51], v[144:147], v[32:47]
    ds_read_b64_tr_b16 v[48:49], v7 offset:512
    ds_read_b64_tr_b16 v[50:51], v7 offset:768
    s_waitcnt lgkmcnt(6)
    v_mfma_f32_32x32x16_bf16 v[32:47], v[52:55], v[148:151], v[32:47]
    ds_read_b64_tr_b16 v[52:53], v7 offset:2560
    ds_read_b64_tr_b16 v[54:55], v7 offset:2816
    buffer_load_dwordx4 v241, s[48:51], s29 offen lds
    s_add_u32 s29, s29, s30
    s_add_u32 m0, m0, 1024
    s_waitcnt lgkmcnt(6)
    v_mfma_f32_32x32x16_bf16 v[32:47], v[56:59], v[152:155], v[32:47]
    ds_read_b64_tr_b16 v[56:57], v7 offset:4608
    ds_read_b64_tr_b16 v[58:59], v7 offset:4864
    s_waitcnt lgkmcnt(6)
    v_mfma_f32_32x32x16_bf16 v[32:47], v[60:63], v[156:159], v[32:47]
    ds_read_b64_tr_b16 v[60:61], v7 offset:6656
    ds_read_b64_tr_b16 v[62:63], v7 offset:6912
    buffer_load_dwordx4 v241, s[48:51], s29 offen lds
    s_add_u32 s29, s29, s30
    s_add_u32 m0, m0, 1024
    s_waitcnt lgkmcnt(6)
    v_mfma_f32_32x32x16_bf16 v[32:47], v[48:51], v[160:163], v[32:47]
    ds_read_b64_tr_b16 v[48:49], v7 offset:8704
    ds_read_b64_tr_b16 v[50:51], v7 offset:8960
    s_waitcnt lgkmcnt(6)
    v_mfma_f32_32x32x16_bf16 v[32:47], v[52:55], v[164:167], v[32:47]
    ds_read_b64_tr_b16 v[52:53], v7 offset:10752
    ds_read_b64_tr_b16 v[54:55], v7 offset:11008
    s_waitcnt lgkmcnt(6)
    v_mfma_f32_32x32x16_bf16 v[32:47], v[56:59], v[168:171], v[32:47]
    ds_read_b64_tr_b16 v[56:57], v7 offset:12800
    ds_read_b64_tr_b16 v[58:59], v7 offset:13056
    s_cmp_eq_u32 s6, 1
    s_cbranch_scc0 p1s_42
    s_waitcnt vmcnt(9)
    s_lshl_b32 s26, s24, 5
    s_add_u32 s26, s26, s21
    s_lshl_b32 s26, s26, 7
    s_add_u32 s26, s26, 2490368
    v_lshrrev_b32 v247, 1, v245
    s_mov_b64 exec, 0xffff
    buffer_store_dwordx2 v[248:249], v247, s[8:11], s26 offen sc1
    s_mov_b64 exec, -1
p1s_42:
    s_waitcnt lgkmcnt(6)
    v_mfma_f32_32x32x16_bf16 v[32:47], v[60:63], v[172:175], v[32:47]
    ds_read_b64_tr_b16 v[60:61], v7 offset:14848
    ds_read_b64_tr_b16 v[62:63], v7 offset:15104
    s_setprio 3
    s_waitcnt lgkmcnt(6)
    v_mfma_f32_32x32x16_bf16 v[32:47], v[48:51], v[176:179], v[32:47]
    ds_read_b64_tr_b16 v[48:49], v7 offset:16896
    ds_read_b64_tr_b16 v[50:51], v7 offset:17152
    s_waitcnt lgkmcnt(6)
    v_mfma_f32_32x32x16_bf16 v[32:47], v[52:55], v[180:183], v[32:47]
    ds_read_b64_tr_b16 v[52:53], v7 offset:18944
    ds_read_b64_tr_b16 v[54:55], v7 offset:19200
    s_waitcnt lgkmcnt(6)
    v_mfma_f32_32x32x16_bf16 v[32:47], v[56:59], v[184:187], v[32:47]
    ds_read_b64_tr_b16 v[56:57], v7 offset:20992
    ds_read_b64_tr_b16 v[58:59], v7 offset:21248
    s_waitcnt lgkmcnt(6)
    v_mfma_f32_32x32x16_bf16 v[32:47], v[60:63], v[188:191], v[32:47]
    ds_read_b64_tr_b16 v[60:61], v7 offset:23040
    ds_read_b64_tr_b16 v[62:63], v7 offset:23296
    s_waitcnt lgkmcnt(6)
    v_mfma_f32_32x32x16_bf16 v[32:47], v[48:51], v[192:195], v[32:47]
    ds_read_b64_tr_b16 v[48:49], v7 offset:25088
    ds_read_b64_tr_b16 v[50:51], v7 offset:25344
    s_waitcnt lgkmcnt(6)
    v_mfma_f32_32x32x16_bf16 v[32:47], v[52:55], v[196:199], v[32:47]
    ds_read_b64_tr_b16 v[52:53], v7 offset:27136
    ds_read_b64_tr_b16 v[54:55], v7 offset:27392
    s_waitcnt lgkmcnt(6)
    v_mfma_f32_32x32x16_bf16 v[32:47], v[56:59], v[200:203], v[32:47]
    ds_read_b64_tr_b16 v[56:57], v7 offset:29184
    ds_read_b64_tr_b16 v[58:59], v7 offset:29440
    s_waitcnt lgkmcnt(6)
    v_mfma_f32_32x32x16_bf16 v[32:47], v[60:63], v[204:207], v[32:47]
    ds_read_b64_tr_b16 v[60:61], v7 offset:31232
    ds_read_b64_tr_b16 v[62:63], v7 offset:31488
    s_waitcnt lgkmcnt(6)
    v_mfma_f32_32x32x16_bf16 v[32:47], v[48:51], v[208:211], v[32:47]
    ds_read_b64_tr_b16 v[48:49], v7 offset:33280
    ds_read_b64_tr_b16 v[50:51], v7 offset:33536
    s_waitcnt lgkmcnt(6)
    v_mfma_f32_32x32x16_bf16 v[32:47], v[52:55], v[212:215], v[32:47]
    ds_read_b64_tr_b16 v[52:53], v7 offset:35328
    ds_read_b64_tr_b16 v[54:55], v7 offset:35584
    s_waitcnt lgkmcnt(6)
    v_mfma_f32_32x32x16_bf16 v[32:47], v[56:59], v[216:219], v[32:47]
    ds_read_b64_tr_b16 v[56:57], v7 offset:37376
    ds_read_b64_tr_b16 v[58:59], v7 offset:37632
    s_waitcnt lgkmcnt(6)
    v_mfma_f32_32x32x16_bf16 v[32:47], v[60:63], v[220:223], v[32:47]
    ds_read_b64_tr_b16 v[60:61], v7 offset:39424
    ds_read_b64_tr_b16 v[62:63], v7 offset:39680
    s_waitcnt lgkmcnt(6)
    v_mfma_f32_32x32x16_bf16 v[32:47], v[48:51], v[224:227], v[32:47]
    s_waitcnt lgkmcnt(4)
    v_mfma_f32_32x32x16_bf16 v[32:47], v[52:55], v[228:231], v[32:47]
    s_waitcnt lgkmcnt(2)
    v_mfma_f32_32x32x16_bf16 v[32:47], v[56:59], v[232:235], v[32:47]
    s_waitcnt lgkmcnt(0)
    v_mfma_f32_32x32x16_bf16 v[32:47], v[60:63], v[236:239], v[32:47]
    s_setprio 0
    s_nop 10
    s_branch p1e_41
p1n_40:
    s_setprio 1
    ds_read_b64_tr_b16 v[48:49], v6 offset:512
    ds_read_b64_tr_b16 v[50:51], v6 offset:768
    ds_read_b64_tr_b16 v[52:53], v6 offset:2560
    ds_read_b64_tr_b16 v[54:55], v6 offset:2816
    ds_read_b64_tr_b16 v[56:57], v6 offset:4608
    ds_read_b64_tr_b16 v[58:59], v6 offset:4864
    ds_read_b64_tr_b16 v[60:61], v6 offset:6656
    ds_read_b64_tr_b16 v[62:63], v6 offset:6912
    s_waitcnt lgkmcnt(6)
    v_mfma_f32_32x32x16_bf16 v[32:47], v[48:51], v[96:99], 0
    ds_read_b64_tr_b16 v[48:49], v6 offset:8704
    ds_read_b64_tr_b16 v[50:51], v6 offset:8960
    s_waitcnt lgkmcnt(6)
    v_mfma_f32_32x32x16_bf16 v[32:47], v[52:55], v[100:103], v[32:47]
    ds_read_b64_tr_b16 v[52:53], v6 offset:10752
    ds_read_b64_tr_b16 v[54:55], v6 offset:11008
    s_waitcnt lgkmcnt(6)
    v_mfma_f32_32x32x16_bf16 v[32:47], v[56:59], v[104:107], v[32:47]
    ds_read_b64_tr_b16 v[56:57], v6 offset:12800
    ds_read_b64_tr_b16 v[58:59], v6 offset:13056
    s_waitcnt lgkmcnt(6)
    v_mfma_f32_32x32x16_bf16 v[32:47], v[60:63], v[108:111], v[32:47]
    ds_read_b64_tr_b16 v[60:61], v6 offset:14848
    ds_read_b64_tr_b16 v[62:63], v6 offset:15104
    s_waitcnt lgkmcnt(6)
    v_mfma_f32_32x32x16_bf16 v[32:47], v[48:51], v[112:115], v[32:47]
    ds_read_b64_tr_b16 v[48:49], v6 offset:16896
    ds_read_b64_tr_b16 v[50:51], v6 offset:17152
    s_waitcnt lgkmcnt(6)
    v_mfma_f32_32x32x16_bf16 v[32:47], v[52:55], v[116:119], v[32:47]
    ds_read_b64_tr_b16 v[52:53], v6 offset:18944
    ds_read_b64_tr_b16 v[54:55], v6 offset:19200
    s_waitcnt lgkmcnt(6)
    v_mfma_f32_32x32x16_bf16 v[32:47], v[56:59], v[120:123], v[32:47]
    ds_read_b64_tr_b16 v[56:57], v6 offset:20992
    ds_read_b64_tr_b16 v[58:59], v6 offset:21248
    s_waitcnt lgkmcnt(6)
    v_mfma_f32_32x32x16_bf16 v[32:47], v[60:63], v[124:127], v[32:47]
    ds_read_b64_tr_b16 v[60:61], v6 offset:23040
    ds_read_b64_tr_b16 v[62:63], v6 offset:23296
    s_waitcnt lgkmcnt(6)
    v_mfma_f32_32x32x16_bf16 v[32:47], v[48:51], v[128:131], v[32:47]
    ds_read_b64_tr_b16 v[48:49], v6 offset:25088
    ds_read_b64_tr_b16 v[50:51], v6 offset:25344
    s_waitcnt lgkmcnt(6)
    v_mfma_f32_32x32x16_bf16 v[32:47], v[52:55], v[132:135], v[32:47]
    ds_read_b64_tr_b16 v[52:53], v6 offset:27136
    ds_read_b64_tr_b16 v[54:55], v6 offset:27392
    s_setprio 2
    s_waitcnt lgkmcnt(6)
    v_mfma_f32_32x32x16_bf16 v[32:47], v[56:59], v[136:139], v[32:47]
    ds_read_b64_tr_b16 v[56:57], v6 offset:29184
    ds_read_b64_tr_b16 v[58:59], v6 offset:29440
    s_waitcnt lgkmcnt(6)
    v_mfma_f32_32x32x16_bf16 v[32:47], v[60:63], v[140:143], v[32:47]
    ds_read_b64_tr_b16 v[60:61], v6 offset:31232
    ds_read_b64_tr_b16 v[62:63], v6 offset:31488
    s_waitcnt lgkmcnt(6)
    v_mfma_f32_32x32x16_bf16 v[32:47], v[48:51], v[144:147], v[32:47]
    ds_read_b64_tr_b16 v[48:49], v7 offset:512
    ds_read_b64_tr_b16 v[50:51], v7 offset:768
    s_waitcnt lgkmcnt(6)
    v_mfma_f32_32x32x16_bf16 v[32:47], v[52:55], v[148:151], v[32:47]
    ds_read_b64_tr_b16 v[52:53], v7 offset:2560
    ds_read_b64_tr_b16 v[54:55], v7 offset:2816
    s_waitcnt lgkmcnt(6)
    v_mfma_f32_32x32x16_bf16 v[32:47], v[56:59], v[152:155], v[32:47]
    ds_read_b64_tr_b16 v[56:57], v7 offset:4608
    ds_read_b64_tr_b16 v[58:59], v7 offset:4864
    s_waitcnt lgkmcnt(6)
    v_mfma_f32_32x32x16_bf16 v[32:47], v[60:63], v[156:159], v[32:47]
    ds_read_b64_tr_b16 v[60:61], v7 offset:6656
    ds_read_b64_tr_b16 v[62:63], v7 offset:6912
    s_waitcnt lgkmcnt(6)
    v_mfma_f32_32x32x16_bf16 v[32:47], v[48:51], v[160:163], v[32:47]
    ds_read_b64_tr_b16 v[48:49], v7 offset:8704
    ds_read_b64_tr_b16 v[50:51], v7 offset:8960
    s_waitcnt lgkmcnt(6)
    v_mfma_f32_32x32x16_bf16 v[32:47], v[52:55], v[164:167], v[32:47]
    ds_read_b64_tr_b16 v[52:53], v7 offset:10752
    ds_read_b64_tr_b16 v[54:55], v7 offset:11008
    s_waitcnt lgkmcnt(6)
    v_mfma_f32_32x32x16_bf16 v[32:47], v[56:59], v[168:171], v[32:47]
    ds_read_b64_tr_b16 v[56:57], v7 offset:12800
    ds_read_b64_tr_b16 v[58:59], v7 offset:13056
    s_cmp_eq_u32 s6, 1
    s_cbranch_scc0 p1s_43
    s_waitcnt vmcnt(0)
    s_lshl_b32 s26, s24, 5
    s_add_u32 s26, s26, s21
    s_lshl_b32 s26, s26, 7
    s_add_u32 s26, s26, 2490368
    v_lshrrev_b32 v247, 1, v245
    s_mov_b64 exec, 0xffff
    buffer_store_dwordx2 v[248:249], v247, s[8:11], s26 offen sc1
    s_mov_b64 exec, -1
p1s_43:
    s_waitcnt lgkmcnt(6)
    v_mfma_f32_32x32x16_bf16 v[32:47], v[60:63], v[172:175], v[32:47]
    ds_read_b64_tr_b16 v[60:61], v7 offset:14848
    ds_read_b64_tr_b16 v[62:63], v7 offset:15104
    s_setprio 3
    s_waitcnt lgkmcnt(6)
    v_mfma_f32_32x32x16_bf16 v[32:47], v[48:51], v[176:179], v[32:47]
    ds_read_b64_tr_b16 v[48:49], v7 offset:16896
    ds_read_b64_tr_b16 v[50:51], v7 offset:17152
    s_waitcnt lgkmcnt(6)
    v_mfma_f32_32x32x16_bf16 v[32:47], v[52:55], v[180:183], v[32:47]
    ds_read_b64_tr_b16 v[52:53], v7 offset:18944
    ds_read_b64_tr_b16 v[54:55], v7 offset:19200
    s_waitcnt lgkmcnt(6)
    v_mfma_f32_32x32x16_bf16 v[32:47], v[56:59], v[184:187], v[32:47]
    ds_read_b64_tr_b16 v[56:57], v7 offset:20992
    ds_read_b64_tr_b16 v[58:59], v7 offset:21248
    s_waitcnt lgkmcnt(6)
    v_mfma_f32_32x32x16_bf16 v[32:47], v[60:63], v[188:191], v[32:47]
    ds_read_b64_tr_b16 v[60:61], v7 offset:23040
    ds_read_b64_tr_b16 v[62:63], v7 offset:23296
    s_waitcnt lgkmcnt(6)
    v_mfma_f32_32x32x16_bf16 v[32:47], v[48:51], v[192:195], v[32:47]
    ds_read_b64_tr_b16 v[48:49], v7 offset:25088
    ds_read_b64_tr_b16 v[50:51], v7 offset:25344
    s_waitcnt lgkmcnt(6)
    v_mfma_f32_32x32x16_bf16 v[32:47], v[52:55], v[196:199], v[32:47]
    ds_read_b64_tr_b16 v[52:53], v7 offset:27136
    ds_read_b64_tr_b16 v[54:55], v7 offset:27392
    s_waitcnt lgkmcnt(6)
    v_mfma_f32_32x32x16_bf16 v[32:47], v[56:59], v[200:203], v[32:47]
    ds_read_b64_tr_b16 v[56:57], v7 offset:29184
    ds_read_b64_tr_b16 v[58:59], v7 offset:29440
    s_waitcnt lgkmcnt(6)
    v_mfma_f32_32x32x16_bf16 v[32:47], v[60:63], v[204:207], v[32:47]
    ds_read_b64_tr_b16 v[60:61], v7 offset:31232
    ds_read_b64_tr_b16 v[62:63], v7 offset:31488
    s_waitcnt lgkmcnt(6)
    v_mfma_f32_32x32x16_bf16 v[32:47], v[48:51], v[208:211], v[32:47]
    ds_read_b64_tr_b16 v[48:49], v7 offset:33280
    ds_read_b64_tr_b16 v[50:51], v7 offset:33536
    s_waitcnt lgkmcnt(6)
    v_mfma_f32_32x32x16_bf16 v[32:47], v[52:55], v[212:215], v[32:47]
    ds_read_b64_tr_b16 v[52:53], v7 offset:35328
    ds_read_b64_tr_b16 v[54:55], v7 offset:35584
    s_waitcnt lgkmcnt(6)
    v_mfma_f32_32x32x16_bf16 v[32:47], v[56:59], v[216:219], v[32:47]
    ds_read_b64_tr_b16 v[56:57], v7 offset:37376
    ds_read_b64_tr_b16 v[58:59], v7 offset:37632
    s_waitcnt lgkmcnt(6)
    v_mfma_f32_32x32x16_bf16 v[32:47], v[60:63], v[220:223], v[32:47]
    ds_read_b64_tr_b16 v[60:61], v7 offset:39424
    ds_read_b64_tr_b16 v[62:63], v7 offset:39680
    s_waitcnt lgkmcnt(6)
    v_mfma_f32_32x32x16_bf16 v[32:47], v[48:51], v[224:227], v[32:47]
    s_waitcnt lgkmcnt(4)
    v_mfma_f32_32x32x16_bf16 v[32:47], v[52:55], v[228:231], v[32:47]
    s_waitcnt lgkmcnt(2)
    v_mfma_f32_32x32x16_bf16 v[32:47], v[56:59], v[232:235], v[32:47]
    s_waitcnt lgkmcnt(0)
    v_mfma_f32_32x32x16_bf16 v[32:47], v[60:63], v[236:239], v[32:47]
    s_setprio 0
    s_nop 10
p1e_41:
    s_mov_b64 exec, 1
    ds_add_u32 v242, v243 offset:20
    s_mov_b64 exec, -1
    v_mul_f32 v16, v32, v32
    v_mul_f32 v17, v33, v33
    v_mul_f32 v18, v34, v34
    v_mul_f32 v19, v35, v35
    v_mul_f32 v20, v36, v36
    v_mul_f32 v21, v37, v37
    v_mul_f32 v22, v38, v38
    v_mul_f32 v23, v39, v39
    v_fmaak_f32 v16, v16, v9, 0xc0135761
    v_fmaak_f32 v17, v17, v9, 0xc0135761
    v_fmaak_f32 v18, v18, v9, 0xc0135761
    v_fmaak_f32 v19, v19, v9, 0xc0135761
    v_fmaak_f32 v20, v20, v9, 0xc0135761
    v_fmaak_f32 v21, v21, v9, 0xc0135761
    v_fmaak_f32 v22, v22, v9, 0xc0135761
    v_fmaak_f32 v23, v23, v9, 0xc0135761
    v_mul_f32 v16, v16, v32
    v_mul_f32 v17, v17, v33
    v_mul_f32 v18, v18, v34
    v_mul_f32 v19, v19, v35
    v_mul_f32 v20, v20, v36
    v_mul_f32 v21, v21, v37
    v_mul_f32 v22, v22, v38
    v_mul_f32 v23, v23, v39
    v_exp_f32 v16, v16
    v_exp_f32 v17, v17
    v_exp_f32 v18, v18
    v_exp_f32 v19, v19
    v_exp_f32 v20, v20
    v_exp_f32 v21, v21
    v_exp_f32 v22, v22
    v_exp_f32 v23, v23
    v_add_f32 v16, 1.0, v16
    v_add_f32 v17, 1.0, v17
    v_add_f32 v18, 1.0, v18
    v_add_f32 v19, 1.0, v19
    v_add_f32 v20, 1.0, v20
    v_add_f32 v21, 1.0, v21
    v_add_f32 v22, 1.0, v22
    v_add_f32 v23, 1.0, v23
    v_rcp_f32 v16, v16
    v_rcp_f32 v17, v17
    v_rcp_f32 v18, v18
    v_rcp_f32 v19, v19
    v_rcp_f32 v20, v20
    v_rcp_f32 v21, v21
    v_rcp_f32 v22, v22
    v_rcp_f32 v23, v23
    v_mul_f32 v32, v32, v16
    v_mul_f32 v33, v33, v17
    v_mul_f32 v34, v34, v18
    v_mul_f32 v35, v35, v19
    v_mul_f32 v36, v36, v20
    v_mul_f32 v37, v37, v21
    v_mul_f32 v38, v38, v22
    v_mul_f32 v39, v39, v23
    v_cvt_pk_bf16_f32 v24, v32, v33
    v_cvt_pk_bf16_f32 v25, v34, v35
    v_cvt_pk_bf16_f32 v26, v36, v37
    v_cvt_pk_bf16_f32 v27, v38, v39
    v_mul_f32 v16, v40, v40
    v_mul_f32 v17, v41, v41
    v_mul_f32 v18, v42, v42
    v_mul_f32 v19, v43, v43
    v_mul_f32 v20, v44, v44
    v_mul_f32 v21, v45, v45
    v_mul_f32 v22, v46, v46
    v_mul_f32 v23, v47, v47
    v_fmaak_f32 v16, v16, v9, 0xc0135761
    v_fmaak_f32 v17, v17, v9, 0xc0135761
    v_fmaak_f32 v18, v18, v9, 0xc0135761
    v_fmaak_f32 v19, v19, v9, 0xc0135761
    v_fmaak_f32 v20, v20, v9, 0xc0135761
    v_fmaak_f32 v21, v21, v9, 0xc0135761
    v_fmaak_f32 v22, v22, v9, 0xc0135761
    v_fmaak_f32 v23, v23, v9, 0xc0135761
    v_mul_f32 v16, v16, v40
    v_mul_f32 v17, v17, v41
    v_mul_f32 v18, v18, v42
    v_mul_f32 v19, v19, v43
    v_mul_f32 v20, v20, v44
    v_mul_f32 v21, v21, v45
    v_mul_f32 v22, v22, v46
    v_mul_f32 v23, v23, v47
    v_exp_f32 v16, v16
    v_exp_f32 v17, v17
    v_exp_f32 v18, v18
    v_exp_f32 v19, v19
    v_exp_f32 v20, v20
    v_exp_f32 v21, v21
    v_exp_f32 v22, v22
    v_exp_f32 v23, v23
    v_add_f32 v16, 1.0, v16
    v_add_f32 v17, 1.0, v17
    v_add_f32 v18, 1.0, v18
    v_add_f32 v19, 1.0, v19
    v_add_f32 v20, 1.0, v20
    v_add_f32 v21, 1.0, v21
    v_add_f32 v22, 1.0, v22
    v_add_f32 v23, 1.0, v23
    v_rcp_f32 v16, v16
    v_rcp_f32 v17, v17
    v_rcp_f32 v18, v18
    v_rcp_f32 v19, v19
    v_rcp_f32 v20, v20
    v_rcp_f32 v21, v21
    v_rcp_f32 v22, v22
    v_rcp_f32 v23, v23
    v_mul_f32 v40, v40, v16
    v_mul_f32 v41, v41, v17
    v_mul_f32 v42, v42, v18
    v_mul_f32 v43, v43, v19
    v_mul_f32 v44, v44, v20
    v_mul_f32 v45, v45, v21
    v_mul_f32 v46, v46, v22
    v_mul_f32 v47, v47, v23
    v_cvt_pk_bf16_f32 v28, v40, v41
    v_cvt_pk_bf16_f32 v29, v42, v43
    v_cvt_pk_bf16_f32 v30, v44, v45
    v_cvt_pk_bf16_f32 v31, v46, v47
    s_cmp_lg_u32 s23, 0
    s_cbranch_scc1 p1g_44
    s_waitcnt vmcnt(0)
    s_mov_b64 exec, 1
    ds_add_u32 v242, v243 offset:8
    s_mov_b64 exec, -1
p1g_44:
    s_lshl_b32 s26, s33, 5
    s_add_u32 s26, s26, s32
    buffer_store_dwordx4 v[24:27], v8, s[8:11], s26 offen offset:1024 sc1
    buffer_store_dwordx4 v[28:31], v8, s[8:11], s26 offen offset:1536 sc1
    s_sub_u32 s27, s21, 20
    s_lshr_b32 s27, s27, 2
    s_add_u32 s27, s27, 24
    s_lshl_b32 s27, s27, 7
    s_mov_b32 s48, s16
    s_mov_b32 s49, s17
    s_mov_b32 s50, s18
    s_mov_b32 s51, s19
    v_mov_b32 v241, v3
    s_mov_b32 s30, 27648
    s_mul_i32 s25, s22, 9
    s_mul_i32 s29, s25, s30
    s_add_u32 s29, s29, s27
    s_lshl_b32 s25, s25, 10
    s_add_u32 m0, s25, 73728
    s_add_u32 s27, s21, 28
    s_sub_u32 s28, s21, 8
    s_cmp_lt_u32 s21, 8
    s_cselect_b32 s33, s27, s28
    s_sub_u32 s28, s21, 17
    s_cmp_lt_u32 s21, 17
    s_cselect_b32 s33, s33, s28
    s_cselect_b32 s34, 0x3eae1a93, 1.0
    s_mov_b32 s28, 73728
    s_cselect_b32 s27, 36864, s28
    s_mov_b32 s28, 27262976
    s_cselect_b32 s35, 24903680, s28
    s_mul_i32 s27, s27, s24
    s_add_u32 s35, s35, s27
    s_lshl_b32 s27, s33, 12
    s_add_u32 s35, s35, s27
    s_sub_u32 s28, s21, 26
    s_cmp_ge_u32 s21, 26
    s_cselect_b32 s33, s28, s33
    s_lshl_b32 s33, s33, 6
    s_cmp_ge_u32 s21, 20
    s_cselect_b64 s[52:53], s[52:53], 0
    s_cselect_b64 s[54:55], s[54:55], 0
p1fw_45:
    ds_read_b32 v244, v242 offset:8
    s_waitcnt lgkmcnt(0)
    v_readfirstlane_b32 s25, v244
    s_cmp_ge_u32 s25, 8
    s_cbranch_scc1 p1fd_46
    s_sleep 1
    s_sub_u32 s38, s38, 1
    s_cmp_gt_i32 s38, 0
    s_cbranch_scc1 p1fw_45
p1fd_46:
    s_cmp_lg_u32 s23, 1
    s_cbranch_scc1 p1g_47
p1fw_48:
    ds_read_b32 v244, v242 offset:20
    s_waitcnt lgkmcnt(0)
    v_readfirstlane_b32 s25, v244
    s_cmp_ge_u32 s25, 8
    s_cbranch_scc1 p1fd_49
    s_sleep 1
    s_sub_u32 s38, s38, 1
    s_cmp_gt_i32 s38, 0
    s_cbranch_scc1 p1fw_48
p1fd_49:
p1g_47:
    s_cmp_ge_u32 s21, 26
    s_cbranch_scc1 p1v_51
    s_mov_b64 vcc, s[54:55]
    s_cbranch_vccz p1n_53
    s_setprio 1
    ds_read_b64_tr_b16 v[48:49], v4 offset:0
    ds_read_b64_tr_b16 v[50:51], v4 offset:256
    ds_read_b64_tr_b16 v[52:53], v4 offset:2048
    ds_read_b64_tr_b16 v[54:55], v4 offset:2304
    ds_read_b64_tr_b16 v[56:57], v4 offset:4096
    ds_read_b64_tr_b16 v[58:59], v4 offset:4352
    ds_read_b64_tr_b16 v[60:61], v4 offset:6144
    ds_read_b64_tr_b16 v[62:63], v4 offset:6400
    buffer_load_dwordx4 v241, s[48:51], s29 offen lds
    s_add_u32 s29, s29, s30
    s_add_u32 m0, m0, 1024
    s_waitcnt lgkmcnt(6)
    v_mfma_f32_32x32x16_bf16 v[32:47], v[48:51], v[96:99], 0
    ds_read_b64_tr_b16 v[48:49], v4 offset:8192
    ds_read_b64_tr_b16 v[50:51], v4 offset:8448
    s_waitcnt lgkmcnt(6)
    v_mfma_f32_32x32x16_bf16 v[32:47], v[52:55], v[100:103], v[32:47]
    ds_read_b64_tr_b16 v[52:53], v4 offset:10240
    ds_read_b64_tr_b16 v[54:55], v4 offset:10496
    buffer_load_dwordx4 v241, s[48:51], s29 offen lds
    s_add_u32 s29, s29, s30
    s_add_u32 m0, m0, 1024
    s_waitcnt lgkmcnt(6)
    v_mfma_f32_32x32x16_bf16 v[32:47], v[56:59], v[104:107], v[32:47]
    ds_read_b64_tr_b16 v[56:57], v4 offset:12288
    ds_read_b64_tr_b16 v[58:59], v4 offset:12544
    s_waitcnt lgkmcnt(6)
    v_mfma_f32_32x32x16_bf16 v[32:47], v[60:63], v[108:111], v[32:47]
    ds_read_b64_tr_b16 v[60:61], v4 offset:14336
    ds_read_b64_tr_b16 v[62:63], v4 offset:14592
    buffer_load_dwordx4 v241, s[48:51], s29 offen lds
    s_add_u32 s29, s29, s30
    s_add_u32 m0, m0, 1024
    s_waitcnt lgkmcnt(6)
    v_mfma_f32_32x32x16_bf16 v[32:47], v[48:51], v[112:115], v[32:47]
    ds_read_b64_tr_b16 v[48:49], v4 offset:16384
    ds_read_b64_tr_b16 v[50:51], v4 offset:16640
    s_waitcnt lgkmcnt(6)
    v_mfma_f32_32x32x16_bf16 v[32:47], v[52:55], v[116:119], v[32:47]
    ds_read_b64_tr_b16 v[52:53], v4 offset:18432
    ds_read_b64_tr_b16 v[54:55], v4 offset:18688
    buffer_load_dwordx4 v241, s[48:51], s29 offen lds
    s_add_u32 s29, s29, s30
    s_add_u32 m0, m0, 1024
    s_waitcnt lgkmcnt(6)
    v_mfma_f32_32x32x16_bf16 v[32:47], v[56:59], v[120:123], v[32:47]
    ds_read_b64_tr_b16 v[56:57], v4 offset:20480
    ds_read_b64_tr_b16 v[58:59], v4 offset:20736
    s_waitcnt lgkmcnt(6)
    v_mfma_f32_32x32x16_bf16 v[32:47], v[60:63], v[124:127], v[32:47]
    ds_read_b64_tr_b16 v[60:61], v4 offset:22528
    ds_read_b64_tr_b16 v[62:63], v4 offset:22784
    buffer_load_dwordx4 v241, s[48:51], s29 offen lds
    s_add_u32 s29, s29, s30
    s_add_u32 m0, m0, 1024
    s_waitcnt lgkmcnt(6)
    v_mfma_f32_32x32x16_bf16 v[32:47], v[48:51], v[128:131], v[32:47]
    ds_read_b64_tr_b16 v[48:49], v4 offset:24576
    ds_read_b64_tr_b16 v[50:51], v4 offset:24832
    s_waitcnt lgkmcnt(6)
    v_mfma_f32_32x32x16_bf16 v[32:47], v[52:55], v[132:135], v[32:47]
    ds_read_b64_tr_b16 v[52:53], v4 offset:26624
    ds_read_b64_tr_b16 v[54:55], v4 offset:26880
    buffer_load_dwordx4 v241, s[48:51], s29 offen lds
    s_add_u32 s29, s29, s30
    s_add_u32 m0, m0, 1024
    s_setprio 2
    s_waitcnt lgkmcnt(6)
    v_mfma_f32_32x32x16_bf16 v[32:47], v[56:59], v[136:139], v[32:47]
    ds_read_b64_tr_b16 v[56:57], v4 offset:28672
    ds_read_b64_tr_b16 v[58:59], v4 offset:28928
    s_waitcnt lgkmcnt(6)
    v_mfma_f32_32x32x16_bf16 v[32:47], v[60:63], v[140:143], v[32:47]
    ds_read_b64_tr_b16 v[60:61], v4 offset:30720
    ds_read_b64_tr_b16 v[62:63], v4 offset:30976
    buffer_load_dwordx4 v241, s[48:51], s29 offen lds
    s_add_u32 s29, s29, s30
    s_add_u32 m0, m0, 1024
    s_waitcnt lgkmcnt(6)
    v_mfma_f32_32x32x16_bf16 v[32:47], v[48:51], v[144:147], v[32:47]
    ds_read_b64_tr_b16 v[48:49], v5 offset:0
    ds_read_b64_tr_b16 v[50:51], v5 offset:256
    s_waitcnt lgkmcnt(6)
    v_mfma_f32_32x32x16_bf16 v[32:47], v[52:55], v[148:151], v[32:47]
    ds_read_b64_tr_b16 v[52:53], v5 offset:2048
    ds_read_b64_tr_b16 v[54:55], v5 offset:2304
    buffer_load_dwordx4 v241, s[48:51], s29 offen lds
    s_add_u32 s29, s29, s30
    s_add_u32 m0, m0, 1024
    s_waitcnt lgkmcnt(6)
    v_mfma_f32_32x32x16_bf16 v[32:47], v[56:59], v[152:155], v[32:47]
    ds_read_b64_tr_b16 v[56:57], v5 offset:4096
    ds_read_b64_tr_b16 v[58:59], v5 offset:4352
    s_waitcnt lgkmcnt(6)
    v_mfma_f32_32x32x16_bf16 v[32:47], v[60:63], v[156:159], v[32:47]
    ds_read_b64_tr_b16 v[60:61], v5 offset:6144
    ds_read_b64_tr_b16 v[62:63], v5 offset:6400
    buffer_load_dwordx4 v241, s[48:51], s29 offen lds
    s_add_u32 s29, s29, s30
    s_add_u32 m0, m0, 1024
    s_waitcnt lgkmcnt(6)
    v_mfma_f32_32x32x16_bf16 v[32:47], v[48:51], v[160:163], v[32:47]
    ds_read_b64_tr_b16 v[48:49], v5 offset:8192
    ds_read_b64_tr_b16 v[50:51], v5 offset:8448
    s_waitcnt lgkmcnt(6)
    v_mfma_f32_32x32x16_bf16 v[32:47], v[52:55], v[164:167], v[32:47]
    ds_read_b64_tr_b16 v[52:53], v5 offset:10240
    ds_read_b64_tr_b16 v[54:55], v5 offset:10496
    s_waitcnt lgkmcnt(6)
    v_mfma_f32_32x32x16_bf16 v[32:47], v[56:59], v[168:171], v[32:47]
    ds_read_b64_tr_b16 v[56:57], v5 offset:12288
    ds_read_b64_tr_b16 v[58:59], v5 offset:12544
    s_waitcnt lgkmcnt(6)
    v_mfma_f32_32x32x16_bf16 v[32:47], v[60:63], v[172:175], v[32:47]
    ds_read_b64_tr_b16 v[60:61], v5 offset:14336
    ds_read_b64_tr_b16 v[62:63], v5 offset:14592
    s_setprio 3
    s_waitcnt lgkmcnt(6)
    v_mfma_f32_32x32x16_bf16 v[32:47], v[48:51], v[176:179], v[32:47]
    ds_read_b64_tr_b16 v[48:49], v5 offset:16384
    ds_read_b64_tr_b16 v[50:51], v5 offset:16640
    s_lshl_b32 s26, s24, 12
    s_add_u32 s26, s26, 2490368
    v_lshlrev_b32 v247, 3, v12
    buffer_load_dwordx2 v[250:251], v247, s[8:11], s26 offen sc1
    s_waitcnt lgkmcnt(6)
    v_mfma_f32_32x32x16_bf16 v[32:47], v[52:55], v[180:183], v[32:47]
    ds_read_b64_tr_b16 v[52:53], v5 offset:18432
    ds_read_b64_tr_b16 v[54:55], v5 offset:18688
    s_waitcnt lgkmcnt(6)
    v_mfma_f32_32x32x16_bf16 v[32:47], v[56:59], v[184:187], v[32:47]
    ds_read_b64_tr_b16 v[56:57], v5 offset:20480
    ds_read_b64_tr_b16 v[58:59], v5 offset:20736
    s_waitcnt lgkmcnt(6)
    v_mfma_f32_32x32x16_bf16 v[32:47], v[60:63], v[188:191], v[32:47]
    ds_read_b64_tr_b16 v[60:61], v5 offset:22528
    ds_read_b64_tr_b16 v[62:63], v5 offset:22784
    s_waitcnt lgkmcnt(6)
    v_mfma_f32_32x32x16_bf16 v[32:47], v[48:51], v[192:195], v[32:47]
    ds_read_b64_tr_b16 v[48:49], v5 offset:24576
    ds_read_b64_tr_b16 v[50:51], v5 offset:24832
    s_waitcnt lgkmcnt(6)
    v_mfma_f32_32x32x16_bf16 v[32:47], v[52:55], v[196:199], v[32:47]
    ds_read_b64_tr_b16 v[52:53], v5 offset:26624
    ds_read_b64_tr_b16 v[54:55], v5 offset:26880
    s_waitcnt lgkmcnt(6)
    v_mfma_f32_32x32x16_bf16 v[32:47], v[56:59], v[200:203], v[32:47]
    ds_read_b64_tr_b16 v[56:57], v5 offset:28672
    ds_read_b64_tr_b16 v[58:59], v5 offset:28928
    s_waitcnt lgkmcnt(6)
    v_mfma_f32_32x32x16_bf16 v[32:47], v[60:63], v[204:207], v[32:47]
    ds_read_b64_tr_b16 v[60:61], v5 offset:30720
    ds_read_b64_tr_b16 v[62:63], v5 offset:30976
    s_waitcnt lgkmcnt(6)
    v_mfma_f32_32x32x16_bf16 v[32:47], v[48:51], v[208:211], v[32:47]
    ds_read_b64_tr_b16 v[48:49], v5 offset:32768
    ds_read_b64_tr_b16 v[50:51], v5 offset:33024
    s_waitcnt lgkmcnt(6)
    v_mfma_f32_32x32x16_bf16 v[32:47], v[52:55], v[212:215], v[32:47]
    ds_read_b64_tr_b16 v[52:53], v5 offset:34816
    ds_read_b64_tr_b16 v[54:55], v5 offset:35072
    s_waitcnt lgkmcnt(6)
    v_mfma_f32_32x32x16_bf16 v[32:47], v[56:59], v[216:219], v[32:47]
    ds_read_b64_tr_b16 v[56:57], v5 offset:36864
    ds_read_b64_tr_b16 v[58:59], v5 offset:37120
    s_waitcnt lgkmcnt(6)
    v_mfma_f32_32x32x16_bf16 v[32:47], v[60:63], v[220:223], v[32:47]
    ds_read_b64_tr_b16 v[60:61], v5 offset:38912
    ds_read_b64_tr_b16 v[62:63], v5 offset:39168
    s_waitcnt lgkmcnt(6)
    v_mfma_f32_32x32x16_bf16 v[32:47], v[48:51], v[224:227], v[32:47]
    s_waitcnt lgkmcnt(4)
    v_mfma_f32_32x32x16_bf16 v[32:47], v[52:55], v[228:231], v[32:47]
    s_waitcnt lgkmcnt(2)
    v_mfma_f32_32x32x16_bf16 v[32:47], v[56:59], v[232:235], v[32:47]
    s_waitcnt lgkmcnt(0)
    v_mfma_f32_32x32x16_bf16 v[32:47], v[60:63], v[236:239], v[32:47]
    s_setprio 0
    s_nop 10
    s_branch p1e_54
p1n_53:
    s_setprio 1
    ds_read_b64_tr_b16 v[48:49], v4 offset:0
    ds_read_b64_tr_b16 v[50:51], v4 offset:256
    ds_read_b64_tr_b16 v[52:53], v4 offset:2048
    ds_read_b64_tr_b16 v[54:55], v4 offset:2304
    ds_read_b64_tr_b16 v[56:57], v4 offset:4096
    ds_read_b64_tr_b16 v[58:59], v4 offset:4352
    ds_read_b64_tr_b16 v[60:61], v4 offset:6144
    ds_read_b64_tr_b16 v[62:63], v4 offset:6400
    s_waitcnt lgkmcnt(6)
    v_mfma_f32_32x32x16_bf16 v[32:47], v[48:51], v[96:99], 0
    ds_read_b64_tr_b16 v[48:49], v4 offset:8192
    ds_read_b64_tr_b16 v[50:51], v4 offset:8448
    s_waitcnt lgkmcnt(6)
    v_mfma_f32_32x32x16_bf16 v[32:47], v[52:55], v[100:103], v[32:47]
    ds_read_b64_tr_b16 v[52:53], v4 offset:10240
    ds_read_b64_tr_b16 v[54:55], v4 offset:10496
    s_waitcnt lgkmcnt(6)
    v_mfma_f32_32x32x16_bf16 v[32:47], v[56:59], v[104:107], v[32:47]
    ds_read_b64_tr_b16 v[56:57], v4 offset:12288
    ds_read_b64_tr_b16 v[58:59], v4 offset:12544
    s_waitcnt lgkmcnt(6)
    v_mfma_f32_32x32x16_bf16 v[32:47], v[60:63], v[108:111], v[32:47]
    ds_read_b64_tr_b16 v[60:61], v4 offset:14336
    ds_read_b64_tr_b16 v[62:63], v4 offset:14592
    s_waitcnt lgkmcnt(6)
    v_mfma_f32_32x32x16_bf16 v[32:47], v[48:51], v[112:115], v[32:47]
    ds_read_b64_tr_b16 v[48:49], v4 offset:16384
    ds_read_b64_tr_b16 v[50:51], v4 offset:16640
    s_waitcnt lgkmcnt(6)
    v_mfma_f32_32x32x16_bf16 v[32:47], v[52:55], v[116:119], v[32:47]
    ds_read_b64_tr_b16 v[52:53], v4 offset:18432
    ds_read_b64_tr_b16 v[54:55], v4 offset:18688
    s_waitcnt lgkmcnt(6)
    v_mfma_f32_32x32x16_bf16 v[32:47], v[56:59], v[120:123], v[32:47]
    ds_read_b64_tr_b16 v[56:57], v4 offset:20480
    ds_read_b64_tr_b16 v[58:59], v4 offset:20736
    s_waitcnt lgkmcnt(6)
    v_mfma_f32_32x32x16_bf16 v[32:47], v[60:63], v[124:127], v[32:47]
    ds_read_b64_tr_b16 v[60:61], v4 offset:22528
    ds_read_b64_tr_b16 v[62:63], v4 offset:22784
    s_waitcnt lgkmcnt(6)
    v_mfma_f32_32x32x16_bf16 v[32:47], v[48:51], v[128:131], v[32:47]
    ds_read_b64_tr_b16 v[48:49], v4 offset:24576
    ds_read_b64_tr_b16 v[50:51], v4 offset:24832
    s_waitcnt lgkmcnt(6)
    v_mfma_f32_32x32x16_bf16 v[32:47], v[52:55], v[132:135], v[32:47]
    ds_read_b64_tr_b16 v[52:53], v4 offset:26624
    ds_read_b64_tr_b16 v[54:55], v4 offset:26880
    s_setprio 2
    s_waitcnt lgkmcnt(6)
    v_mfma_f32_32x32x16_bf16 v[32:47], v[56:59], v[136:139], v[32:47]
    ds_read_b64_tr_b16 v[56:57], v4 offset:28672
    ds_read_b64_tr_b16 v[58:59], v4 offset:28928
    s_waitcnt lgkmcnt(6)
    v_mfma_f32_32x32x16_bf16 v[32:47], v[60:63], v[140:143], v[32:47]
    ds_read_b64_tr_b16 v[60:61], v4 offset:30720
    ds_read_b64_tr_b16 v[62:63], v4 offset:30976
    s_waitcnt lgkmcnt(6)
    v_mfma_f32_32x32x16_bf16 v[32:47], v[48:51], v[144:147], v[32:47]
    ds_read_b64_tr_b16 v[48:49], v5 offset:0
    ds_read_b64_tr_b16 v[50:51], v5 offset:256
    s_waitcnt lgkmcnt(6)
    v_mfma_f32_32x32x16_bf16 v[32:47], v[52:55], v[148:151], v[32:47]
    ds_read_b64_tr_b16 v[52:53], v5 offset:2048
    ds_read_b64_tr_b16 v[54:55], v5 offset:2304
    s_waitcnt lgkmcnt(6)
    v_mfma_f32_32x32x16_bf16 v[32:47], v[56:59], v[152:155], v[32:47]
    ds_read_b64_tr_b16 v[56:57], v5 offset:4096
    ds_read_b64_tr_b16 v[58:59], v5 offset:4352
    s_waitcnt lgkmcnt(6)
    v_mfma_f32_32x32x16_bf16 v[32:47], v[60:63], v[156:159], v[32:47]
    ds_read_b64_tr_b16 v[60:61], v5 offset:6144
    ds_read_b64_tr_b16 v[62:63], v5 offset:6400
    s_waitcnt lgkmcnt(6)
    v_mfma_f32_32x32x16_bf16 v[32:47], v[48:51], v[160:163], v[32:47]
    ds_read_b64_tr_b16 v[48:49], v5 offset:8192
    ds_read_b64_tr_b16 v[50:51], v5 offset:8448
    s_waitcnt lgkmcnt(6)
    v_mfma_f32_32x32x16_bf16 v[32:47], v[52:55], v[164:167], v[32:47]
    ds_read_b64_tr_b16 v[52:53], v5 offset:10240
    ds_read_b64_tr_b16 v[54:55], v5 offset:10496
    s_waitcnt lgkmcnt(6)
    v_mfma_f32_32x32x16_bf16 v[32:47], v[56:59], v[168:171], v[32:47]
    ds_read_b64_tr_b16 v[56:57], v5 offset:12288
    ds_read_b64_tr_b16 v[58:59], v5 offset:12544
    s_waitcnt lgkmcnt(6)
    v_mfma_f32_32x32x16_bf16 v[32:47], v[60:63], v[172:175], v[32:47]
    ds_read_b64_tr_b16 v[60:61], v5 offset:14336
    ds_read_b64_tr_b16 v[62:63], v5 offset:14592
    s_setprio 3
    s_waitcnt lgkmcnt(6)
    v_mfma_f32_32x32x16_bf16 v[32:47], v[48:51], v[176:179], v[32:47]
    ds_read_b64_tr_b16 v[48:49], v5 offset:16384
    ds_read_b64_tr_b16 v[50:51], v5 offset:16640
    s_lshl_b32 s26, s24, 12
    s_add_u32 s26, s26, 2490368
    v_lshlrev_b32 v247, 3, v12
    buffer_load_dwordx2 v[250:251], v247, s[8:11], s26 offen sc1
    s_waitcnt lgkmcnt(6)
    v_mfma_f32_32x32x16_bf16 v[32:47], v[52:55], v[180:183], v[32:47]
    ds_read_b64_tr_b16 v[52:53], v5 offset:18432
    ds_read_b64_tr_b16 v[54:55], v5 offset:18688
    s_waitcnt lgkmcnt(6)
    v_mfma_f32_32x32x16_bf16 v[32:47], v[56:59], v[184:187], v[32:47]
    ds_read_b64_tr_b16 v[56:57], v5 offset:20480
    ds_read_b64_tr_b16 v[58:59], v5 offset:20736
    s_waitcnt lgkmcnt(6)
    v_mfma_f32_32x32x16_bf16 v[32:47], v[60:63], v[188:191], v[32:47]
    ds_read_b64_tr_b16 v[60:61], v5 offset:22528
    ds_read_b64_tr_b16 v[62:63], v5 offset:22784
    s_waitcnt lgkmcnt(6)
    v_mfma_f32_32x32x16_bf16 v[32:47], v[48:51], v[192:195], v[32:47]
    ds_read_b64_tr_b16 v[48:49], v5 offset:24576
    ds_read_b64_tr_b16 v[50:51], v5 offset:24832
    s_waitcnt lgkmcnt(6)
    v_mfma_f32_32x32x16_bf16 v[32:47], v[52:55], v[196:199], v[32:47]
    ds_read_b64_tr_b16 v[52:53], v5 offset:26624
    ds_read_b64_tr_b16 v[54:55], v5 offset:26880
    s_waitcnt lgkmcnt(6)
    v_mfma_f32_32x32x16_bf16 v[32:47], v[56:59], v[200:203], v[32:47]
    ds_read_b64_tr_b16 v[56:57], v5 offset:28672
    ds_read_b64_tr_b16 v[58:59], v5 offset:28928
    s_waitcnt lgkmcnt(6)
    v_mfma_f32_32x32x16_bf16 v[32:47], v[60:63], v[204:207], v[32:47]
    ds_read_b64_tr_b16 v[60:61], v5 offset:30720
    ds_read_b64_tr_b16 v[62:63], v5 offset:30976
    s_waitcnt lgkmcnt(6)
    v_mfma_f32_32x32x16_bf16 v[32:47], v[48:51], v[208:211], v[32:47]
    ds_read_b64_tr_b16 v[48:49], v5 offset:32768
    ds_read_b64_tr_b16 v[50:51], v5 offset:33024
    s_waitcnt lgkmcnt(6)
    v_mfma_f32_32x32x16_bf16 v[32:47], v[52:55], v[212:215], v[32:47]
    ds_read_b64_tr_b16 v[52:53], v5 offset:34816
    ds_read_b64_tr_b16 v[54:55], v5 offset:35072
    s_waitcnt lgkmcnt(6)
    v_mfma_f32_32x32x16_bf16 v[32:47], v[56:59], v[216:219], v[32:47]
    ds_read_b64_tr_b16 v[56:57], v5 offset:36864
    ds_read_b64_tr_b16 v[58:59], v5 offset:37120
    s_waitcnt lgkmcnt(6)
    v_mfma_f32_32x32x16_bf16 v[32:47], v[60:63], v[220:223], v[32:47]
    ds_read_b64_tr_b16 v[60:61], v5 offset:38912
    ds_read_b64_tr_b16 v[62:63], v5 offset:39168
    s_waitcnt lgkmcnt(6)
    v_mfma_f32_32x32x16_bf16 v[32:47], v[48:51], v[224:227], v[32:47]
    s_waitcnt lgkmcnt(4)
    v_mfma_f32_32x32x16_bf16 v[32:47], v[52:55], v[228:231], v[32:47]
    s_waitcnt lgkmcnt(2)
    v_mfma_f32_32x32x16_bf16 v[32:47], v[56:59], v[232:235], v[32:47]
    s_waitcnt lgkmcnt(0)
    v_mfma_f32_32x32x16_bf16 v[32:47], v[60:63], v[236:239], v[32:47]
    s_setprio 0
    s_nop 10
p1e_54:
    s_waitcnt vmcnt(0)
    v_cmp_ne_u64 vcc, s[100:101], v[250:251]
    s_nop 0
    s_cmp_eq_u64 vcc, 0
    s_cselect_b32 s7, 1, 0
    s_lshl_b32 s7, s7, s23
    s_mul_i32 s25, s31, 2
    s_lshl_b32 s7, s7, s25
    s_cmp_lg_u32 s23, 1
    s_cbranch_scc1 p1g_55
    s_mov_b64 exec, 1
    ds_add_u32 v242, v243 offset:12
    s_mov_b64 exec, -1
p1g_55:
    s_cmp_lg_u32 s7, 1
    s_cbranch_scc1 p1w_56
    s_lshl_b32 s26, s24, 13
    s_add_u32 s26, s26, 2752512
    s_add_u32 s28, s26, 4096
    s_cmp_eq_u32 s6, 1
    s_cbranch_scc1 p1a_57
    buffer_load_dwordx4 v[80:83], v245, s[8:11], s26 offen offset:0 sc1
    buffer_load_dwordx4 v[84:87], v245, s[8:11], s26 offen offset:1024 sc1
    buffer_load_dwordx4 v[88:91], v245, s[8:11], s26 offen offset:2048 sc1
    buffer_load_dwordx4 v[92:95], v245, s[8:11], s26 offen offset:3072 sc1
    buffer_load_dwordx4 v[48:51], v245, s[8:11], s28 offen offset:0 sc1
    buffer_load_dwordx4 v[52:55], v245, s[8:11], s28 offen offset:1024 sc1
    buffer_load_dwordx4 v[56:59], v245, s[8:11], s28 offen offset:2048 sc1
    buffer_load_dwordx4 v[60:63], v245, s[8:11], s28 offen offset:3072 sc1
    s_branch p1j_58
p1a_57:
    buffer_load_dwordx4 v[88:91], v245, s[8:11], s26 offen offset:0 sc1
    buffer_load_dwordx4 v[92:95], v245, s[8:11], s26 offen offset:1024 sc1
    buffer_load_dwordx4 v[16:19], v245, s[8:11], s26 offen offset:2048 sc1
    buffer_load_dwordx4 v[20:23], v245, s[8:11], s26 offen offset:3072 sc1
    buffer_load_dwordx4 v[48:51], v245, s[8:11], s28 offen offset:0 sc1
    buffer_load_dwordx4 v[52:55], v245, s[8:11], s28 offen offset:1024 sc1
    buffer_load_dwordx4 v[56:59], v245, s[8:11], s28 offen offset:2048 sc1
    buffer_load_dwordx4 v[60:63], v245, s[8:11], s28 offen offset:3072 sc1
p1j_58:
p1w_56:
    s_cmp_eq_u32 s31, 0
    s_cbranch_scc1 p1x_59
p1fw_60:
    ds_read_b32 v244, v242 offset:20
    s_waitcnt lgkmcnt(0)
    v_readfirstlane_b32 s25, v244
    s_cmp_ge_u32 s25, 8
    s_cbranch_scc1 p1fd_61
    s_sleep 1
    s_sub_u32 s38, s38, 1
    s_cmp_gt_i32 s38, 0
    s_cbranch_scc1 p1fw_60
p1fd_61:
    buffer_load_dwordx4 v241, s[48:51], s29 offen lds
    s_add_u32 s29, s29, s30
    s_add_u32 m0, m0, 1024
    s_nop 0
    buffer_load_dwordx4 v241, s[48:51], s29 offen lds
    s_add_u32 s29, s29, s30
    s_add_u32 m0, m0, 1024
    s_nop 0
    buffer_load_dwordx4 v241, s[48:51], s29 offen lds
    s_add_u32 s29, s29, s30
    s_add_u32 m0, m0, 1024
    s_nop 0
    buffer_load_dwordx4 v241, s[48:51], s29 offen lds
    s_add_u32 s29, s29, s30
    s_add_u32 m0, m0, 1024
    s_nop 0
    buffer_load_dwordx4 v241, s[48:51], s29 offen lds
    s_add_u32 s29, s29, s30
    s_add_u32 m0, m0, 1024
    s_nop 0
    buffer_load_dwordx4 v241, s[48:51], s29 offen lds
    s_add_u32 s29, s29, s30
    s_add_u32 m0, m0, 1024
    s_nop 0
    buffer_load_dwordx4 v241, s[48:51], s29 offen lds
    s_add_u32 s29, s29, s30
    s_add_u32 m0, m0, 1024
    s_nop 0
    buffer_load_dwordx4 v241, s[48:51], s29 offen lds
    s_add_u32 s29, s29, s30
    s_add_u32 m0, m0, 1024
    s_nop 0
    buffer_load_dwordx4 v241, s[48:51], s29 offen lds
    s_add_u32 s29, s29, s30
    s_add_u32 m0, m0, 1024
p1x_59:
    s_cmp_ge_u32 s21, 8
    s_cbranch_scc1 p1a_62
    v_mul_f32 v16, v32, v32
    v_mul_f32 v17, v33, v33
    v_mul_f32 v18, v34, v34
    v_mul_f32 v19, v35, v35
    v_mul_f32 v20, v36, v36
    v_mul_f32 v21, v37, v37
    v_mul_f32 v22, v38, v38
    v_mul_f32 v23, v39, v39
    v_fmaak_f32 v16, v16, v9, 0xc0135761
    v_fmaak_f32 v17, v17, v9, 0xc0135761
    v_fmaak_f32 v18, v18, v9, 0xc0135761
    v_fmaak_f32 v19, v19, v9, 0xc0135761
    v_fmaak_f32 v20, v20, v9, 0xc0135761
    v_fmaak_f32 v21, v21, v9, 0xc0135761
    v_fmaak_f32 v22, v22, v9, 0xc0135761
    v_fmaak_f32 v23, v23, v9, 0xc0135761
    v_mul_f32 v16, v16, v32
    v_mul_f32 v17, v17, v33
    v_mul_f32 v18, v18, v34
    v_mul_f32 v19, v19, v35
    v_mul_f32 v20, v20, v36
    v_mul_f32 v21, v21, v37
    v_mul_f32 v22, v22, v38
    v_mul_f32 v23, v23, v39
    v_exp_f32 v16, v16
    v_exp_f32 v17, v17
    v_exp_f32 v18, v18
    v_exp_f32 v19, v19
    v_exp_f32 v20, v20
    v_exp_f32 v21, v21
    v_exp_f32 v22, v22
    v_exp_f32 v23, v23
    v_add_f32 v16, 1.0, v16
    v_add_f32 v17, 1.0, v17
    v_add_f32 v18, 1.0, v18
    v_add_f32 v19, 1.0, v19
    v_add_f32 v20, 1.0, v20
    v_add_f32 v21, 1.0, v21
    v_add_f32 v22, 1.0, v22
    v_add_f32 v23, 1.0, v23
    v_rcp_f32 v16, v16
    v_rcp_f32 v17, v17
    v_rcp_f32 v18, v18
    v_rcp_f32 v19, v19
    v_rcp_f32 v20, v20
    v_rcp_f32 v21, v21
    v_rcp_f32 v22, v22
    v_rcp_f32 v23, v23
    v_mul_f32 v32, v32, v16
    v_mul_f32 v33, v33, v17
    v_mul_f32 v34, v34, v18
    v_mul_f32 v35, v35, v19
    v_mul_f32 v36, v36, v20
    v_mul_f32 v37, v37, v21
    v_mul_f32 v38, v38, v22
    v_mul_f32 v39, v39, v23
    v_cvt_pk_bf16_f32 v24, v32, v33
    v_cvt_pk_bf16_f32 v25, v34, v35
    v_cvt_pk_bf16_f32 v26, v36, v37
    v_cvt_pk_bf16_f32 v27, v38, v39
    v_mul_f32 v16, v40, v40
    v_mul_f32 v17, v41, v41
    v_mul_f32 v18, v42, v42
    v_mul_f32 v19, v43, v43
    v_mul_f32 v20, v44, v44
    v_mul_f32 v21, v45, v45
    v_mul_f32 v22, v46, v46
    v_mul_f32 v23, v47, v47
    v_fmaak_f32 v16, v16, v9, 0xc0135761
    v_fmaak_f32 v17, v17, v9, 0xc0135761
    v_fmaak_f32 v18, v18, v9, 0xc0135761
    v_fmaak_f32 v19, v19, v9, 0xc0135761
    v_fmaak_f32 v20, v20, v9, 0xc0135761
    v_fmaak_f32 v21, v21, v9, 0xc0135761
    v_fmaak_f32 v22, v22, v9, 0xc0135761
    v_fmaak_f32 v23, v23, v9, 0xc0135761
    v_mul_f32 v16, v16, v40
    v_mul_f32 v17, v17, v41
    v_mul_f32 v18, v18, v42
    v_mul_f32 v19, v19, v43
    v_mul_f32 v20, v20, v44
    v_mul_f32 v21, v21, v45
    v_mul_f32 v22, v22, v46
    v_mul_f32 v23, v23, v47
    v_exp_f32 v16, v16
    v_exp_f32 v17, v17
    v_exp_f32 v18, v18
    v_exp_f32 v19, v19
    v_exp_f32 v20, v20
    v_exp_f32 v21, v21
    v_exp_f32 v22, v22
    v_exp_f32 v23, v23
    v_add_f32 v16, 1.0, v16
    v_add_f32 v17, 1.0, v17
    v_add_f32 v18, 1.0, v18
    v_add_f32 v19, 1.0, v19
    v_add_f32 v20, 1.0, v20
    v_add_f32 v21, 1.0, v21
    v_add_f32 v22, 1.0, v22
    v_add_f32 v23, 1.0, v23
    v_rcp_f32 v16, v16
    v_rcp_f32 v17, v17
    v_rcp_f32 v18, v18
    v_rcp_f32 v19, v19
    v_rcp_f32 v20, v20
    v_rcp_f32 v21, v21
    v_rcp_f32 v22, v22
    v_rcp_f32 v23, v23
    v_mul_f32 v40, v40, v16
    v_mul_f32 v41, v41, v17
    v_mul_f32 v42, v42, v18
    v_mul_f32 v43, v43, v19
    v_mul_f32 v44, v44, v20
    v_mul_f32 v45, v45, v21
    v_mul_f32 v46, v46, v22
    v_mul_f32 v47, v47, v23
    v_cvt_pk_bf16_f32 v28, v40, v41
    v_cvt_pk_bf16_f32 v29, v42, v43
    v_cvt_pk_bf16_f32 v30, v44, v45
    v_cvt_pk_bf16_f32 v31, v46, v47
    s_cmp_lg_u32 s7, 1
    s_cbranch_scc1 p1w_64
    s_waitcnt vmcnt(0)
    s_lshl_b32 s27, s22, 10
    s_add_u32 s27, s27, 147456
    v_add_u32 v244, s27, v245
    s_cmp_eq_u32 s6, 1
    s_cbranch_scc1 p1a_65
    v_add_f32 v80, v80, v84
    v_add_f32 v81, v81, v85
    v_add_f32 v82, v82, v86
    v_add_f32 v83, v83, v87
    v_add_f32 v88, v88, v92
    v_add_f32 v89, v89, v93
    v_add_f32 v90, v90, v94
    v_add_f32 v91, v91, v95
    v_add_f32 v48, v48, v52
    v_add_f32 v49, v49, v53
    v_add_f32 v50, v50, v54
    v_add_f32 v51, v51, v55
    v_add_f32 v56, v56, v60
    v_add_f32 v57, v57, v61
    v_add_f32 v58, v58, v62
    v_add_f32 v59, v59, v63
    v_add_f32 v80, v80, v88
    v_add_f32 v48, v48, v56
    v_add_f32 v81, v81, v89
    v_add_f32 v49, v49, v57
    v_add_f32 v82, v82, v90
    v_add_f32 v50, v50, v58
    v_add_f32 v83, v83, v91
    v_add_f32 v51, v51, v59
    v_add_f32 v80, v80, v48
    v_add_f32 v81, v81, v49
    v_add_f32 v82, v82, v50
    v_add_f32 v83, v83, v51
    ds_write_b128 v244, v[80:83]
    s_branch p1j_66
p1a_65:
    v_add_f32 v88, v88, v92
    v_add_f32 v89, v89, v93
    v_add_f32 v90, v90, v94
    v_add_f32 v91, v91, v95
    v_add_f32 v16, v16, v20
    v_add_f32 v17, v17, v21
    v_add_f32 v18, v18, v22
    v_add_f32 v19, v19, v23
    v_add_f32 v48, v48, v52
    v_add_f32 v49, v49, v53
    v_add_f32 v50, v50, v54
    v_add_f32 v51, v51, v55
    v_add_f32 v56, v56, v60
    v_add_f32 v57, v57, v61
    v_add_f32 v58, v58, v62
    v_add_f32 v59, v59, v63
    v_add_f32 v88, v88, v16
    v_add_f32 v48, v48, v56
    v_add_f32 v89, v89, v17
    v_add_f32 v49, v49, v57
    v_add_f32 v90, v90, v18
    v_add_f32 v50, v50, v58
    v_add_f32 v91, v91, v19
    v_add_f32 v51, v51, v59
    v_add_f32 v88, v88, v48
    v_add_f32 v89, v89, v49
    v_add_f32 v90, v90, v50
    v_add_f32 v91, v91, v51
    ds_write_b128 v244, v[88:91]
p1j_66:
p1w_64:
    s_lshl_b32 s26, s33, 5
    s_add_u32 s26, s26, s32
    buffer_store_dwordx4 v[24:27], v8, s[8:11], s26 offen offset:0 sc1
    buffer_store_dwordx4 v[28:31], v8, s[8:11], s26 offen offset:512 sc1
    s_branch p1j_63
p1a_62:
    v_mul_f32 v32, s34, v32
    v_mul_f32 v33, s34, v33
    v_mul_f32 v34, s34, v34
    v_mul_f32 v35, s34, v35
    v_mul_f32 v36, s34, v36
    v_mul_f32 v37, s34, v37
    v_mul_f32 v38, s34, v38
    v_mul_f32 v39, s34, v39
    v_mul_f32 v40, s34, v40
    v_mul_f32 v41, s34, v41
    v_mul_f32 v42, s34, v42
    v_mul_f32 v43, s34, v43
    v_mul_f32 v44, s34, v44
    v_mul_f32 v45, s34, v45
    v_mul_f32 v46, s34, v46
    v_mul_f32 v47, s34, v47
    v_cvt_pk_bf16_f32 v24, v32, v33
    v_cvt_pk_bf16_f32 v25, v34, v35
    v_cvt_pk_bf16_f32 v26, v36, v37
    v_cvt_pk_bf16_f32 v27, v38, v39
    v_cvt_pk_bf16_f32 v28, v40, v41
    v_cvt_pk_bf16_f32 v29, v42, v43
    v_cvt_pk_bf16_f32 v30, v44, v45
    v_cvt_pk_bf16_f32 v31, v46, v47
    s_cmp_lg_u32 s7, 1
    s_cbranch_scc1 p1w_67
    s_waitcnt vmcnt(0)
    s_lshl_b32 s27, s22, 10
    s_add_u32 s27, s27, 147456
    v_add_u32 v244, s27, v245
    s_cmp_eq_u32 s6, 1
    s_cbranch_scc1 p1a_68
    v_add_f32 v80, v80, v84
    v_add_f32 v81, v81, v85
    v_add_f32 v82, v82, v86
    v_add_f32 v83, v83, v87
    v_add_f32 v88, v88, v92
    v_add_f32 v89, v89, v93
    v_add_f32 v90, v90, v94
    v_add_f32 v91, v91, v95
    v_add_f32 v48, v48, v52
    v_add_f32 v49, v49, v53
    v_add_f32 v50, v50, v54
    v_add_f32 v51, v51, v55
    v_add_f32 v56, v56, v60
    v_add_f32 v57, v57, v61
    v_add_f32 v58, v58, v62
    v_add_f32 v59, v59, v63
    v_add_f32 v80, v80, v88
    v_add_f32 v48, v48, v56
    v_add_f32 v81, v81, v89
    v_add_f32 v49, v49, v57
    v_add_f32 v82, v82, v90
    v_add_f32 v50, v50, v58
    v_add_f32 v83, v83, v91
    v_add_f32 v51, v51, v59
    v_add_f32 v80, v80, v48
    v_add_f32 v81, v81, v49
    v_add_f32 v82, v82, v50
    v_add_f32 v83, v83, v51
    ds_write_b128 v244, v[80:83]
    s_branch p1j_69
p1a_68:
    v_add_f32 v88, v88, v92
    v_add_f32 v89, v89, v93
    v_add_f32 v90, v90, v94
    v_add_f32 v91, v91, v95
    v_add_f32 v16, v16, v20
    v_add_f32 v17, v17, v21
    v_add_f32 v18, v18, v22
    v_add_f32 v19, v19, v23
    v_add_f32 v48, v48, v52
    v_add_f32 v49, v49, v53
    v_add_f32 v50, v50, v54
    v_add_f32 v51, v51, v55
    v_add_f32 v56, v56, v60
    v_add_f32 v57, v57, v61
    v_add_f32 v58, v58, v62
    v_add_f32 v59, v59, v63
    v_add_f32 v88, v88, v16
    v_add_f32 v48, v48, v56
    v_add_f32 v89, v89, v17
    v_add_f32 v49, v49, v57
    v_add_f32 v90, v90, v18
    v_add_f32 v50, v50, v58
    v_add_f32 v91, v91, v19
    v_add_f32 v51, v51, v59
    v_add_f32 v88, v88, v48
    v_add_f32 v89, v89, v49
    v_add_f32 v90, v90, v50
    v_add_f32 v91, v91, v51
    ds_write_b128 v244, v[88:91]
p1j_69:
p1w_67:
    buffer_store_dwordx4 v[24:27], v245, s[8:11], s35 offen offset:0 sc1
    buffer_store_dwordx4 v[28:31], v245, s[8:11], s35 offen offset:1024 sc1
p1j_63:
    s_mov_b32 s36, 0
    s_cmp_eq_u32 s7, 1
    s_cbranch_scc1 p1norm_50
p1ret_70:
    s_setprio 1
    ds_read_b64_tr_b16 v[48:49], v4 offset:512
    ds_read_b64_tr_b16 v[50:51], v4 offset:768
    ds_read_b64_tr_b16 v[52:53], v4 offset:2560
    ds_read_b64_tr_b16 v[54:55], v4 offset:2816
    ds_read_b64_tr_b16 v[56:57], v4 offset:4608
    ds_read_b64_tr_b16 v[58:59], v4 offset:4864
    ds_read_b64_tr_b16 v[60:61], v4 offset:6656
    ds_read_b64_tr_b16 v[62:63], v4 offset:6912
    s_waitcnt lgkmcnt(6)
    v_mfma_f32_32x32x16_bf16 v[32:47], v[48:51], v[96:99], 0
    ds_read_b64_tr_b16 v[48:49], v4 offset:8704
    ds_read_b64_tr_b16 v[50:51], v4 offset:8960
    s_waitcnt lgkmcnt(6)
    v_mfma_f32_32x32x16_bf16 v[32:47], v[52:55], v[100:103], v[32:47]
    ds_read_b64_tr_b16 v[52:53], v4 offset:10752
    ds_read_b64_tr_b16 v[54:55], v4 offset:11008
    s_waitcnt lgkmcnt(6)
    v_mfma_f32_32x32x16_bf16 v[32:47], v[56:59], v[104:107], v[32:47]
    ds_read_b64_tr_b16 v[56:57], v4 offset:12800
    ds_read_b64_tr_b16 v[58:59], v4 offset:13056
    s_waitcnt lgkmcnt(6)
    v_mfma_f32_32x32x16_bf16 v[32:47], v[60:63], v[108:111], v[32:47]
    ds_read_b64_tr_b16 v[60:61], v4 offset:14848
    ds_read_b64_tr_b16 v[62:63], v4 offset:15104
    s_waitcnt lgkmcnt(6)
    v_mfma_f32_32x32x16_bf16 v[32:47], v[48:51], v[112:115], v[32:47]
    ds_read_b64_tr_b16 v[48:49], v4 offset:16896
    ds_read_b64_tr_b16 v[50:51], v4 offset:17152
    s_waitcnt lgkmcnt(6)
    v_mfma_f32_32x32x16_bf16 v[32:47], v[52:55], v[116:119], v[32:47]
    ds_read_b64_tr_b16 v[52:53], v4 offset:18944
    ds_read_b64_tr_b16 v[54:55], v4 offset:19200
    s_waitcnt lgkmcnt(6)
    v_mfma_f32_32x32x16_bf16 v[32:47], v[56:59], v[120:123], v[32:47]
    ds_read_b64_tr_b16 v[56:57], v4 offset:20992
    ds_read_b64_tr_b16 v[58:59], v4 offset:21248
    s_waitcnt lgkmcnt(6)
    v_mfma_f32_32x32x16_bf16 v[32:47], v[60:63], v[124:127], v[32:47]
    ds_read_b64_tr_b16 v[60:61], v4 offset:23040
    ds_read_b64_tr_b16 v[62:63], v4 offset:23296
    s_waitcnt lgkmcnt(6)
    v_mfma_f32_32x32x16_bf16 v[32:47], v[48:51], v[128:131], v[32:47]
    ds_read_b64_tr_b16 v[48:49], v4 offset:25088
    ds_read_b64_tr_b16 v[50:51], v4 offset:25344
    s_cmp_lg_u32 s7, 2
    s_cbranch_scc1 p1m_72
    s_lshl_b32 s26, s24, 13
    s_add_u32 s26, s26, 2752512
    s_add_u32 s28, s26, 4096
    buffer_load_dwordx4 v[96:99], v245, s[8:11], s26 offen offset:0 sc1
    buffer_load_dwordx4 v[100:103], v245, s[8:11], s26 offen offset:1024 sc1
    buffer_load_dwordx4 v[104:107], v245, s[8:11], s26 offen offset:2048 sc1
    buffer_load_dwordx4 v[108:111], v245, s[8:11], s26 offen offset:3072 sc1
    buffer_load_dwordx4 v[112:115], v245, s[8:11], s28 offen offset:0 sc1
    buffer_load_dwordx4 v[116:119], v245, s[8:11], s28 offen offset:1024 sc1
    buffer_load_dwordx4 v[120:123], v245, s[8:11], s28 offen offset:2048 sc1
    buffer_load_dwordx4 v[124:127], v245, s[8:11], s28 offen offset:3072 sc1
p1m_72:
    s_waitcnt lgkmcnt(6)
    v_mfma_f32_32x32x16_bf16 v[32:47], v[52:55], v[132:135], v[32:47]
    ds_read_b64_tr_b16 v[52:53], v4 offset:27136
    ds_read_b64_tr_b16 v[54:55], v4 offset:27392
    s_setprio 2
    s_waitcnt lgkmcnt(6)
    v_mfma_f32_32x32x16_bf16 v[32:47], v[56:59], v[136:139], v[32:47]
    ds_read_b64_tr_b16 v[56:57], v4 offset:29184
    ds_read_b64_tr_b16 v[58:59], v4 offset:29440
    s_waitcnt lgkmcnt(6)
    v_mfma_f32_32x32x16_bf16 v[32:47], v[60:63], v[140:143], v[32:47]
    ds_read_b64_tr_b16 v[60:61], v4 offset:31232
    ds_read_b64_tr_b16 v[62:63], v4 offset:31488
    s_waitcnt lgkmcnt(6)
    v_mfma_f32_32x32x16_bf16 v[32:47], v[48:51], v[144:147], v[32:47]
    ds_read_b64_tr_b16 v[48:49], v5 offset:512
    ds_read_b64_tr_b16 v[50:51], v5 offset:768
    s_waitcnt lgkmcnt(6)
    v_mfma_f32_32x32x16_bf16 v[32:47], v[52:55], v[148:151], v[32:47]
    ds_read_b64_tr_b16 v[52:53], v5 offset:2560
    ds_read_b64_tr_b16 v[54:55], v5 offset:2816
    s_waitcnt lgkmcnt(6)
    v_mfma_f32_32x32x16_bf16 v[32:47], v[56:59], v[152:155], v[32:47]
    ds_read_b64_tr_b16 v[56:57], v5 offset:4608
    ds_read_b64_tr_b16 v[58:59], v5 offset:4864
    s_waitcnt lgkmcnt(6)
    v_mfma_f32_32x32x16_bf16 v[32:47], v[60:63], v[156:159], v[32:47]
    ds_read_b64_tr_b16 v[60:61], v5 offset:6656
    ds_read_b64_tr_b16 v[62:63], v5 offset:6912
    s_waitcnt lgkmcnt(6)
    v_mfma_f32_32x32x16_bf16 v[32:47], v[48:51], v[160:163], v[32:47]
    ds_read_b64_tr_b16 v[48:49], v5 offset:8704
    ds_read_b64_tr_b16 v[50:51], v5 offset:8960
    s_waitcnt lgkmcnt(6)
    v_mfma_f32_32x32x16_bf16 v[32:47], v[52:55], v[164:167], v[32:47]
    ds_read_b64_tr_b16 v[52:53], v5 offset:10752
    ds_read_b64_tr_b16 v[54:55], v5 offset:11008
    s_waitcnt lgkmcnt(6)
    v_mfma_f32_32x32x16_bf16 v[32:47], v[56:59], v[168:171], v[32:47]
    ds_read_b64_tr_b16 v[56:57], v5 offset:12800
    ds_read_b64_tr_b16 v[58:59], v5 offset:13056
    s_waitcnt lgkmcnt(6)
    v_mfma_f32_32x32x16_bf16 v[32:47], v[60:63], v[172:175], v[32:47]
    ds_read_b64_tr_b16 v[60:61], v5 offset:14848
    ds_read_b64_tr_b16 v[62:63], v5 offset:15104
    s_setprio 3
    s_waitcnt lgkmcnt(6)
    v_mfma_f32_32x32x16_bf16 v[32:47], v[48:51], v[176:179], v[32:47]
    ds_read_b64_tr_b16 v[48:49], v5 offset:16896
    ds_read_b64_tr_b16 v[50:51], v5 offset:17152
    s_cmp_lg_u32 s7, 0
    s_cbranch_scc1 p1m_71
    s_lshl_b32 s26, s24, 12
    s_add_u32 s26, s26, 2490368
    v_lshlrev_b32 v247, 3, v12
    buffer_load_dwordx2 v[250:251], v247, s[8:11], s26 offen sc1
p1m_71:
    s_waitcnt lgkmcnt(6)
    v_mfma_f32_32x32x16_bf16 v[32:47], v[52:55], v[180:183], v[32:47]
    ds_read_b64_tr_b16 v[52:53], v5 offset:18944
    ds_read_b64_tr_b16 v[54:55], v5 offset:19200
    s_waitcnt lgkmcnt(6)
    v_mfma_f32_32x32x16_bf16 v[32:47], v[56:59], v[184:187], v[32:47]
    ds_read_b64_tr_b16 v[56:57], v5 offset:20992
    ds_read_b64_tr_b16 v[58:59], v5 offset:21248
    s_waitcnt lgkmcnt(6)
    v_mfma_f32_32x32x16_bf16 v[32:47], v[60:63], v[188:191], v[32:47]
    ds_read_b64_tr_b16 v[60:61], v5 offset:23040
    ds_read_b64_tr_b16 v[62:63], v5 offset:23296
    s_waitcnt lgkmcnt(6)
    v_mfma_f32_32x32x16_bf16 v[32:47], v[48:51], v[192:195], v[32:47]
    ds_read_b64_tr_b16 v[48:49], v5 offset:25088
    ds_read_b64_tr_b16 v[50:51], v5 offset:25344
    s_waitcnt lgkmcnt(6)
    v_mfma_f32_32x32x16_bf16 v[32:47], v[52:55], v[196:199], v[32:47]
    ds_read_b64_tr_b16 v[52:53], v5 offset:27136
    ds_read_b64_tr_b16 v[54:55], v5 offset:27392
    s_waitcnt lgkmcnt(6)
    v_mfma_f32_32x32x16_bf16 v[32:47], v[56:59], v[200:203], v[32:47]
    ds_read_b64_tr_b16 v[56:57], v5 offset:29184
    ds_read_b64_tr_b16 v[58:59], v5 offset:29440
    s_waitcnt lgkmcnt(6)
    v_mfma_f32_32x32x16_bf16 v[32:47], v[60:63], v[204:207], v[32:47]
    ds_read_b64_tr_b16 v[60:61], v5 offset:31232
    ds_read_b64_tr_b16 v[62:63], v5 offset:31488
    s_waitcnt lgkmcnt(6)
    v_mfma_f32_32x32x16_bf16 v[32:47], v[48:51], v[208:211], v[32:47]
    ds_read_b64_tr_b16 v[48:49], v5 offset:33280
    ds_read_b64_tr_b16 v[50:51], v5 offset:33536
    s_waitcnt lgkmcnt(6)
    v_mfma_f32_32x32x16_bf16 v[32:47], v[52:55], v[212:215], v[32:47]
    ds_read_b64_tr_b16 v[52:53], v5 offset:35328
    ds_read_b64_tr_b16 v[54:55], v5 offset:35584
    s_waitcnt lgkmcnt(6)
    v_mfma_f32_32x32x16_bf16 v[32:47], v[56:59], v[216:219], v[32:47]
    ds_read_b64_tr_b16 v[56:57], v5 offset:37376
    ds_read_b64_tr_b16 v[58:59], v5 offset:37632
    s_waitcnt lgkmcnt(6)
    v_mfma_f32_32x32x16_bf16 v[32:47], v[60:63], v[220:223], v[32:47]
    ds_read_b64_tr_b16 v[60:61], v5 offset:39424
    ds_read_b64_tr_b16 v[62:63], v5 offset:39680
    s_waitcnt lgkmcnt(6)
    v_mfma_f32_32x32x16_bf16 v[32:47], v[48:51], v[224:227], v[32:47]
    s_waitcnt lgkmcnt(4)
    v_mfma_f32_32x32x16_bf16 v[32:47], v[52:55], v[228:231], v[32:47]
    s_waitcnt lgkmcnt(2)
    v_mfma_f32_32x32x16_bf16 v[32:47], v[56:59], v[232:235], v[32:47]
    s_waitcnt lgkmcnt(0)
    v_mfma_f32_32x32x16_bf16 v[32:47], v[60:63], v[236:239], v[32:47]
    s_setprio 0
    s_nop 10
    s_cmp_lg_u32 s7, 0
    s_cbranch_scc1 p1w_73
p1poll_74:
    s_waitcnt vmcnt(0)
    v_cmp_ne_u64 vcc, s[100:101], v[250:251]
    s_cbranch_vccz p1go_75
    s_sleep 4
    s_lshl_b32 s26, s24, 12
    s_add_u32 s26, s26, 2490368
    v_lshlrev_b32 v247, 3, v12
    buffer_load_dwordx2 v[250:251], v247, s[8:11], s26 offen sc1
    s_sub_u32 s39, s39, 1
    s_cmp_gt_i32 s39, 0
    s_cbranch_scc1 p1poll_74
    s_waitcnt vmcnt(0)
p1go_75:
    s_lshl_b32 s26, s24, 13
    s_add_u32 s26, s26, 2752512
    s_add_u32 s28, s26, 4096
    s_cmp_eq_u32 s6, 1
    s_cbranch_scc1 p1a_76
    buffer_load_dwordx4 v[80:83], v245, s[8:11], s26 offen offset:0 sc1
    buffer_load_dwordx4 v[84:87], v245, s[8:11], s26 offen offset:1024 sc1
    buffer_load_dwordx4 v[88:91], v245, s[8:11], s26 offen offset:2048 sc1
    buffer_load_dwordx4 v[92:95], v245, s[8:11], s26 offen offset:3072 sc1
    buffer_load_dwordx4 v[48:51], v245, s[8:11], s28 offen offset:0 sc1
    buffer_load_dwordx4 v[52:55], v245, s[8:11], s28 offen offset:1024 sc1
    buffer_load_dwordx4 v[56:59], v245, s[8:11], s28 offen offset:2048 sc1
    buffer_load_dwordx4 v[60:63], v245, s[8:11], s28 offen offset:3072 sc1
    s_branch p1j_77
p1a_76:
    buffer_load_dwordx4 v[88:91], v245, s[8:11], s26 offen offset:0 sc1
    buffer_load_dwordx4 v[92:95], v245, s[8:11], s26 offen offset:1024 sc1
    buffer_load_dwordx4 v[16:19], v245, s[8:11], s26 offen offset:2048 sc1
    buffer_load_dwordx4 v[20:23], v245, s[8:11], s26 offen offset:3072 sc1
    buffer_load_dwordx4 v[48:51], v245, s[8:11], s28 offen offset:0 sc1
    buffer_load_dwordx4 v[52:55], v245, s[8:11], s28 offen offset:1024 sc1
    buffer_load_dwordx4 v[56:59], v245, s[8:11], s28 offen offset:2048 sc1
    buffer_load_dwordx4 v[60:63], v245, s[8:11], s28 offen offset:3072 sc1
p1j_77:
p1w_73:
    s_cmp_lg_u32 s23, 0
    s_cbranch_scc1 p1x_78
    s_cmp_lg_u32 s7, 4
    s_cbranch_scc1 p1w_79
    s_waitcnt vmcnt(0)
p1w_79:
    s_mov_b64 exec, 1
    ds_add_u32 v242, v243 offset:12
    s_mov_b64 exec, -1
p1x_78:
    s_cmp_ge_u32 s21, 8
    s_cbranch_scc1 p1a_80
    v_mul_f32 v16, v32, v32
    v_mul_f32 v17, v33, v33
    v_mul_f32 v18, v34, v34
    v_mul_f32 v19, v35, v35
    v_mul_f32 v20, v36, v36
    v_mul_f32 v21, v37, v37
    v_mul_f32 v22, v38, v38
    v_mul_f32 v23, v39, v39
    v_fmaak_f32 v16, v16, v9, 0xc0135761
    v_fmaak_f32 v17, v17, v9, 0xc0135761
    v_fmaak_f32 v18, v18, v9, 0xc0135761
    v_fmaak_f32 v19, v19, v9, 0xc0135761
    v_fmaak_f32 v20, v20, v9, 0xc0135761
    v_fmaak_f32 v21, v21, v9, 0xc0135761
    v_fmaak_f32 v22, v22, v9, 0xc0135761
    v_fmaak_f32 v23, v23, v9, 0xc0135761
    v_mul_f32 v16, v16, v32
    v_mul_f32 v17, v17, v33
    v_mul_f32 v18, v18, v34
    v_mul_f32 v19, v19, v35
    v_mul_f32 v20, v20, v36
    v_mul_f32 v21, v21, v37
    v_mul_f32 v22, v22, v38
    v_mul_f32 v23, v23, v39
    v_exp_f32 v16, v16
    v_exp_f32 v17, v17
    v_exp_f32 v18, v18
    v_exp_f32 v19, v19
    v_exp_f32 v20, v20
    v_exp_f32 v21, v21
    v_exp_f32 v22, v22
    v_exp_f32 v23, v23
    v_add_f32 v16, 1.0, v16
    v_add_f32 v17, 1.0, v17
    v_add_f32 v18, 1.0, v18
    v_add_f32 v19, 1.0, v19
    v_add_f32 v20, 1.0, v20
    v_add_f32 v21, 1.0, v21
    v_add_f32 v22, 1.0, v22
    v_add_f32 v23, 1.0, v23
    v_rcp_f32 v16, v16
    v_rcp_f32 v17, v17
    v_rcp_f32 v18, v18
    v_rcp_f32 v19, v19
    v_rcp_f32 v20, v20
    v_rcp_f32 v21, v21
    v_rcp_f32 v22, v22
    v_rcp_f32 v23, v23
    v_mul_f32 v32, v32, v16
    v_mul_f32 v33, v33, v17
    v_mul_f32 v34, v34, v18
    v_mul_f32 v35, v35, v19
    v_mul_f32 v36, v36, v20
    v_mul_f32 v37, v37, v21
    v_mul_f32 v38, v38, v22
    v_mul_f32 v39, v39, v23
    v_cvt_pk_bf16_f32 v24, v32, v33
    v_cvt_pk_bf16_f32 v25, v34, v35
    v_cvt_pk_bf16_f32 v26, v36, v37
    v_cvt_pk_bf16_f32 v27, v38, v39
    v_mul_f32 v16, v40, v40
    v_mul_f32 v17, v41, v41
    v_mul_f32 v18, v42, v42
    v_mul_f32 v19, v43, v43
    v_mul_f32 v20, v44, v44
    v_mul_f32 v21, v45, v45
    v_mul_f32 v22, v46, v46
    v_mul_f32 v23, v47, v47
    v_fmaak_f32 v16, v16, v9, 0xc0135761
    v_fmaak_f32 v17, v17, v9, 0xc0135761
    v_fmaak_f32 v18, v18, v9, 0xc0135761
    v_fmaak_f32 v19, v19, v9, 0xc0135761
    v_fmaak_f32 v20, v20, v9, 0xc0135761
    v_fmaak_f32 v21, v21, v9, 0xc0135761
    v_fmaak_f32 v22, v22, v9, 0xc0135761
    v_fmaak_f32 v23, v23, v9, 0xc0135761
    v_mul_f32 v16, v16, v40
    v_mul_f32 v17, v17, v41
    v_mul_f32 v18, v18, v42
    v_mul_f32 v19, v19, v43
    v_mul_f32 v20, v20, v44
    v_mul_f32 v21, v21, v45
    v_mul_f32 v22, v22, v46
    v_mul_f32 v23, v23, v47
    v_exp_f32 v16, v16
    v_exp_f32 v17, v17
    v_exp_f32 v18, v18
    v_exp_f32 v19, v19
    v_exp_f32 v20, v20
    v_exp_f32 v21, v21
    v_exp_f32 v22, v22
    v_exp_f32 v23, v23
    v_add_f32 v16, 1.0, v16
    v_add_f32 v17, 1.0, v17
    v_add_f32 v18, 1.0, v18
    v_add_f32 v19, 1.0, v19
    v_add_f32 v20, 1.0, v20
    v_add_f32 v21, 1.0, v21
    v_add_f32 v22, 1.0, v22
    v_add_f32 v23, 1.0, v23
    v_rcp_f32 v16, v16
    v_rcp_f32 v17, v17
    v_rcp_f32 v18, v18
    v_rcp_f32 v19, v19
    v_rcp_f32 v20, v20
    v_rcp_f32 v21, v21
    v_rcp_f32 v22, v22
    v_rcp_f32 v23, v23
    v_mul_f32 v40, v40, v16
    v_mul_f32 v41, v41, v17
    v_mul_f32 v42, v42, v18
    v_mul_f32 v43, v43, v19
    v_mul_f32 v44, v44, v20
    v_mul_f32 v45, v45, v21
    v_mul_f32 v46, v46, v22
    v_mul_f32 v47, v47, v23
    v_cvt_pk_bf16_f32 v28, v40, v41
    v_cvt_pk_bf16_f32 v29, v42, v43
    v_cvt_pk_bf16_f32 v30, v44, v45
    v_cvt_pk_bf16_f32 v31, v46, v47
    s_cmp_lg_u32 s7, 0
    s_cbranch_scc1 p1w_82
    s_waitcnt vmcnt(0)
    s_lshl_b32 s27, s22, 10
    s_add_u32 s27, s27, 147456
    v_add_u32 v244, s27, v245
    s_cmp_eq_u32 s6, 1
    s_cbranch_scc1 p1a_83
    v_add_f32 v80, v80, v84
    v_add_f32 v81, v81, v85
    v_add_f32 v82, v82, v86
    v_add_f32 v83, v83, v87
    v_add_f32 v88, v88, v92
    v_add_f32 v89, v89, v93
    v_add_f32 v90, v90, v94
    v_add_f32 v91, v91, v95
    v_add_f32 v48, v48, v52
    v_add_f32 v49, v49, v53
    v_add_f32 v50, v50, v54
    v_add_f32 v51, v51, v55
    v_add_f32 v56, v56, v60
    v_add_f32 v57, v57, v61
    v_add_f32 v58, v58, v62
    v_add_f32 v59, v59, v63
    v_add_f32 v80, v80, v88
    v_add_f32 v48, v48, v56
    v_add_f32 v81, v81, v89
    v_add_f32 v49, v49, v57
    v_add_f32 v82, v82, v90
    v_add_f32 v50, v50, v58
    v_add_f32 v83, v83, v91
    v_add_f32 v51, v51, v59
    v_add_f32 v80, v80, v48
    v_add_f32 v81, v81, v49
    v_add_f32 v82, v82, v50
    v_add_f32 v83, v83, v51
    ds_write_b128 v244, v[80:83]
    s_branch p1j_84
p1a_83:
    v_add_f32 v88, v88, v92
    v_add_f32 v89, v89, v93
    v_add_f32 v90, v90, v94
    v_add_f32 v91, v91, v95
    v_add_f32 v16, v16, v20
    v_add_f32 v17, v17, v21
    v_add_f32 v18, v18, v22
    v_add_f32 v19, v19, v23
    v_add_f32 v48, v48, v52
    v_add_f32 v49, v49, v53
    v_add_f32 v50, v50, v54
    v_add_f32 v51, v51, v55
    v_add_f32 v56, v56, v60
    v_add_f32 v57, v57, v61
    v_add_f32 v58, v58, v62
    v_add_f32 v59, v59, v63
    v_add_f32 v88, v88, v16
    v_add_f32 v48, v48, v56
    v_add_f32 v89, v89, v17
    v_add_f32 v49, v49, v57
    v_add_f32 v90, v90, v18
    v_add_f32 v50, v50, v58
    v_add_f32 v91, v91, v19
    v_add_f32 v51, v51, v59
    v_add_f32 v88, v88, v48
    v_add_f32 v89, v89, v49
    v_add_f32 v90, v90, v50
    v_add_f32 v91, v91, v51
    ds_write_b128 v244, v[88:91]
p1j_84:
p1w_82:
    s_cmp_lg_u32 s7, 2
    s_cbranch_scc1 p1w_85
    s_waitcnt vmcnt(0)
    s_lshl_b32 s27, s22, 10
    s_add_u32 s27, s27, 147456
    v_add_u32 v244, s27, v245
    v_add_f32 v96, v96, v100
    v_add_f32 v97, v97, v101
    v_add_f32 v98, v98, v102
    v_add_f32 v99, v99, v103
    v_add_f32 v104, v104, v108
    v_add_f32 v105, v105, v109
    v_add_f32 v106, v106, v110
    v_add_f32 v107, v107, v111
    v_add_f32 v112, v112, v116
    v_add_f32 v113, v113, v117
    v_add_f32 v114, v114, v118
    v_add_f32 v115, v115, v119
    v_add_f32 v120, v120, v124
    v_add_f32 v121, v121, v125
    v_add_f32 v122, v122, v126
    v_add_f32 v123, v123, v127
    v_add_f32 v96, v96, v104
    v_add_f32 v112, v112, v120
    v_add_f32 v97, v97, v105
    v_add_f32 v113, v113, v121
    v_add_f32 v98, v98, v106
    v_add_f32 v114, v114, v122
    v_add_f32 v99, v99, v107
    v_add_f32 v115, v115, v123
    v_add_f32 v96, v96, v112
    v_add_f32 v97, v97, v113
    v_add_f32 v98, v98, v114
    v_add_f32 v99, v99, v115
    ds_write_b128 v244, v[96:99]
p1w_85:
    s_lshl_b32 s26, s33, 5
    s_add_u32 s26, s26, s32
    buffer_store_dwordx4 v[24:27], v8, s[8:11], s26 offen offset:1024 sc1
    buffer_store_dwordx4 v[28:31], v8, s[8:11], s26 offen offset:1536 sc1
    s_branch p1j_81
p1a_80:
    v_mul_f32 v32, s34, v32
    v_mul_f32 v33, s34, v33
    v_mul_f32 v34, s34, v34
    v_mul_f32 v35, s34, v35
    v_mul_f32 v36, s34, v36
    v_mul_f32 v37, s34, v37
    v_mul_f32 v38, s34, v38
    v_mul_f32 v39, s34, v39
    v_mul_f32 v40, s34, v40
    v_mul_f32 v41, s34, v41
    v_mul_f32 v42, s34, v42
    v_mul_f32 v43, s34, v43
    v_mul_f32 v44, s34, v44
    v_mul_f32 v45, s34, v45
    v_mul_f32 v46, s34, v46
    v_mul_f32 v47, s34, v47
    v_cvt_pk_bf16_f32 v24, v32, v33
    v_cvt_pk_bf16_f32 v25, v34, v35
    v_cvt_pk_bf16_f32 v26, v36, v37
    v_cvt_pk_bf16_f32 v27, v38, v39
    v_cvt_pk_bf16_f32 v28, v40, v41
    v_cvt_pk_bf16_f32 v29, v42, v43
    v_cvt_pk_bf16_f32 v30, v44, v45
    v_cvt_pk_bf16_f32 v31, v46, v47
    s_cmp_lg_u32 s7, 0
    s_cbranch_scc1 p1w_86
    s_waitcnt vmcnt(0)
    s_lshl_b32 s27, s22, 10
    s_add_u32 s27, s27, 147456
    v_add_u32 v244, s27, v245
    s_cmp_eq_u32 s6, 1
    s_cbranch_scc1 p1a_87
    v_add_f32 v80, v80, v84
    v_add_f32 v81, v81, v85
    v_add_f32 v82, v82, v86
    v_add_f32 v83, v83, v87
    v_add_f32 v88, v88, v92
    v_add_f32 v89, v89, v93
    v_add_f32 v90, v90, v94
    v_add_f32 v91, v91, v95
    v_add_f32 v48, v48, v52
    v_add_f32 v49, v49, v53
    v_add_f32 v50, v50, v54
    v_add_f32 v51, v51, v55
    v_add_f32 v56, v56, v60
    v_add_f32 v57, v57, v61
    v_add_f32 v58, v58, v62
    v_add_f32 v59, v59, v63
    v_add_f32 v80, v80, v88
    v_add_f32 v48, v48, v56
    v_add_f32 v81, v81, v89
    v_add_f32 v49, v49, v57
    v_add_f32 v82, v82, v90
    v_add_f32 v50, v50, v58
    v_add_f32 v83, v83, v91
    v_add_f32 v51, v51, v59
    v_add_f32 v80, v80, v48
    v_add_f32 v81, v81, v49
    v_add_f32 v82, v82, v50
    v_add_f32 v83, v83, v51
    ds_write_b128 v244, v[80:83]
    s_branch p1j_88
p1a_87:
    v_add_f32 v88, v88, v92
    v_add_f32 v89, v89, v93
    v_add_f32 v90, v90, v94
    v_add_f32 v91, v91, v95
    v_add_f32 v16, v16, v20
    v_add_f32 v17, v17, v21
    v_add_f32 v18, v18, v22
    v_add_f32 v19, v19, v23
    v_add_f32 v48, v48, v52
    v_add_f32 v49, v49, v53
    v_add_f32 v50, v50, v54
    v_add_f32 v51, v51, v55
    v_add_f32 v56, v56, v60
    v_add_f32 v57, v57, v61
    v_add_f32 v58, v58, v62
    v_add_f32 v59, v59, v63
    v_add_f32 v88, v88, v16
    v_add_f32 v48, v48, v56
    v_add_f32 v89, v89, v17
    v_add_f32 v49, v49, v57
    v_add_f32 v90, v90, v18
    v_add_f32 v50, v50, v58
    v_add_f32 v91, v91, v19
    v_add_f32 v51, v51, v59
    v_add_f32 v88, v88, v48
    v_add_f32 v89, v89, v49
    v_add_f32 v90, v90, v50
    v_add_f32 v91, v91, v51
    ds_write_b128 v244, v[88:91]
p1j_88:
p1w_86:
    s_cmp_lg_u32 s7, 2
    s_cbranch_scc1 p1w_89
    s_waitcnt vmcnt(0)
    s_lshl_b32 s27, s22, 10
    s_add_u32 s27, s27, 147456
    v_add_u32 v244, s27, v245
    v_add_f32 v96, v96, v100
    v_add_f32 v97, v97, v101
    v_add_f32 v98, v98, v102
    v_add_f32 v99, v99, v103
    v_add_f32 v104, v104, v108
    v_add_f32 v105, v105, v109
    v_add_f32 v106, v106, v110
    v_add_f32 v107, v107, v111
    v_add_f32 v112, v112, v116
    v_add_f32 v113, v113, v117
    v_add_f32 v114, v114, v118
    v_add_f32 v115, v115, v119
    v_add_f32 v120, v120, v124
    v_add_f32 v121, v121, v125
    v_add_f32 v122, v122, v126
    v_add_f32 v123, v123, v127
    v_add_f32 v96, v96, v104
    v_add_f32 v112, v112, v120
    v_add_f32 v97, v97, v105
    v_add_f32 v113, v113, v121
    v_add_f32 v98, v98, v106
    v_add_f32 v114, v114, v122
    v_add_f32 v99, v99, v107
    v_add_f32 v115, v115, v123
    v_add_f32 v96, v96, v112
    v_add_f32 v97, v97, v113
    v_add_f32 v98, v98, v114
    v_add_f32 v99, v99, v115
    ds_write_b128 v244, v[96:99]
p1w_89:
    buffer_store_dwordx4 v[24:27], v245, s[8:11], s35 offen offset:2048 sc1
    buffer_store_dwordx4 v[28:31], v245, s[8:11], s35 offen offset:3072 sc1
p1j_81:
    s_branch p1e2_52
p1v_51:
    s_mov_b64 vcc, s[54:55]
    s_cbranch_vccz p1n_90
    s_setprio 1
    ds_read_b64_tr_b16 v[48:49], v4 offset:0
    ds_read_b64_tr_b16 v[50:51], v4 offset:256
    ds_read_b64_tr_b16 v[52:53], v4 offset:2048
    ds_read_b64_tr_b16 v[54:55], v4 offset:2304
    ds_read_b64_tr_b16 v[56:57], v4 offset:4096
    ds_read_b64_tr_b16 v[58:59], v4 offset:4352
    ds_read_b64_tr_b16 v[60:61], v4 offset:6144
    ds_read_b64_tr_b16 v[62:63], v4 offset:6400
    buffer_load_dwordx4 v241, s[48:51], s29 offen lds
    s_add_u32 s29, s29, s30
    s_add_u32 m0, m0, 1024
    s_waitcnt lgkmcnt(6)
    v_mfma_f32_32x32x16_bf16 v[32:47], v[96:99], v[48:51], 0
    ds_read_b64_tr_b16 v[48:49], v4 offset:8192
    ds_read_b64_tr_b16 v[50:51], v4 offset:8448
    s_waitcnt lgkmcnt(6)
    v_mfma_f32_32x32x16_bf16 v[32:47], v[100:103], v[52:55], v[32:47]
    ds_read_b64_tr_b16 v[52:53], v4 offset:10240
    ds_read_b64_tr_b16 v[54:55], v4 offset:10496
    buffer_load_dwordx4 v241, s[48:51], s29 offen lds
    s_add_u32 s29, s29, s30
    s_add_u32 m0, m0, 1024
    s_waitcnt lgkmcnt(6)
    v_mfma_f32_32x32x16_bf16 v[32:47], v[104:107], v[56:59], v[32:47]
    ds_read_b64_tr_b16 v[56:57], v4 offset:12288
    ds_read_b64_tr_b16 v[58:59], v4 offset:12544
    s_waitcnt lgkmcnt(6)
    v_mfma_f32_32x32x16_bf16 v[32:47], v[108:111], v[60:63], v[32:47]
    ds_read_b64_tr_b16 v[60:61], v4 offset:14336
    ds_read_b64_tr_b16 v[62:63], v4 offset:14592
    buffer_load_dwordx4 v241, s[48:51], s29 offen lds
    s_add_u32 s29, s29, s30
    s_add_u32 m0, m0, 1024
    s_waitcnt lgkmcnt(6)
    v_mfma_f32_32x32x16_bf16 v[32:47], v[112:115], v[48:51], v[32:47]
    ds_read_b64_tr_b16 v[48:49], v4 offset:16384
    ds_read_b64_tr_b16 v[50:51], v4 offset:16640
    s_waitcnt lgkmcnt(6)
    v_mfma_f32_32x32x16_bf16 v[32:47], v[116:119], v[52:55], v[32:47]
    ds_read_b64_tr_b16 v[52:53], v4 offset:18432
    ds_read_b64_tr_b16 v[54:55], v4 offset:18688
    buffer_load_dwordx4 v241, s[48:51], s29 offen lds
    s_add_u32 s29, s29, s30
    s_add_u32 m0, m0, 1024
    s_waitcnt lgkmcnt(6)
    v_mfma_f32_32x32x16_bf16 v[32:47], v[120:123], v[56:59], v[32:47]
    ds_read_b64_tr_b16 v[56:57], v4 offset:20480
    ds_read_b64_tr_b16 v[58:59], v4 offset:20736
    s_waitcnt lgkmcnt(6)
    v_mfma_f32_32x32x16_bf16 v[32:47], v[124:127], v[60:63], v[32:47]
    ds_read_b64_tr_b16 v[60:61], v4 offset:22528
    ds_read_b64_tr_b16 v[62:63], v4 offset:22784
    buffer_load_dwordx4 v241, s[48:51], s29 offen lds
    s_add_u32 s29, s29, s30
    s_add_u32 m0, m0, 1024
    s_waitcnt lgkmcnt(6)
    v_mfma_f32_32x32x16_bf16 v[32:47], v[128:131], v[48:51], v[32:47]
    ds_read_b64_tr_b16 v[48:49], v4 offset:24576
    ds_read_b64_tr_b16 v[50:51], v4 offset:24832
    s_waitcnt lgkmcnt(6)
    v_mfma_f32_32x32x16_bf16 v[32:47], v[132:135], v[52:55], v[32:47]
    ds_read_b64_tr_b16 v[52:53], v4 offset:26624
    ds_read_b64_tr_b16 v[54:55], v4 offset:26880
    buffer_load_dwordx4 v241, s[48:51], s29 offen lds
    s_add_u32 s29, s29, s30
    s_add_u32 m0, m0, 1024
    s_setprio 2
    s_waitcnt lgkmcnt(6)
    v_mfma_f32_32x32x16_bf16 v[32:47], v[136:139], v[56:59], v[32:47]
    ds_read_b64_tr_b16 v[56:57], v4 offset:28672
    ds_read_b64_tr_b16 v[58:59], v4 offset:28928
    s_waitcnt lgkmcnt(6)
    v_mfma_f32_32x32x16_bf16 v[32:47], v[140:143], v[60:63], v[32:47]
    ds_read_b64_tr_b16 v[60:61], v4 offset:30720
    ds_read_b64_tr_b16 v[62:63], v4 offset:30976
    buffer_load_dwordx4 v241, s[48:51], s29 offen lds
    s_add_u32 s29, s29, s30
    s_add_u32 m0, m0, 1024
    s_waitcnt lgkmcnt(6)
    v_mfma_f32_32x32x16_bf16 v[32:47], v[144:147], v[48:51], v[32:47]
    ds_read_b64_tr_b16 v[48:49], v5 offset:0
    ds_read_b64_tr_b16 v[50:51], v5 offset:256
    s_waitcnt lgkmcnt(6)
    v_mfma_f32_32x32x16_bf16 v[32:47], v[148:151], v[52:55], v[32:47]
    ds_read_b64_tr_b16 v[52:53], v5 offset:2048
    ds_read_b64_tr_b16 v[54:55], v5 offset:2304
    buffer_load_dwordx4 v241, s[48:51], s29 offen lds
    s_add_u32 s29, s29, s30
    s_add_u32 m0, m0, 1024
    s_waitcnt lgkmcnt(6)
    v_mfma_f32_32x32x16_bf16 v[32:47], v[152:155], v[56:59], v[32:47]
    ds_read_b64_tr_b16 v[56:57], v5 offset:4096
    ds_read_b64_tr_b16 v[58:59], v5 offset:4352
    s_waitcnt lgkmcnt(6)
    v_mfma_f32_32x32x16_bf16 v[32:47], v[156:159], v[60:63], v[32:47]
    ds_read_b64_tr_b16 v[60:61], v5 offset:6144
    ds_read_b64_tr_b16 v[62:63], v5 offset:6400
    buffer_load_dwordx4 v241, s[48:51], s29 offen lds
    s_add_u32 s29, s29, s30
    s_add_u32 m0, m0, 1024
    s_waitcnt lgkmcnt(6)
    v_mfma_f32_32x32x16_bf16 v[32:47], v[160:163], v[48:51], v[32:47]
    ds_read_b64_tr_b16 v[48:49], v5 offset:8192
    ds_read_b64_tr_b16 v[50:51], v5 offset:8448
    s_waitcnt lgkmcnt(6)
    v_mfma_f32_32x32x16_bf16 v[32:47], v[164:167], v[52:55], v[32:47]
    ds_read_b64_tr_b16 v[52:53], v5 offset:10240
    ds_read_b64_tr_b16 v[54:55], v5 offset:10496
    s_waitcnt lgkmcnt(6)
    v_mfma_f32_32x32x16_bf16 v[32:47], v[168:171], v[56:59], v[32:47]
    ds_read_b64_tr_b16 v[56:57], v5 offset:12288
    ds_read_b64_tr_b16 v[58:59], v5 offset:12544
    s_waitcnt lgkmcnt(6)
    v_mfma_f32_32x32x16_bf16 v[32:47], v[172:175], v[60:63], v[32:47]
    ds_read_b64_tr_b16 v[60:61], v5 offset:14336
    ds_read_b64_tr_b16 v[62:63], v5 offset:14592
    s_setprio 3
    s_waitcnt lgkmcnt(6)
    v_mfma_f32_32x32x16_bf16 v[32:47], v[176:179], v[48:51], v[32:47]
    ds_read_b64_tr_b16 v[48:49], v5 offset:16384
    ds_read_b64_tr_b16 v[50:51], v5 offset:16640
    s_lshl_b32 s26, s24, 12
    s_add_u32 s26, s26, 2490368
    v_lshlrev_b32 v247, 3, v12
    buffer_load_dwordx2 v[250:251], v247, s[8:11], s26 offen sc1
    s_waitcnt lgkmcnt(6)
    v_mfma_f32_32x32x16_bf16 v[32:47], v[180:183], v[52:55], v[32:47]
    ds_read_b64_tr_b16 v[52:53], v5 offset:18432
    ds_read_b64_tr_b16 v[54:55], v5 offset:18688
    s_waitcnt lgkmcnt(6)
    v_mfma_f32_32x32x16_bf16 v[32:47], v[184:187], v[56:59], v[32:47]
    ds_read_b64_tr_b16 v[56:57], v5 offset:20480
    ds_read_b64_tr_b16 v[58:59], v5 offset:20736
    s_waitcnt lgkmcnt(6)
    v_mfma_f32_32x32x16_bf16 v[32:47], v[188:191], v[60:63], v[32:47]
    ds_read_b64_tr_b16 v[60:61], v5 offset:22528
    ds_read_b64_tr_b16 v[62:63], v5 offset:22784
    s_waitcnt lgkmcnt(6)
    v_mfma_f32_32x32x16_bf16 v[32:47], v[192:195], v[48:51], v[32:47]
    ds_read_b64_tr_b16 v[48:49], v5 offset:24576
    ds_read_b64_tr_b16 v[50:51], v5 offset:24832
    s_waitcnt lgkmcnt(6)
    v_mfma_f32_32x32x16_bf16 v[32:47], v[196:199], v[52:55], v[32:47]
    ds_read_b64_tr_b16 v[52:53], v5 offset:26624
    ds_read_b64_tr_b16 v[54:55], v5 offset:26880
    s_waitcnt lgkmcnt(6)
    v_mfma_f32_32x32x16_bf16 v[32:47], v[200:203], v[56:59], v[32:47]
    ds_read_b64_tr_b16 v[56:57], v5 offset:28672
    ds_read_b64_tr_b16 v[58:59], v5 offset:28928
    s_waitcnt lgkmcnt(6)
    v_mfma_f32_32x32x16_bf16 v[32:47], v[204:207], v[60:63], v[32:47]
    ds_read_b64_tr_b16 v[60:61], v5 offset:30720
    ds_read_b64_tr_b16 v[62:63], v5 offset:30976
    s_waitcnt lgkmcnt(6)
    v_mfma_f32_32x32x16_bf16 v[32:47], v[208:211], v[48:51], v[32:47]
    ds_read_b64_tr_b16 v[48:49], v5 offset:32768
    ds_read_b64_tr_b16 v[50:51], v5 offset:33024
    s_waitcnt lgkmcnt(6)
    v_mfma_f32_32x32x16_bf16 v[32:47], v[212:215], v[52:55], v[32:47]
    ds_read_b64_tr_b16 v[52:53], v5 offset:34816
    ds_read_b64_tr_b16 v[54:55], v5 offset:35072
    s_waitcnt lgkmcnt(6)
    v_mfma_f32_32x32x16_bf16 v[32:47], v[216:219], v[56:59], v[32:47]
    ds_read_b64_tr_b16 v[56:57], v5 offset:36864
    ds_read_b64_tr_b16 v[58:59], v5 offset:37120
    s_waitcnt lgkmcnt(6)
    v_mfma_f32_32x32x16_bf16 v[32:47], v[220:223], v[60:63], v[32:47]
    ds_read_b64_tr_b16 v[60:61], v5 offset:38912
    ds_read_b64_tr_b16 v[62:63], v5 offset:39168
    s_waitcnt lgkmcnt(6)
    v_mfma_f32_32x32x16_bf16 v[32:47], v[224:227], v[48:51], v[32:47]
    s_waitcnt lgkmcnt(4)
    v_mfma_f32_32x32x16_bf16 v[32:47], v[228:231], v[52:55], v[32:47]
    s_waitcnt lgkmcnt(2)
    v_mfma_f32_32x32x16_bf16 v[32:47], v[232:235], v[56:59], v[32:47]
    s_waitcnt lgkmcnt(0)
    v_mfma_f32_32x32x16_bf16 v[32:47], v[236:239], v[60:63], v[32:47]
    s_setprio 0
    s_nop 10
    s_branch p1e_91
p1n_90:
    s_setprio 1
    ds_read_b64_tr_b16 v[48:49], v4 offset:0
    ds_read_b64_tr_b16 v[50:51], v4 offset:256
    ds_read_b64_tr_b16 v[52:53], v4 offset:2048
    ds_read_b64_tr_b16 v[54:55], v4 offset:2304
    ds_read_b64_tr_b16 v[56:57], v4 offset:4096
    ds_read_b64_tr_b16 v[58:59], v4 offset:4352
    ds_read_b64_tr_b16 v[60:61], v4 offset:6144
    ds_read_b64_tr_b16 v[62:63], v4 offset:6400
    s_waitcnt lgkmcnt(6)
    v_mfma_f32_32x32x16_bf16 v[32:47], v[96:99], v[48:51], 0
    ds_read_b64_tr_b16 v[48:49], v4 offset:8192
    ds_read_b64_tr_b16 v[50:51], v4 offset:8448
    s_waitcnt lgkmcnt(6)
    v_mfma_f32_32x32x16_bf16 v[32:47], v[100:103], v[52:55], v[32:47]
    ds_read_b64_tr_b16 v[52:53], v4 offset:10240
    ds_read_b64_tr_b16 v[54:55], v4 offset:10496
    s_waitcnt lgkmcnt(6)
    v_mfma_f32_32x32x16_bf16 v[32:47], v[104:107], v[56:59], v[32:47]
    ds_read_b64_tr_b16 v[56:57], v4 offset:12288
    ds_read_b64_tr_b16 v[58:59], v4 offset:12544
    s_waitcnt lgkmcnt(6)
    v_mfma_f32_32x32x16_bf16 v[32:47], v[108:111], v[60:63], v[32:47]
    ds_read_b64_tr_b16 v[60:61], v4 offset:14336
    ds_read_b64_tr_b16 v[62:63], v4 offset:14592
    s_waitcnt lgkmcnt(6)
    v_mfma_f32_32x32x16_bf16 v[32:47], v[112:115], v[48:51], v[32:47]
    ds_read_b64_tr_b16 v[48:49], v4 offset:16384
    ds_read_b64_tr_b16 v[50:51], v4 offset:16640
    s_waitcnt lgkmcnt(6)
    v_mfma_f32_32x32x16_bf16 v[32:47], v[116:119], v[52:55], v[32:47]
    ds_read_b64_tr_b16 v[52:53], v4 offset:18432
    ds_read_b64_tr_b16 v[54:55], v4 offset:18688
    s_waitcnt lgkmcnt(6)
    v_mfma_f32_32x32x16_bf16 v[32:47], v[120:123], v[56:59], v[32:47]
    ds_read_b64_tr_b16 v[56:57], v4 offset:20480
    ds_read_b64_tr_b16 v[58:59], v4 offset:20736
    s_waitcnt lgkmcnt(6)
    v_mfma_f32_32x32x16_bf16 v[32:47], v[124:127], v[60:63], v[32:47]
    ds_read_b64_tr_b16 v[60:61], v4 offset:22528
    ds_read_b64_tr_b16 v[62:63], v4 offset:22784
    s_waitcnt lgkmcnt(6)
    v_mfma_f32_32x32x16_bf16 v[32:47], v[128:131], v[48:51], v[32:47]
    ds_read_b64_tr_b16 v[48:49], v4 offset:24576
    ds_read_b64_tr_b16 v[50:51], v4 offset:24832
    s_waitcnt lgkmcnt(6)
    v_mfma_f32_32x32x16_bf16 v[32:47], v[132:135], v[52:55], v[32:47]
    ds_read_b64_tr_b16 v[52:53], v4 offset:26624
    ds_read_b64_tr_b16 v[54:55], v4 offset:26880
    s_setprio 2
    s_waitcnt lgkmcnt(6)
    v_mfma_f32_32x32x16_bf16 v[32:47], v[136:139], v[56:59], v[32:47]
    ds_read_b64_tr_b16 v[56:57], v4 offset:28672
    ds_read_b64_tr_b16 v[58:59], v4 offset:28928
    s_waitcnt lgkmcnt(6)
    v_mfma_f32_32x32x16_bf16 v[32:47], v[140:143], v[60:63], v[32:47]
    ds_read_b64_tr_b16 v[60:61], v4 offset:30720
    ds_read_b64_tr_b16 v[62:63], v4 offset:30976
    s_waitcnt lgkmcnt(6)
    v_mfma_f32_32x32x16_bf16 v[32:47], v[144:147], v[48:51], v[32:47]
    ds_read_b64_tr_b16 v[48:49], v5 offset:0
    ds_read_b64_tr_b16 v[50:51], v5 offset:256
    s_waitcnt lgkmcnt(6)
    v_mfma_f32_32x32x16_bf16 v[32:47], v[148:151], v[52:55], v[32:47]
    ds_read_b64_tr_b16 v[52:53], v5 offset:2048
    ds_read_b64_tr_b16 v[54:55], v5 offset:2304
    s_waitcnt lgkmcnt(6)
    v_mfma_f32_32x32x16_bf16 v[32:47], v[152:155], v[56:59], v[32:47]
    ds_read_b64_tr_b16 v[56:57], v5 offset:4096
    ds_read_b64_tr_b16 v[58:59], v5 offset:4352
    s_waitcnt lgkmcnt(6)
    v_mfma_f32_32x32x16_bf16 v[32:47], v[156:159], v[60:63], v[32:47]
    ds_read_b64_tr_b16 v[60:61], v5 offset:6144
    ds_read_b64_tr_b16 v[62:63], v5 offset:6400
    s_waitcnt lgkmcnt(6)
    v_mfma_f32_32x32x16_bf16 v[32:47], v[160:163], v[48:51], v[32:47]
    ds_read_b64_tr_b16 v[48:49], v5 offset:8192
    ds_read_b64_tr_b16 v[50:51], v5 offset:8448
    s_waitcnt lgkmcnt(6)
    v_mfma_f32_32x32x16_bf16 v[32:47], v[164:167], v[52:55], v[32:47]
    ds_read_b64_tr_b16 v[52:53], v5 offset:10240
    ds_read_b64_tr_b16 v[54:55], v5 offset:10496
    s_waitcnt lgkmcnt(6)
    v_mfma_f32_32x32x16_bf16 v[32:47], v[168:171], v[56:59], v[32:47]
    ds_read_b64_tr_b16 v[56:57], v5 offset:12288
    ds_read_b64_tr_b16 v[58:59], v5 offset:12544
    s_waitcnt lgkmcnt(6)
    v_mfma_f32_32x32x16_bf16 v[32:47], v[172:175], v[60:63], v[32:47]
    ds_read_b64_tr_b16 v[60:61], v5 offset:14336
    ds_read_b64_tr_b16 v[62:63], v5 offset:14592
    s_setprio 3
    s_waitcnt lgkmcnt(6)
    v_mfma_f32_32x32x16_bf16 v[32:47], v[176:179], v[48:51], v[32:47]
    ds_read_b64_tr_b16 v[48:49], v5 offset:16384
    ds_read_b64_tr_b16 v[50:51], v5 offset:16640
    s_lshl_b32 s26, s24, 12
    s_add_u32 s26, s26, 2490368
    v_lshlrev_b32 v247, 3, v12
    buffer_load_dwordx2 v[250:251], v247, s[8:11], s26 offen sc1
    s_waitcnt lgkmcnt(6)
    v_mfma_f32_32x32x16_bf16 v[32:47], v[180:183], v[52:55], v[32:47]
    ds_read_b64_tr_b16 v[52:53], v5 offset:18432
    ds_read_b64_tr_b16 v[54:55], v5 offset:18688
    s_waitcnt lgkmcnt(6)
    v_mfma_f32_32x32x16_bf16 v[32:47], v[184:187], v[56:59], v[32:47]
    ds_read_b64_tr_b16 v[56:57], v5 offset:20480
    ds_read_b64_tr_b16 v[58:59], v5 offset:20736
    s_waitcnt lgkmcnt(6)
    v_mfma_f32_32x32x16_bf16 v[32:47], v[188:191], v[60:63], v[32:47]
    ds_read_b64_tr_b16 v[60:61], v5 offset:22528
    ds_read_b64_tr_b16 v[62:63], v5 offset:22784
    s_waitcnt lgkmcnt(6)
    v_mfma_f32_32x32x16_bf16 v[32:47], v[192:195], v[48:51], v[32:47]
    ds_read_b64_tr_b16 v[48:49], v5 offset:24576
    ds_read_b64_tr_b16 v[50:51], v5 offset:24832
    s_waitcnt lgkmcnt(6)
    v_mfma_f32_32x32x16_bf16 v[32:47], v[196:199], v[52:55], v[32:47]
    ds_read_b64_tr_b16 v[52:53], v5 offset:26624
    ds_read_b64_tr_b16 v[54:55], v5 offset:26880
    s_waitcnt lgkmcnt(6)
    v_mfma_f32_32x32x16_bf16 v[32:47], v[200:203], v[56:59], v[32:47]
    ds_read_b64_tr_b16 v[56:57], v5 offset:28672
    ds_read_b64_tr_b16 v[58:59], v5 offset:28928
    s_waitcnt lgkmcnt(6)
    v_mfma_f32_32x32x16_bf16 v[32:47], v[204:207], v[60:63], v[32:47]
    ds_read_b64_tr_b16 v[60:61], v5 offset:30720
    ds_read_b64_tr_b16 v[62:63], v5 offset:30976
    s_waitcnt lgkmcnt(6)
    v_mfma_f32_32x32x16_bf16 v[32:47], v[208:211], v[48:51], v[32:47]
    ds_read_b64_tr_b16 v[48:49], v5 offset:32768
    ds_read_b64_tr_b16 v[50:51], v5 offset:33024
    s_waitcnt lgkmcnt(6)
    v_mfma_f32_32x32x16_bf16 v[32:47], v[212:215], v[52:55], v[32:47]
    ds_read_b64_tr_b16 v[52:53], v5 offset:34816
    ds_read_b64_tr_b16 v[54:55], v5 offset:35072
    s_waitcnt lgkmcnt(6)
    v_mfma_f32_32x32x16_bf16 v[32:47], v[216:219], v[56:59], v[32:47]
    ds_read_b64_tr_b16 v[56:57], v5 offset:36864
    ds_read_b64_tr_b16 v[58:59], v5 offset:37120
    s_waitcnt lgkmcnt(6)
    v_mfma_f32_32x32x16_bf16 v[32:47], v[220:223], v[60:63], v[32:47]
    ds_read_b64_tr_b16 v[60:61], v5 offset:38912
    ds_read_b64_tr_b16 v[62:63], v5 offset:39168
    s_waitcnt lgkmcnt(6)
    v_mfma_f32_32x32x16_bf16 v[32:47], v[224:227], v[48:51], v[32:47]
    s_waitcnt lgkmcnt(4)
    v_mfma_f32_32x32x16_bf16 v[32:47], v[228:231], v[52:55], v[32:47]
    s_waitcnt lgkmcnt(2)
    v_mfma_f32_32x32x16_bf16 v[32:47], v[232:235], v[56:59], v[32:47]
    s_waitcnt lgkmcnt(0)
    v_mfma_f32_32x32x16_bf16 v[32:47], v[236:239], v[60:63], v[32:47]
    s_setprio 0
    s_nop 10
p1e_91:
    s_waitcnt vmcnt(0)
    v_cmp_ne_u64 vcc, s[100:101], v[250:251]
    s_nop 0
    s_cmp_eq_u64 vcc, 0
    s_cselect_b32 s7, 1, 0
    s_lshl_b32 s7, s7, s23
    s_mul_i32 s25, s31, 2
    s_lshl_b32 s7, s7, s25
    s_cmp_lg_u32 s23, 1
    s_cbranch_scc1 p1g_92
    s_mov_b64 exec, 1
    ds_add_u32 v242, v243 offset:12
    s_mov_b64 exec, -1
p1g_92:
    s_cmp_lg_u32 s7, 1
    s_cbranch_scc1 p1w_93
    s_lshl_b32 s26, s24, 13
    s_add_u32 s26, s26, 2752512
    s_add_u32 s28, s26, 4096
    s_cmp_eq_u32 s6, 1
    s_cbranch_scc1 p1a_94
    buffer_load_dwordx4 v[80:83], v245, s[8:11], s26 offen offset:0 sc1
    buffer_load_dwordx4 v[84:87], v245, s[8:11], s26 offen offset:1024 sc1
    buffer_load_dwordx4 v[88:91], v245, s[8:11], s26 offen offset:2048 sc1
    buffer_load_dwordx4 v[92:95], v245, s[8:11], s26 offen offset:3072 sc1
    buffer_load_dwordx4 v[48:51], v245, s[8:11], s28 offen offset:0 sc1
    buffer_load_dwordx4 v[52:55], v245, s[8:11], s28 offen offset:1024 sc1
    buffer_load_dwordx4 v[56:59], v245, s[8:11], s28 offen offset:2048 sc1
    buffer_load_dwordx4 v[60:63], v245, s[8:11], s28 offen offset:3072 sc1
    s_branch p1j_95
p1a_94:
    buffer_load_dwordx4 v[88:91], v245, s[8:11], s26 offen offset:0 sc1
    buffer_load_dwordx4 v[92:95], v245, s[8:11], s26 offen offset:1024 sc1
    buffer_load_dwordx4 v[16:19], v245, s[8:11], s26 offen offset:2048 sc1
    buffer_load_dwordx4 v[20:23], v245, s[8:11], s26 offen offset:3072 sc1
    buffer_load_dwordx4 v[48:51], v245, s[8:11], s28 offen offset:0 sc1
    buffer_load_dwordx4 v[52:55], v245, s[8:11], s28 offen offset:1024 sc1
    buffer_load_dwordx4 v[56:59], v245, s[8:11], s28 offen offset:2048 sc1
    buffer_load_dwordx4 v[60:63], v245, s[8:11], s28 offen offset:3072 sc1
p1j_95:
p1w_93:
    s_cmp_eq_u32 s31, 0
    s_cbranch_scc1 p1x_96
p1fw_97:
    ds_read_b32 v244, v242 offset:20
    s_waitcnt lgkmcnt(0)
    v_readfirstlane_b32 s25, v244
    s_cmp_ge_u32 s25, 8
    s_cbranch_scc1 p1fd_98
    s_sleep 1
    s_sub_u32 s38, s38, 1
    s_cmp_gt_i32 s38, 0
    s_cbranch_scc1 p1fw_97
p1fd_98:
    buffer_load_dwordx4 v241, s[48:51], s29 offen lds
    s_add_u32 s29, s29, s30
    s_add_u32 m0, m0, 1024
    s_nop 0
    buffer_load_dwordx4 v241, s[48:51], s29 offen lds
    s_add_u32 s29, s29, s30
    s_add_u32 m0, m0, 1024
    s_nop 0
    buffer_load_dwordx4 v241, s[48:51], s29 offen lds
    s_add_u32 s29, s29, s30
    s_add_u32 m0, m0, 1024
    s_nop 0
    buffer_load_dwordx4 v241, s[48:51], s29 offen lds
    s_add_u32 s29, s29, s30
    s_add_u32 m0, m0, 1024
    s_nop 0
    buffer_load_dwordx4 v241, s[48:51], s29 offen lds
    s_add_u32 s29, s29, s30
    s_add_u32 m0, m0, 1024
    s_nop 0
    buffer_load_dwordx4 v241, s[48:51], s29 offen lds
    s_add_u32 s29, s29, s30
    s_add_u32 m0, m0, 1024
    s_nop 0
    buffer_load_dwordx4 v241, s[48:51], s29 offen lds
    s_add_u32 s29, s29, s30
    s_add_u32 m0, m0, 1024
    s_nop 0
    buffer_load_dwordx4 v241, s[48:51], s29 offen lds
    s_add_u32 s29, s29, s30
    s_add_u32 m0, m0, 1024
    s_nop 0
    buffer_load_dwordx4 v241, s[48:51], s29 offen lds
    s_add_u32 s29, s29, s30
    s_add_u32 m0, m0, 1024
p1x_96:
    v_cvt_pk_bf16_f32 v24, v32, v33
    v_cvt_pk_bf16_f32 v25, v34, v35
    v_cvt_pk_bf16_f32 v26, v36, v37
    v_cvt_pk_bf16_f32 v27, v38, v39
    v_cvt_pk_bf16_f32 v28, v40, v41
    v_cvt_pk_bf16_f32 v29, v42, v43
    v_cvt_pk_bf16_f32 v30, v44, v45
    v_cvt_pk_bf16_f32 v31, v46, v47
    v_mul_u32_u24 v16, 72, v13
    v_add_lshl_u32 v16, v16, v14, 4
    s_cmp_lg_u32 s7, 1
    s_cbranch_scc1 p1w_99
    s_waitcnt vmcnt(0)
    s_lshl_b32 s27, s22, 10
    s_add_u32 s27, s27, 147456
    v_add_u32 v244, s27, v245
    s_cmp_eq_u32 s6, 1
    s_cbranch_scc1 p1a_100
    v_add_f32 v80, v80, v84
    v_add_f32 v81, v81, v85
    v_add_f32 v82, v82, v86
    v_add_f32 v83, v83, v87
    v_add_f32 v88, v88, v92
    v_add_f32 v89, v89, v93
    v_add_f32 v90, v90, v94
    v_add_f32 v91, v91, v95
    v_add_f32 v48, v48, v52
    v_add_f32 v49, v49, v53
    v_add_f32 v50, v50, v54
    v_add_f32 v51, v51, v55
    v_add_f32 v56, v56, v60
    v_add_f32 v57, v57, v61
    v_add_f32 v58, v58, v62
    v_add_f32 v59, v59, v63
    v_add_f32 v80, v80, v88
    v_add_f32 v48, v48, v56
    v_add_f32 v81, v81, v89
    v_add_f32 v49, v49, v57
    v_add_f32 v82, v82, v90
    v_add_f32 v50, v50, v58
    v_add_f32 v83, v83, v91
    v_add_f32 v51, v51, v59
    v_add_f32 v80, v80, v48
    v_add_f32 v81, v81, v49
    v_add_f32 v82, v82, v50
    v_add_f32 v83, v83, v51
    ds_write_b128 v244, v[80:83]
    s_branch p1j_101
p1a_100:
    v_add_f32 v88, v88, v92
    v_add_f32 v89, v89, v93
    v_add_f32 v90, v90, v94
    v_add_f32 v91, v91, v95
    v_add_f32 v16, v16, v20
    v_add_f32 v17, v17, v21
    v_add_f32 v18, v18, v22
    v_add_f32 v19, v19, v23
    v_add_f32 v48, v48, v52
    v_add_f32 v49, v49, v53
    v_add_f32 v50, v50, v54
    v_add_f32 v51, v51, v55
    v_add_f32 v56, v56, v60
    v_add_f32 v57, v57, v61
    v_add_f32 v58, v58, v62
    v_add_f32 v59, v59, v63
    v_add_f32 v88, v88, v16
    v_add_f32 v48, v48, v56
    v_add_f32 v89, v89, v17
    v_add_f32 v49, v49, v57
    v_add_f32 v90, v90, v18
    v_add_f32 v50, v50, v58
    v_add_f32 v91, v91, v19
    v_add_f32 v51, v51, v59
    v_add_f32 v88, v88, v48
    v_add_f32 v89, v89, v49
    v_add_f32 v90, v90, v50
    v_add_f32 v91, v91, v51
    ds_write_b128 v244, v[88:91]
p1j_101:
p1w_99:
    s_mul_i32 s26, s24, 73728
    s_lshl_b32 s28, s33, 4
    s_add_u32 s26, s26, s28
    s_add_u32 s26, s26, 27299840
    s_add_u32 s28, s26, 18432
    buffer_store_dwordx4 v[24:27], v16, s[8:11], s26 offen offset:0 sc1
    buffer_store_dwordx4 v[28:31], v16, s[8:11], s28 offen offset:0 sc1
    s_mov_b32 s36, 1
    s_cmp_eq_u32 s7, 1
    s_cbranch_scc1 p1norm_50
p1ret_102:
    s_setprio 1
    ds_read_b64_tr_b16 v[48:49], v4 offset:512
    ds_read_b64_tr_b16 v[50:51], v4 offset:768
    ds_read_b64_tr_b16 v[52:53], v4 offset:2560
    ds_read_b64_tr_b16 v[54:55], v4 offset:2816
    ds_read_b64_tr_b16 v[56:57], v4 offset:4608
    ds_read_b64_tr_b16 v[58:59], v4 offset:4864
    ds_read_b64_tr_b16 v[60:61], v4 offset:6656
    ds_read_b64_tr_b16 v[62:63], v4 offset:6912
    s_waitcnt lgkmcnt(6)
    v_mfma_f32_32x32x16_bf16 v[32:47], v[96:99], v[48:51], 0
    ds_read_b64_tr_b16 v[48:49], v4 offset:8704
    ds_read_b64_tr_b16 v[50:51], v4 offset:8960
    s_waitcnt lgkmcnt(6)
    v_mfma_f32_32x32x16_bf16 v[32:47], v[100:103], v[52:55], v[32:47]
    ds_read_b64_tr_b16 v[52:53], v4 offset:10752
    ds_read_b64_tr_b16 v[54:55], v4 offset:11008
    s_waitcnt lgkmcnt(6)
    v_mfma_f32_32x32x16_bf16 v[32:47], v[104:107], v[56:59], v[32:47]
    ds_read_b64_tr_b16 v[56:57], v4 offset:12800
    ds_read_b64_tr_b16 v[58:59], v4 offset:13056
    s_waitcnt lgkmcnt(6)
    v_mfma_f32_32x32x16_bf16 v[32:47], v[108:111], v[60:63], v[32:47]
    ds_read_b64_tr_b16 v[60:61], v4 offset:14848
    ds_read_b64_tr_b16 v[62:63], v4 offset:15104
    s_waitcnt lgkmcnt(6)
    v_mfma_f32_32x32x16_bf16 v[32:47], v[112:115], v[48:51], v[32:47]
    ds_read_b64_tr_b16 v[48:49], v4 offset:16896
    ds_read_b64_tr_b16 v[50:51], v4 offset:17152
    s_waitcnt lgkmcnt(6)
    v_mfma_f32_32x32x16_bf16 v[32:47], v[116:119], v[52:55], v[32:47]
    ds_read_b64_tr_b16 v[52:53], v4 offset:18944
    ds_read_b64_tr_b16 v[54:55], v4 offset:19200
    s_waitcnt lgkmcnt(6)
    v_mfma_f32_32x32x16_bf16 v[32:47], v[120:123], v[56:59], v[32:47]
    ds_read_b64_tr_b16 v[56:57], v4 offset:20992
    ds_read_b64_tr_b16 v[58:59], v4 offset:21248
    s_waitcnt lgkmcnt(6)
    v_mfma_f32_32x32x16_bf16 v[32:47], v[124:127], v[60:63], v[32:47]
    ds_read_b64_tr_b16 v[60:61], v4 offset:23040
    ds_read_b64_tr_b16 v[62:63], v4 offset:23296
    s_waitcnt lgkmcnt(6)
    v_mfma_f32_32x32x16_bf16 v[32:47], v[128:131], v[48:51], v[32:47]
    ds_read_b64_tr_b16 v[48:49], v4 offset:25088
    ds_read_b64_tr_b16 v[50:51], v4 offset:25344
    s_cmp_lg_u32 s7, 2
    s_cbranch_scc1 p1m_104
    s_lshl_b32 s26, s24, 13
    s_add_u32 s26, s26, 2752512
    s_add_u32 s28, s26, 4096
    buffer_load_dwordx4 v[96:99], v245, s[8:11], s26 offen offset:0 sc1
    buffer_load_dwordx4 v[100:103], v245, s[8:11], s26 offen offset:1024 sc1
    buffer_load_dwordx4 v[104:107], v245, s[8:11], s26 offen offset:2048 sc1
    buffer_load_dwordx4 v[108:111], v245, s[8:11], s26 offen offset:3072 sc1
    buffer_load_dwordx4 v[112:115], v245, s[8:11], s28 offen offset:0 sc1
    buffer_load_dwordx4 v[116:119], v245, s[8:11], s28 offen offset:1024 sc1
    buffer_load_dwordx4 v[120:123], v245, s[8:11], s28 offen offset:2048 sc1
    buffer_load_dwordx4 v[124:127], v245, s[8:11], s28 offen offset:3072 sc1
p1m_104:
    s_waitcnt lgkmcnt(6)
    v_mfma_f32_32x32x16_bf16 v[32:47], v[132:135], v[52:55], v[32:47]
    ds_read_b64_tr_b16 v[52:53], v4 offset:27136
    ds_read_b64_tr_b16 v[54:55], v4 offset:27392
    s_setprio 2
    s_waitcnt lgkmcnt(6)
    v_mfma_f32_32x32x16_bf16 v[32:47], v[136:139], v[56:59], v[32:47]
    ds_read_b64_tr_b16 v[56:57], v4 offset:29184
    ds_read_b64_tr_b16 v[58:59], v4 offset:29440
    s_waitcnt lgkmcnt(6)
    v_mfma_f32_32x32x16_bf16 v[32:47], v[140:143], v[60:63], v[32:47]
    ds_read_b64_tr_b16 v[60:61], v4 offset:31232
    ds_read_b64_tr_b16 v[62:63], v4 offset:31488
    s_waitcnt lgkmcnt(6)
    v_mfma_f32_32x32x16_bf16 v[32:47], v[144:147], v[48:51], v[32:47]
    ds_read_b64_tr_b16 v[48:49], v5 offset:512
    ds_read_b64_tr_b16 v[50:51], v5 offset:768
    s_waitcnt lgkmcnt(6)
    v_mfma_f32_32x32x16_bf16 v[32:47], v[148:151], v[52:55], v[32:47]
    ds_read_b64_tr_b16 v[52:53], v5 offset:2560
    ds_read_b64_tr_b16 v[54:55], v5 offset:2816
    s_waitcnt lgkmcnt(6)
    v_mfma_f32_32x32x16_bf16 v[32:47], v[152:155], v[56:59], v[32:47]
    ds_read_b64_tr_b16 v[56:57], v5 offset:4608
    ds_read_b64_tr_b16 v[58:59], v5 offset:4864
    s_waitcnt lgkmcnt(6)
    v_mfma_f32_32x32x16_bf16 v[32:47], v[156:159], v[60:63], v[32:47]
    ds_read_b64_tr_b16 v[60:61], v5 offset:6656
    ds_read_b64_tr_b16 v[62:63], v5 offset:6912
    s_waitcnt lgkmcnt(6)
    v_mfma_f32_32x32x16_bf16 v[32:47], v[160:163], v[48:51], v[32:47]
    ds_read_b64_tr_b16 v[48:49], v5 offset:8704
    ds_read_b64_tr_b16 v[50:51], v5 offset:8960
    s_waitcnt lgkmcnt(6)
    v_mfma_f32_32x32x16_bf16 v[32:47], v[164:167], v[52:55], v[32:47]
    ds_read_b64_tr_b16 v[52:53], v5 offset:10752
    ds_read_b64_tr_b16 v[54:55], v5 offset:11008
    s_waitcnt lgkmcnt(6)
    v_mfma_f32_32x32x16_bf16 v[32:47], v[168:171], v[56:59], v[32:47]
    ds_read_b64_tr_b16 v[56:57], v5 offset:12800
    ds_read_b64_tr_b16 v[58:59], v5 offset:13056
    s_waitcnt lgkmcnt(6)
    v_mfma_f32_32x32x16_bf16 v[32:47], v[172:175], v[60:63], v[32:47]
    ds_read_b64_tr_b16 v[60:61], v5 offset:14848
    ds_read_b64_tr_b16 v[62:63], v5 offset:15104
    s_setprio 3
    s_waitcnt lgkmcnt(6)
    v_mfma_f32_32x32x16_bf16 v[32:47], v[176:179], v[48:51], v[32:47]
    ds_read_b64_tr_b16 v[48:49], v5 offset:16896
    ds_read_b64_tr_b16 v[50:51], v5 offset:17152
    s_cmp_lg_u32 s7, 0
    s_cbranch_scc1 p1m_103
    s_lshl_b32 s26, s24, 12
    s_add_u32 s26, s26, 2490368
    v_lshlrev_b32 v247, 3, v12
    buffer_load_dwordx2 v[250:251], v247, s[8:11], s26 offen sc1
p1m_103:
    s_waitcnt lgkmcnt(6)
    v_mfma_f32_32x32x16_bf16 v[32:47], v[180:183], v[52:55], v[32:47]
    ds_read_b64_tr_b16 v[52:53], v5 offset:18944
    ds_read_b64_tr_b16 v[54:55], v5 offset:19200
    s_waitcnt lgkmcnt(6)
    v_mfma_f32_32x32x16_bf16 v[32:47], v[184:187], v[56:59], v[32:47]
    ds_read_b64_tr_b16 v[56:57], v5 offset:20992
    ds_read_b64_tr_b16 v[58:59], v5 offset:21248
    s_waitcnt lgkmcnt(6)
    v_mfma_f32_32x32x16_bf16 v[32:47], v[188:191], v[60:63], v[32:47]
    ds_read_b64_tr_b16 v[60:61], v5 offset:23040
    ds_read_b64_tr_b16 v[62:63], v5 offset:23296
    s_waitcnt lgkmcnt(6)
    v_mfma_f32_32x32x16_bf16 v[32:47], v[192:195], v[48:51], v[32:47]
    ds_read_b64_tr_b16 v[48:49], v5 offset:25088
    ds_read_b64_tr_b16 v[50:51], v5 offset:25344
    s_waitcnt lgkmcnt(6)
    v_mfma_f32_32x32x16_bf16 v[32:47], v[196:199], v[52:55], v[32:47]
    ds_read_b64_tr_b16 v[52:53], v5 offset:27136
    ds_read_b64_tr_b16 v[54:55], v5 offset:27392
    s_waitcnt lgkmcnt(6)
    v_mfma_f32_32x32x16_bf16 v[32:47], v[200:203], v[56:59], v[32:47]
    ds_read_b64_tr_b16 v[56:57], v5 offset:29184
    ds_read_b64_tr_b16 v[58:59], v5 offset:29440
    s_waitcnt lgkmcnt(6)
    v_mfma_f32_32x32x16_bf16 v[32:47], v[204:207], v[60:63], v[32:47]
    ds_read_b64_tr_b16 v[60:61], v5 offset:31232
    ds_read_b64_tr_b16 v[62:63], v5 offset:31488
    s_waitcnt lgkmcnt(6)
    v_mfma_f32_32x32x16_bf16 v[32:47], v[208:211], v[48:51], v[32:47]
    ds_read_b64_tr_b16 v[48:49], v5 offset:33280
    ds_read_b64_tr_b16 v[50:51], v5 offset:33536
    s_waitcnt lgkmcnt(6)
    v_mfma_f32_32x32x16_bf16 v[32:47], v[212:215], v[52:55], v[32:47]
    ds_read_b64_tr_b16 v[52:53], v5 offset:35328
    ds_read_b64_tr_b16 v[54:55], v5 offset:35584
    s_waitcnt lgkmcnt(6)
    v_mfma_f32_32x32x16_bf16 v[32:47], v[216:219], v[56:59], v[32:47]
    ds_read_b64_tr_b16 v[56:57], v5 offset:37376
    ds_read_b64_tr_b16 v[58:59], v5 offset:37632
    s_waitcnt lgkmcnt(6)
    v_mfma_f32_32x32x16_bf16 v[32:47], v[220:223], v[60:63], v[32:47]
    ds_read_b64_tr_b16 v[60:61], v5 offset:39424
    ds_read_b64_tr_b16 v[62:63], v5 offset:39680
    s_waitcnt lgkmcnt(6)
    v_mfma_f32_32x32x16_bf16 v[32:47], v[224:227], v[48:51], v[32:47]
    s_waitcnt lgkmcnt(4)
    v_mfma_f32_32x32x16_bf16 v[32:47], v[228:231], v[52:55], v[32:47]
    s_waitcnt lgkmcnt(2)
    v_mfma_f32_32x32x16_bf16 v[32:47], v[232:235], v[56:59], v[32:47]
    s_waitcnt lgkmcnt(0)
    v_mfma_f32_32x32x16_bf16 v[32:47], v[236:239], v[60:63], v[32:47]
    s_setprio 0
    s_nop 10
    s_cmp_lg_u32 s7, 0
    s_cbranch_scc1 p1w_105
p1poll_106:
    s_waitcnt vmcnt(0)
    v_cmp_ne_u64 vcc, s[100:101], v[250:251]
    s_cbranch_vccz p1go_107
    s_sleep 4
    s_lshl_b32 s26, s24, 12
    s_add_u32 s26, s26, 2490368
    v_lshlrev_b32 v247, 3, v12
    buffer_load_dwordx2 v[250:251], v247, s[8:11], s26 offen sc1
    s_sub_u32 s39, s39, 1
    s_cmp_gt_i32 s39, 0
    s_cbranch_scc1 p1poll_106
    s_waitcnt vmcnt(0)
p1go_107:
    s_lshl_b32 s26, s24, 13
    s_add_u32 s26, s26, 2752512
    s_add_u32 s28, s26, 4096
    s_cmp_eq_u32 s6, 1
    s_cbranch_scc1 p1a_108
    buffer_load_dwordx4 v[80:83], v245, s[8:11], s26 offen offset:0 sc1
    buffer_load_dwordx4 v[84:87], v245, s[8:11], s26 offen offset:1024 sc1
    buffer_load_dwordx4 v[88:91], v245, s[8:11], s26 offen offset:2048 sc1
    buffer_load_dwordx4 v[92:95], v245, s[8:11], s26 offen offset:3072 sc1
    buffer_load_dwordx4 v[48:51], v245, s[8:11], s28 offen offset:0 sc1
    buffer_load_dwordx4 v[52:55], v245, s[8:11], s28 offen offset:1024 sc1
    buffer_load_dwordx4 v[56:59], v245, s[8:11], s28 offen offset:2048 sc1
    buffer_load_dwordx4 v[60:63], v245, s[8:11], s28 offen offset:3072 sc1
    s_branch p1j_109
p1a_108:
    buffer_load_dwordx4 v[88:91], v245, s[8:11], s26 offen offset:0 sc1
    buffer_load_dwordx4 v[92:95], v245, s[8:11], s26 offen offset:1024 sc1
    buffer_load_dwordx4 v[16:19], v245, s[8:11], s26 offen offset:2048 sc1
    buffer_load_dwordx4 v[20:23], v245, s[8:11], s26 offen offset:3072 sc1
    buffer_load_dwordx4 v[48:51], v245, s[8:11], s28 offen offset:0 sc1
    buffer_load_dwordx4 v[52:55], v245, s[8:11], s28 offen offset:1024 sc1
    buffer_load_dwordx4 v[56:59], v245, s[8:11], s28 offen offset:2048 sc1
    buffer_load_dwordx4 v[60:63], v245, s[8:11], s28 offen offset:3072 sc1
p1j_109:
p1w_105:
    s_cmp_lg_u32 s23, 0
    s_cbranch_scc1 p1x_110
    s_cmp_lg_u32 s7, 4
    s_cbranch_scc1 p1w_111
    s_waitcnt vmcnt(0)
p1w_111:
    s_mov_b64 exec, 1
    ds_add_u32 v242, v243 offset:12
    s_mov_b64 exec, -1
p1x_110:
    v_cvt_pk_bf16_f32 v24, v32, v33
    v_cvt_pk_bf16_f32 v25, v34, v35
    v_cvt_pk_bf16_f32 v26, v36, v37
    v_cvt_pk_bf16_f32 v27, v38, v39
    v_cvt_pk_bf16_f32 v28, v40, v41
    v_cvt_pk_bf16_f32 v29, v42, v43
    v_cvt_pk_bf16_f32 v30, v44, v45
    v_cvt_pk_bf16_f32 v31, v46, v47
    v_mul_u32_u24 v16, 72, v13
    v_add_lshl_u32 v16, v16, v14, 4
    s_cmp_lg_u32 s7, 0
    s_cbranch_scc1 p1w_112
    s_waitcnt vmcnt(0)
    s_lshl_b32 s27, s22, 10
    s_add_u32 s27, s27, 147456
    v_add_u32 v244, s27, v245
    s_cmp_eq_u32 s6, 1
    s_cbranch_scc1 p1a_113
    v_add_f32 v80, v80, v84
    v_add_f32 v81, v81, v85
    v_add_f32 v82, v82, v86
    v_add_f32 v83, v83, v87
    v_add_f32 v88, v88, v92
    v_add_f32 v89, v89, v93
    v_add_f32 v90, v90, v94
    v_add_f32 v91, v91, v95
    v_add_f32 v48, v48, v52
    v_add_f32 v49, v49, v53
    v_add_f32 v50, v50, v54
    v_add_f32 v51, v51, v55
    v_add_f32 v56, v56, v60
    v_add_f32 v57, v57, v61
    v_add_f32 v58, v58, v62
    v_add_f32 v59, v59, v63
    v_add_f32 v80, v80, v88
    v_add_f32 v48, v48, v56
    v_add_f32 v81, v81, v89
    v_add_f32 v49, v49, v57
    v_add_f32 v82, v82, v90
    v_add_f32 v50, v50, v58
    v_add_f32 v83, v83, v91
    v_add_f32 v51, v51, v59
    v_add_f32 v80, v80, v48
    v_add_f32 v81, v81, v49
    v_add_f32 v82, v82, v50
    v_add_f32 v83, v83, v51
    ds_write_b128 v244, v[80:83]
    s_branch p1j_114
p1a_113:
    v_add_f32 v88, v88, v92
    v_add_f32 v89, v89, v93
    v_add_f32 v90, v90, v94
    v_add_f32 v91, v91, v95
    v_add_f32 v16, v16, v20
    v_add_f32 v17, v17, v21
    v_add_f32 v18, v18, v22
    v_add_f32 v19, v19, v23
    v_add_f32 v48, v48, v52
    v_add_f32 v49, v49, v53
    v_add_f32 v50, v50, v54
    v_add_f32 v51, v51, v55
    v_add_f32 v56, v56, v60
    v_add_f32 v57, v57, v61
    v_add_f32 v58, v58, v62
    v_add_f32 v59, v59, v63
    v_add_f32 v88, v88, v16
    v_add_f32 v48, v48, v56
    v_add_f32 v89, v89, v17
    v_add_f32 v49, v49, v57
    v_add_f32 v90, v90, v18
    v_add_f32 v50, v50, v58
    v_add_f32 v91, v91, v19
    v_add_f32 v51, v51, v59
    v_add_f32 v88, v88, v48
    v_add_f32 v89, v89, v49
    v_add_f32 v90, v90, v50
    v_add_f32 v91, v91, v51
    ds_write_b128 v244, v[88:91]
p1j_114:
p1w_112:
    s_cmp_lg_u32 s7, 2
    s_cbranch_scc1 p1w_115
    s_waitcnt vmcnt(0)
    s_lshl_b32 s27, s22, 10
    s_add_u32 s27, s27, 147456
    v_add_u32 v244, s27, v245
    v_add_f32 v96, v96, v100
    v_add_f32 v97, v97, v101
    v_add_f32 v98, v98, v102
    v_add_f32 v99, v99, v103
    v_add_f32 v104, v104, v108
    v_add_f32 v105, v105, v109
    v_add_f32 v106, v106, v110
    v_add_f32 v107, v107, v111
    v_add_f32 v112, v112, v116
    v_add_f32 v113, v113, v117
    v_add_f32 v114, v114, v118
    v_add_f32 v115, v115, v119
    v_add_f32 v120, v120, v124
    v_add_f32 v121, v121, v125
    v_add_f32 v122, v122, v126
    v_add_f32 v123, v123, v127
    v_add_f32 v96, v96, v104
    v_add_f32 v112, v112, v120
    v_add_f32 v97, v97, v105
    v_add_f32 v113, v113, v121
    v_add_f32 v98, v98, v106
    v_add_f32 v114, v114, v122
    v_add_f32 v99, v99, v107
    v_add_f32 v115, v115, v123
    v_add_f32 v96, v96, v112
    v_add_f32 v97, v97, v113
    v_add_f32 v98, v98, v114
    v_add_f32 v99, v99, v115
    ds_write_b128 v244, v[96:99]
p1w_115:
    s_mul_i32 s26, s24, 73728
    s_lshl_b32 s28, s33, 4
    s_add_u32 s26, s26, s28
    s_add_u32 s26, s26, 27299840
    s_add_u32 s28, s26, 18432
    buffer_store_dwordx4 v[24:27], v16, s[8:11], s26 offen offset:512 sc1
    buffer_store_dwordx4 v[28:31], v16, s[8:11], s28 offen offset:512 sc1
p1e2_52:
    s_cmp_eq_u32 s31, 0
    s_cbranch_scc1 p1tail_116
    s_sub_u32 s27, s21, 20
    s_lshr_b32 s28, s27, 1
    s_add_u32 s33, s28, 12
    s_lshl_b32 s33, s33, 5
    s_and_b32 s28, s28, 1
    s_lshl_b32 s28, s28, 9
    v_add_u32 v6, s28, v6
    v_add_u32 v7, s28, v7
p1fw_117:
    ds_read_b32 v244, v242 offset:12
    s_waitcnt lgkmcnt(0)
    v_readfirstlane_b32 s25, v244
    s_cmp_ge_u32 s25, 8
    s_cbranch_scc1 p1fd_118
    s_sleep 1
    s_sub_u32 s38, s38, 1
    s_cmp_gt_i32 s38, 0
    s_cbranch_scc1 p1fw_117
p1fd_118:
    s_setprio 1
    ds_read_b64_tr_b16 v[48:49], v6 offset:0
    ds_read_b64_tr_b16 v[50:51], v6 offset:256
    ds_read_b64_tr_b16 v[52:53], v6 offset:2048
    ds_read_b64_tr_b16 v[54:55], v6 offset:2304
    ds_read_b64_tr_b16 v[56:57], v6 offset:4096
    ds_read_b64_tr_b16 v[58:59], v6 offset:4352
    ds_read_b64_tr_b16 v[60:61], v6 offset:6144
    ds_read_b64_tr_b16 v[62:63], v6 offset:6400
    s_waitcnt lgkmcnt(6)
    v_mfma_f32_32x32x16_bf16 v[32:47], v[96:99], v[48:51], 0
    ds_read_b64_tr_b16 v[48:49], v6 offset:8192
    ds_read_b64_tr_b16 v[50:51], v6 offset:8448
    s_waitcnt lgkmcnt(6)
    v_mfma_f32_32x32x16_bf16 v[32:47], v[100:103], v[52:55], v[32:47]
    ds_read_b64_tr_b16 v[52:53], v6 offset:10240
    ds_read_b64_tr_b16 v[54:55], v6 offset:10496
    s_waitcnt lgkmcnt(6)
    v_mfma_f32_32x32x16_bf16 v[32:47], v[104:107], v[56:59], v[32:47]
    ds_read_b64_tr_b16 v[56:57], v6 offset:12288
    ds_read_b64_tr_b16 v[58:59], v6 offset:12544
    s_waitcnt lgkmcnt(6)
    v_mfma_f32_32x32x16_bf16 v[32:47], v[108:111], v[60:63], v[32:47]
    ds_read_b64_tr_b16 v[60:61], v6 offset:14336
    ds_read_b64_tr_b16 v[62:63], v6 offset:14592
    s_waitcnt lgkmcnt(6)
    v_mfma_f32_32x32x16_bf16 v[32:47], v[112:115], v[48:51], v[32:47]
    ds_read_b64_tr_b16 v[48:49], v6 offset:16384
    ds_read_b64_tr_b16 v[50:51], v6 offset:16640
    s_waitcnt lgkmcnt(6)
    v_mfma_f32_32x32x16_bf16 v[32:47], v[116:119], v[52:55], v[32:47]
    ds_read_b64_tr_b16 v[52:53], v6 offset:18432
    ds_read_b64_tr_b16 v[54:55], v6 offset:18688
    s_waitcnt lgkmcnt(6)
    v_mfma_f32_32x32x16_bf16 v[32:47], v[120:123], v[56:59], v[32:47]
    ds_read_b64_tr_b16 v[56:57], v6 offset:20480
    ds_read_b64_tr_b16 v[58:59], v6 offset:20736
    s_waitcnt lgkmcnt(6)
    v_mfma_f32_32x32x16_bf16 v[32:47], v[124:127], v[60:63], v[32:47]
    ds_read_b64_tr_b16 v[60:61], v6 offset:22528
    ds_read_b64_tr_b16 v[62:63], v6 offset:22784
    s_waitcnt lgkmcnt(6)
    v_mfma_f32_32x32x16_bf16 v[32:47], v[128:131], v[48:51], v[32:47]
    ds_read_b64_tr_b16 v[48:49], v6 offset:24576
    ds_read_b64_tr_b16 v[50:51], v6 offset:24832
    s_cmp_lg_u32 s7, 4
    s_cbranch_scc1 p1m_119
    s_lshl_b32 s26, s24, 13
    s_add_u32 s26, s26, 2752512
    s_add_u32 s28, s26, 4096
    buffer_load_dwordx4 v[96:99], v245, s[8:11], s26 offen offset:0 sc1
    buffer_load_dwordx4 v[100:103], v245, s[8:11], s26 offen offset:1024 sc1
    buffer_load_dwordx4 v[104:107], v245, s[8:11], s26 offen offset:2048 sc1
    buffer_load_dwordx4 v[108:111], v245, s[8:11], s26 offen offset:3072 sc1
    buffer_load_dwordx4 v[112:115], v245, s[8:11], s28 offen offset:0 sc1
    buffer_load_dwordx4 v[116:119], v245, s[8:11], s28 offen offset:1024 sc1
    buffer_load_dwordx4 v[120:123], v245, s[8:11], s28 offen offset:2048 sc1
    buffer_load_dwordx4 v[124:127], v245, s[8:11], s28 offen offset:3072 sc1
p1m_119:
    s_waitcnt lgkmcnt(6)
    v_mfma_f32_32x32x16_bf16 v[32:47], v[132:135], v[52:55], v[32:47]
    ds_read_b64_tr_b16 v[52:53], v6 offset:26624
    ds_read_b64_tr_b16 v[54:55], v6 offset:26880
    s_setprio 2
    s_waitcnt lgkmcnt(6)
    v_mfma_f32_32x32x16_bf16 v[32:47], v[136:139], v[56:59], v[32:47]
    ds_read_b64_tr_b16 v[56:57], v6 offset:28672
    ds_read_b64_tr_b16 v[58:59], v6 offset:28928
    s_waitcnt lgkmcnt(6)
    v_mfma_f32_32x32x16_bf16 v[32:47], v[140:143], v[60:63], v[32:47]
    ds_read_b64_tr_b16 v[60:61], v6 offset:30720
    ds_read_b64_tr_b16 v[62:63], v6 offset:30976
    s_waitcnt lgkmcnt(6)
    v_mfma_f32_32x32x16_bf16 v[32:47], v[144:147], v[48:51], v[32:47]
    ds_read_b64_tr_b16 v[48:49], v7 offset:0
    ds_read_b64_tr_b16 v[50:51], v7 offset:256
    s_waitcnt lgkmcnt(6)
    v_mfma_f32_32x32x16_bf16 v[32:47], v[148:151], v[52:55], v[32:47]
    ds_read_b64_tr_b16 v[52:53], v7 offset:2048
    ds_read_b64_tr_b16 v[54:55], v7 offset:2304
    s_waitcnt lgkmcnt(6)
    v_mfma_f32_32x32x16_bf16 v[32:47], v[152:155], v[56:59], v[32:47]
    ds_read_b64_tr_b16 v[56:57], v7 offset:4096
    ds_read_b64_tr_b16 v[58:59], v7 offset:4352
    s_waitcnt lgkmcnt(6)
    v_mfma_f32_32x32x16_bf16 v[32:47], v[156:159], v[60:63], v[32:47]
    ds_read_b64_tr_b16 v[60:61], v7 offset:6144
    ds_read_b64_tr_b16 v[62:63], v7 offset:6400
    s_waitcnt lgkmcnt(6)
    v_mfma_f32_32x32x16_bf16 v[32:47], v[160:163], v[48:51], v[32:47]
    ds_read_b64_tr_b16 v[48:49], v7 offset:8192
    ds_read_b64_tr_b16 v[50:51], v7 offset:8448
    s_waitcnt lgkmcnt(6)
    v_mfma_f32_32x32x16_bf16 v[32:47], v[164:167], v[52:55], v[32:47]
    ds_read_b64_tr_b16 v[52:53], v7 offset:10240
    ds_read_b64_tr_b16 v[54:55], v7 offset:10496
    s_waitcnt lgkmcnt(6)
    v_mfma_f32_32x32x16_bf16 v[32:47], v[168:171], v[56:59], v[32:47]
    ds_read_b64_tr_b16 v[56:57], v7 offset:12288
    ds_read_b64_tr_b16 v[58:59], v7 offset:12544
    s_waitcnt lgkmcnt(6)
    v_mfma_f32_32x32x16_bf16 v[32:47], v[172:175], v[60:63], v[32:47]
    ds_read_b64_tr_b16 v[60:61], v7 offset:14336
    ds_read_b64_tr_b16 v[62:63], v7 offset:14592
    s_setprio 3
    s_waitcnt lgkmcnt(6)
    v_mfma_f32_32x32x16_bf16 v[32:47], v[176:179], v[48:51], v[32:47]
    ds_read_b64_tr_b16 v[48:49], v7 offset:16384
    ds_read_b64_tr_b16 v[50:51], v7 offset:16640
    s_waitcnt lgkmcnt(6)
    v_mfma_f32_32x32x16_bf16 v[32:47], v[180:183], v[52:55], v[32:47]
    ds_read_b64_tr_b16 v[52:53], v7 offset:18432
    ds_read_b64_tr_b16 v[54:55], v7 offset:18688
    s_waitcnt lgkmcnt(6)
    v_mfma_f32_32x32x16_bf16 v[32:47], v[184:187], v[56:59], v[32:47]
    ds_read_b64_tr_b16 v[56:57], v7 offset:20480
    ds_read_b64_tr_b16 v[58:59], v7 offset:20736
    s_waitcnt lgkmcnt(6)
    v_mfma_f32_32x32x16_bf16 v[32:47], v[188:191], v[60:63], v[32:47]
    ds_read_b64_tr_b16 v[60:61], v7 offset:22528
    ds_read_b64_tr_b16 v[62:63], v7 offset:22784
    s_waitcnt lgkmcnt(6)
    v_mfma_f32_32x32x16_bf16 v[32:47], v[192:195], v[48:51], v[32:47]
    ds_read_b64_tr_b16 v[48:49], v7 offset:24576
    ds_read_b64_tr_b16 v[50:51], v7 offset:24832
    s_waitcnt lgkmcnt(6)
    v_mfma_f32_32x32x16_bf16 v[32:47], v[196:199], v[52:55], v[32:47]
    ds_read_b64_tr_b16 v[52:53], v7 offset:26624
    ds_read_b64_tr_b16 v[54:55], v7 offset:26880
    s_waitcnt lgkmcnt(6)
    v_mfma_f32_32x32x16_bf16 v[32:47], v[200:203], v[56:59], v[32:47]
    ds_read_b64_tr_b16 v[56:57], v7 offset:28672
    ds_read_b64_tr_b16 v[58:59], v7 offset:28928
    s_waitcnt lgkmcnt(6)
    v_mfma_f32_32x32x16_bf16 v[32:47], v[204:207], v[60:63], v[32:47]
    ds_read_b64_tr_b16 v[60:61], v7 offset:30720
    ds_read_b64_tr_b16 v[62:63], v7 offset:30976
    s_waitcnt lgkmcnt(6)
    v_mfma_f32_32x32x16_bf16 v[32:47], v[208:211], v[48:51], v[32:47]
    ds_read_b64_tr_b16 v[48:49], v7 offset:32768
    ds_read_b64_tr_b16 v[50:51], v7 offset:33024
    s_waitcnt lgkmcnt(6)
    v_mfma_f32_32x32x16_bf16 v[32:47], v[212:215], v[52:55], v[32:47]
    ds_read_b64_tr_b16 v[52:53], v7 offset:34816
    ds_read_b64_tr_b16 v[54:55], v7 offset:35072
    s_waitcnt lgkmcnt(6)
    v_mfma_f32_32x32x16_bf16 v[32:47], v[216:219], v[56:59], v[32:47]
    ds_read_b64_tr_b16 v[56:57], v7 offset:36864
    ds_read_b64_tr_b16 v[58:59], v7 offset:37120
    s_waitcnt lgkmcnt(6)
    v_mfma_f32_32x32x16_bf16 v[32:47], v[220:223], v[60:63], v[32:47]
    ds_read_b64_tr_b16 v[60:61], v7 offset:38912
    ds_read_b64_tr_b16 v[62:63], v7 offset:39168
    s_waitcnt lgkmcnt(6)
    v_mfma_f32_32x32x16_bf16 v[32:47], v[224:227], v[48:51], v[32:47]
    s_waitcnt lgkmcnt(4)
    v_mfma_f32_32x32x16_bf16 v[32:47], v[228:231], v[52:55], v[32:47]
    s_waitcnt lgkmcnt(2)
    v_mfma_f32_32x32x16_bf16 v[32:47], v[232:235], v[56:59], v[32:47]
    s_waitcnt lgkmcnt(0)
    v_mfma_f32_32x32x16_bf16 v[32:47], v[236:239], v[60:63], v[32:47]
    s_setprio 0
    s_nop 10
    v_cvt_pk_bf16_f32 v24, v32, v33
    v_cvt_pk_bf16_f32 v25, v34, v35
    v_cvt_pk_bf16_f32 v26, v36, v37
    v_cvt_pk_bf16_f32 v27, v38, v39
    v_cvt_pk_bf16_f32 v28, v40, v41
    v_cvt_pk_bf16_f32 v29, v42, v43
    v_cvt_pk_bf16_f32 v30, v44, v45
    v_cvt_pk_bf16_f32 v31, v46, v47
    v_mul_u32_u24 v16, 72, v13
    v_add_lshl_u32 v16, v16, v14, 4
    s_cmp_lg_u32 s7, 4
    s_cbranch_scc1 p1w_120
    s_waitcnt vmcnt(0)
    s_lshl_b32 s27, s22, 10
    s_add_u32 s27, s27, 147456
    v_add_u32 v244, s27, v245
    v_add_f32 v96, v96, v100
    v_add_f32 v97, v97, v101
    v_add_f32 v98, v98, v102
    v_add_f32 v99, v99, v103
    v_add_f32 v104, v104, v108
    v_add_f32 v105, v105, v109
    v_add_f32 v106, v106, v110
    v_add_f32 v107, v107, v111
    v_add_f32 v112, v112, v116
    v_add_f32 v113, v113, v117
    v_add_f32 v114, v114, v118
    v_add_f32 v115, v115, v119
    v_add_f32 v120, v120, v124
    v_add_f32 v121, v121, v125
    v_add_f32 v122, v122, v126
    v_add_f32 v123, v123, v127
    v_add_f32 v96, v96, v104
    v_add_f32 v112, v112, v120
    v_add_f32 v97, v97, v105
    v_add_f32 v113, v113, v121
    v_add_f32 v98, v98, v106
    v_add_f32 v114, v114, v122
    v_add_f32 v99, v99, v107
    v_add_f32 v115, v115, v123
    v_add_f32 v96, v96, v112
    v_add_f32 v97, v97, v113
    v_add_f32 v98, v98, v114
    v_add_f32 v99, v99, v115
    ds_write_b128 v244, v[96:99]
p1w_120:
    s_mul_i32 s26, s24, 73728
    s_lshl_b32 s28, s33, 4
    s_add_u32 s26, s26, s28
    s_add_u32 s26, s26, 27299840
    s_add_u32 s28, s26, 18432
    buffer_store_dwordx4 v[24:27], v16, s[8:11], s26 offen offset:0 sc1
    buffer_store_dwordx4 v[28:31], v16, s[8:11], s28 offen offset:0 sc1
p1tail_116:
    s_mov_b32 s36, 2
    s_cmp_eq_u32 s7, 1
    s_cbranch_scc1 p1_kernel_end
p1norm_50:
    s_lshl_b32 s27, s22, 10
    s_add_u32 s27, s27, 147456
    v_lshrrev_b32 v20, 2, v12
    v_add_u32 v20, s27, v20
    ds_read2_b32 v[32:33], v20 offset0:0 offset1:32
    ds_read2_b32 v[34:35], v20 offset0:64 offset1:96
    ds_read2_b32 v[36:37], v20 offset0:128 offset1:160
    ds_read2_b32 v[38:39], v20 offset0:192 offset1:224
    v_lshlrev_b32 v18, 1, v12
    v_lshl_add_u32 v18, v13, 1, v18
    v_add_u32 v18, s27, v18
    v_lshrrev_b32 v21, 4, v1
    v_lshlrev_b32 v19, 8, v21
    v_bfe_u32 v22, v1, 2, 2
    v_lshl_add_u32 v19, v22, 5, v19
    v_and_b32 v22, 3, v1
    v_lshl_add_u32 v19, v22, 3, v19
    v_add_u32 v19, s27, v19
    s_and_b32 s28, s24, 1
    s_mul_i32 s25, s28, 576
    v_and_b32 v22, 0x33, v1
    v_bfe_u32 v23, v1, 2, 1
    v_lshl_add_u32 v22, v23, 6, v22
    v_bfe_u32 v23, v1, 3, 1
    v_lshl_add_u32 v22, v23, 2, v22
    v_add_lshl_u32 v22, v22, s25, 4
    s_add_u32 s25, s25, 512
    v_add_lshl_u32 v23, v1, s25, 4
    s_lshl_b32 s3, s21, 2
    s_lshr_b32 s26, s24, 1
    s_mul_i32 s26, s26, 18432
    s_add_u32 s26, s26, 15466496
    s_waitcnt lgkmcnt(0)
    v_add_f32 v10, v32, v34
    v_add_f32 v11, v33, v35
    v_add_f32 v36, v36, v38
    v_add_f32 v37, v37, v39
    v_add_f32 v10, v10, v36
    v_add_f32 v11, v11, v37
    v_mul_f32 v10, 0x39e38e39, v10
    v_mul_f32 v11, 0x39e38e39, v11
    v_fma_f32 v11, -v10, v10, v11
    v_max_f32 v11, 0, v11
    v_cvt_pk_bf16_f32 v10, v10, v11
    v_and_b32 v11, 0xffff0000, v10
    v_lshlrev_b32 v10, 16, v10
    v_add_f32 v11, 0x3727c5ac, v11
    v_cvt_pk_bf16_f32 v11, v11, v11
    v_lshlrev_b32 v11, 16, v11
    v_sqrt_f32 v11, v11
    s_nop 0
    v_cvt_pk_bf16_f32 v11, v11, v11
    v_lshlrev_b32 v11, 16, v11
    v_rcp_f32 v11, v11
    s_nop 0
    v_mul_f32 v10, v10, v11
    v_sub_f32 v10, 0, v10
    v_lshlrev_b32 v32, 16, v64
    v_and_b32 v33, 0xffff0000, v64
    v_lshlrev_b32 v34, 16, v65
    v_and_b32 v35, 0xffff0000, v65
    v_lshlrev_b32 v36, 16, v66
    v_and_b32 v37, 0xffff0000, v66
    v_lshlrev_b32 v38, 16, v67
    v_and_b32 v39, 0xffff0000, v67
    v_fma_f32 v32, v32, v11, v10
    v_fma_f32 v33, v33, v11, v10
    v_fma_f32 v34, v34, v11, v10
    v_fma_f32 v35, v35, v11, v10
    v_fma_f32 v36, v36, v11, v10
    v_fma_f32 v37, v37, v11, v10
    v_fma_f32 v38, v38, v11, v10
    v_fma_f32 v39, v39, v11, v10
    v_cvt_pk_bf16_f32 v64, v32, v33
    v_cvt_pk_bf16_f32 v65, v34, v35
    v_cvt_pk_bf16_f32 v66, v36, v37
    v_cvt_pk_bf16_f32 v67, v38, v39
    ds_write_b128 v18, v[64:67]
    ds_read_b64_tr_b16 v[48:49], v19
    ds_read_b64_tr_b16 v[50:51], v19 offset:128
    s_add_u32 s25, s3, 0
    s_mul_i32 s27, s25, 57
    s_lshr_b32 s27, s27, 9
    s_mul_i32 s28, s27, 9
    s_sub_u32 s25, s25, s28
    s_mul_i32 s27, s27, 589824
    s_add_u32 s40, s27, s26
    s_lshr_b32 s27, s25, 1
    s_lshl_b32 s27, s27, 11
    s_and_b32 s28, s25, 1
    s_lshl_b32 s28, s28, 7
    s_add_u32 s27, s27, s28
    s_cmp_eq_u32 s25, 8
    s_cselect_b32 s27, 0, s27
    s_cselect_b64 vcc, -1, 0
    s_add_u32 s40, s40, s27
    v_cndmask_b32 v24, v22, v23, vcc
    v_lshlrev_b32 v40, 16, v68
    v_and_b32 v41, 0xffff0000, v68
    v_lshlrev_b32 v42, 16, v69
    v_and_b32 v43, 0xffff0000, v69
    v_lshlrev_b32 v44, 16, v70
    v_and_b32 v45, 0xffff0000, v70
    v_lshlrev_b32 v46, 16, v71
    v_and_b32 v47, 0xffff0000, v71
    v_fma_f32 v40, v40, v11, v10
    v_fma_f32 v41, v41, v11, v10
    v_fma_f32 v42, v42, v11, v10
    v_fma_f32 v43, v43, v11, v10
    v_fma_f32 v44, v44, v11, v10
    v_fma_f32 v45, v45, v11, v10
    v_fma_f32 v46, v46, v11, v10
    v_fma_f32 v47, v47, v11, v10
    v_cvt_pk_bf16_f32 v68, v40, v41
    v_cvt_pk_bf16_f32 v69, v42, v43
    v_cvt_pk_bf16_f32 v70, v44, v45
    v_cvt_pk_bf16_f32 v71, v46, v47
    ds_write_b128 v18, v[68:71]
    ds_read_b64_tr_b16 v[52:53], v19
    ds_read_b64_tr_b16 v[54:55], v19 offset:128
    s_add_u32 s25, s3, 1
    s_mul_i32 s27, s25, 57
    s_lshr_b32 s27, s27, 9
    s_mul_i32 s28, s27, 9
    s_sub_u32 s25, s25, s28
    s_mul_i32 s27, s27, 589824
    s_add_u32 s41, s27, s26
    s_lshr_b32 s27, s25, 1
    s_lshl_b32 s27, s27, 11
    s_and_b32 s28, s25, 1
    s_lshl_b32 s28, s28, 7
    s_add_u32 s27, s27, s28
    s_cmp_eq_u32 s25, 8
    s_cselect_b32 s27, 0, s27
    s_cselect_b64 vcc, -1, 0
    s_add_u32 s41, s41, s27
    v_cndmask_b32 v25, v22, v23, vcc
    s_waitcnt lgkmcnt(3)
    buffer_store_dwordx4 v[48:51], v24, s[8:11], s40 offen sc1
    v_lshlrev_b32 v32, 16, v72
    v_and_b32 v33, 0xffff0000, v72
    v_lshlrev_b32 v34, 16, v73
    v_and_b32 v35, 0xffff0000, v73
    v_lshlrev_b32 v36, 16, v74
    v_and_b32 v37, 0xffff0000, v74
    v_lshlrev_b32 v38, 16, v75
    v_and_b32 v39, 0xffff0000, v75
    v_fma_f32 v32, v32, v11, v10
    v_fma_f32 v33, v33, v11, v10
    v_fma_f32 v34, v34, v11, v10
    v_fma_f32 v35, v35, v11, v10
    v_fma_f32 v36, v36, v11, v10
    v_fma_f32 v37, v37, v11, v10
    v_fma_f32 v38, v38, v11, v10
    v_fma_f32 v39, v39, v11, v10
    v_cvt_pk_bf16_f32 v72, v32, v33
    v_cvt_pk_bf16_f32 v73, v34, v35
    v_cvt_pk_bf16_f32 v74, v36, v37
    v_cvt_pk_bf16_f32 v75, v38, v39
    ds_write_b128 v18, v[72:75]
    ds_read_b64_tr_b16 v[56:57], v19
    ds_read_b64_tr_b16 v[58:59], v19 offset:128
    s_add_u32 s25, s3, 2
    s_mul_i32 s27, s25, 57
    s_lshr_b32 s27, s27, 9
    s_mul_i32 s28, s27, 9
    s_sub_u32 s25, s25, s28
    s_mul_i32 s27, s27, 589824
    s_add_u32 s42, s27, s26
    s_lshr_b32 s27, s25, 1
    s_lshl_b32 s27, s27, 11
    s_and_b32 s28, s25, 1
    s_lshl_b32 s28, s28, 7
    s_add_u32 s27, s27, s28
    s_cmp_eq_u32 s25, 8
    s_cselect_b32 s27, 0, s27
    s_cselect_b64 vcc, -1, 0
    s_add_u32 s42, s42, s27
    v_cndmask_b32 v26, v22, v23, vcc
    s_waitcnt lgkmcnt(3)
    buffer_store_dwordx4 v[52:55], v25, s[8:11], s41 offen sc1
    v_lshlrev_b32 v40, 16, v76
    v_and_b32 v41, 0xffff0000, v76
    v_lshlrev_b32 v42, 16, v77
    v_and_b32 v43, 0xffff0000, v77
    v_lshlrev_b32 v44, 16, v78
    v_and_b32 v45, 0xffff0000, v78
    v_lshlrev_b32 v46, 16, v79
    v_and_b32 v47, 0xffff0000, v79
    v_fma_f32 v40, v40, v11, v10
    v_fma_f32 v41, v41, v11, v10
    v_fma_f32 v42, v42, v11, v10
    v_fma_f32 v43, v43, v11, v10
    v_fma_f32 v44, v44, v11, v10
    v_fma_f32 v45, v45, v11, v10
    v_fma_f32 v46, v46, v11, v10
    v_fma_f32 v47, v47, v11, v10
    v_cvt_pk_bf16_f32 v76, v40, v41
    v_cvt_pk_bf16_f32 v77, v42, v43
    v_cvt_pk_bf16_f32 v78, v44, v45
    v_cvt_pk_bf16_f32 v79, v46, v47
    ds_write_b128 v18, v[76:79]
    ds_read_b64_tr_b16 v[60:61], v19
    ds_read_b64_tr_b16 v[62:63], v19 offset:128
    s_add_u32 s25, s3, 3
    s_mul_i32 s27, s25, 57
    s_lshr_b32 s27, s27, 9
    s_mul_i32 s28, s27, 9
    s_sub_u32 s25, s25, s28
    s_mul_i32 s27, s27, 589824
    s_add_u32 s43, s27, s26
    s_lshr_b32 s27, s25, 1
    s_lshl_b32 s27, s27, 11
    s_and_b32 s28, s25, 1
    s_lshl_b32 s28, s28, 7
    s_add_u32 s27, s27, s28
    s_cmp_eq_u32 s25, 8
    s_cselect_b32 s27, 0, s27
    s_cselect_b64 vcc, -1, 0
    s_add_u32 s43, s43, s27
    v_cndmask_b32 v27, v22, v23, vcc
    s_waitcnt lgkmcnt(3)
    buffer_store_dwordx4 v[56:59], v26, s[8:11], s42 offen sc1
    s_waitcnt lgkmcnt(0)
    buffer_store_dwordx4 v[60:63], v27, s[8:11], s43 offen sc1
    s_cmp_lg_u32 s6, 1
    s_cbranch_scc1 p1r_121
    s_lshl_b32 s3, s21, 1
    v_lshlrev_b32 v32, 16, v80
    v_and_b32 v33, 0xffff0000, v80
    v_lshlrev_b32 v34, 16, v81
    v_and_b32 v35, 0xffff0000, v81
    v_lshlrev_b32 v36, 16, v82
    v_and_b32 v37, 0xffff0000, v82
    v_lshlrev_b32 v38, 16, v83
    v_and_b32 v39, 0xffff0000, v83
    v_fma_f32 v32, v32, v11, v10
    v_fma_f32 v33, v33, v11, v10
    v_fma_f32 v34, v34, v11, v10
    v_fma_f32 v35, v35, v11, v10
    v_fma_f32 v36, v36, v11, v10
    v_fma_f32 v37, v37, v11, v10
    v_fma_f32 v38, v38, v11, v10
    v_fma_f32 v39, v39, v11, v10
    v_cvt_pk_bf16_f32 v80, v32, v33
    v_cvt_pk_bf16_f32 v81, v34, v35
    v_cvt_pk_bf16_f32 v82, v36, v37
    v_cvt_pk_bf16_f32 v83, v38, v39
    ds_write_b128 v18, v[80:83]
    ds_read_b64_tr_b16 v[48:49], v19
    ds_read_b64_tr_b16 v[50:51], v19 offset:128
    s_add_u32 s25, s3, 112
    s_mul_i32 s27, s25, 57
    s_lshr_b32 s27, s27, 9
    s_mul_i32 s28, s27, 9
    s_sub_u32 s25, s25, s28
    s_mul_i32 s27, s27, 589824
    s_add_u32 s40, s27, s26
    s_lshr_b32 s27, s25, 1
    s_lshl_b32 s27, s27, 11
    s_and_b32 s28, s25, 1
    s_lshl_b32 s28, s28, 7
    s_add_u32 s27, s27, s28
    s_cmp_eq_u32 s25, 8
    s_cselect_b32 s27, 0, s27
    s_cselect_b64 vcc, -1, 0
    s_add_u32 s40, s40, s27
    v_cndmask_b32 v24, v22, v23, vcc
    v_lshlrev_b32 v40, 16, v84
    v_and_b32 v41, 0xffff0000, v84
    v_lshlrev_b32 v42, 16, v85
    v_and_b32 v43, 0xffff0000, v85
    v_lshlrev_b32 v44, 16, v86
    v_and_b32 v45, 0xffff0000, v86
    v_lshlrev_b32 v46, 16, v87
    v_and_b32 v47, 0xffff0000, v87
    v_fma_f32 v40, v40, v11, v10
    v_fma_f32 v41, v41, v11, v10
    v_fma_f32 v42, v42, v11, v10
    v_fma_f32 v43, v43, v11, v10
    v_fma_f32 v44, v44, v11, v10
    v_fma_f32 v45, v45, v11, v10
    v_fma_f32 v46, v46, v11, v10
    v_fma_f32 v47, v47, v11, v10
    v_cvt_pk_bf16_f32 v84, v40, v41
    v_cvt_pk_bf16_f32 v85, v42, v43
    v_cvt_pk_bf16_f32 v86, v44, v45
    v_cvt_pk_bf16_f32 v87, v46, v47
    ds_write_b128 v18, v[84:87]
    ds_read_b64_tr_b16 v[52:53], v19
    ds_read_b64_tr_b16 v[54:55], v19 offset:128
    s_add_u32 s25, s3, 113
    s_mul_i32 s27, s25, 57
    s_lshr_b32 s27, s27, 9
    s_mul_i32 s28, s27, 9
    s_sub_u32 s25, s25, s28
    s_mul_i32 s27, s27, 589824
    s_add_u32 s41, s27, s26
    s_lshr_b32 s27, s25, 1
    s_lshl_b32 s27, s27, 11
    s_and_b32 s28, s25, 1
    s_lshl_b32 s28, s28, 7
    s_add_u32 s27, s27, s28
    s_cmp_eq_u32 s25, 8
    s_cselect_b32 s27, 0, s27
    s_cselect_b64 vcc, -1, 0
    s_add_u32 s41, s41, s27
    v_cndmask_b32 v25, v22, v23, vcc
    s_waitcnt lgkmcnt(3)
    buffer_store_dwordx4 v[48:51], v24, s[8:11], s40 offen sc1
    s_waitcnt lgkmcnt(0)
    buffer_store_dwordx4 v[52:55], v25, s[8:11], s41 offen sc1
p1r_121:
    s_cmp_eq_u32 s36, 0
    s_cbranch_scc1 p1ret_70
    s_cmp_eq_u32 s36, 1
    s_cbranch_scc1 p1ret_102
p1_kernel_end:
p1_kernel_end_x:
    s_endpgm
.globl p2_kernel
.p2align 8
.type p2_kernel,@function
p2_kernel:
    s_cmp_ge_u32 s2, 256
    s_cbranch_scc1 p2_kernel_end_x
    s_load_dwordx2 s[4:5], s[0:1], 80
    s_load_dwordx4 s[48:51], s[0:1], 40
    s_and_b32 s20, s2, 7
    s_lshr_b32 s21, s2, 3
    s_lshr_b32 s27, s21, 3
    s_lshr_b32 s23, s20, 1
    s_lshl_b32 s23, s23, 2
    s_add_u32 s23, s23, s27
    s_and_b32 s26, s21, 7
    s_and_b32 s24, s20, 1
    s_lshl_b32 s24, s24, 3
    s_add_u32 s24, s24, s26
    s_lshl_b32 s25, s20, 2
    s_add_u32 s25, s25, s27
    v_lshrrev_b32 v1, 6, v0
    s_nop 0
    v_readfirstlane_b32 s22, v1
    v_and_b32 v1, 63, v0
    s_waitcnt lgkmcnt(0)
    s_mov_b32 s8, s4
    s_mov_b32 s9, s5
    s_mov_b32 s10, 0x2400000
    s_mov_b32 s11, 0x00020000
    s_mov_b32 s12, s48
    s_mov_b32 s13, s49
    s_mov_b32 s14, 0x800000
    s_mov_b32 s15, 0x00020000
    s_mov_b32 s16, s50
    s_mov_b32 s17, s51
    s_mov_b32 s18, 0x1000
    s_mov_b32 s19, 0x00020000
    s_add_u32 s6, s4, 3571712
    s_addc_u32 s7, s5, 0
    s_load_dwordx2 s[100:101], s[6:7], 0
    s_lshl_b32 s27, s23, 1
    s_lshr_b32 s28, s22, 1
    s_add_u32 s27, s27, s28
    s_lshl_b32 s27, s27, 6
    s_lshl_b32 s28, s24, 1
    s_add_u32 s27, s27, s28
    s_and_b32 s28, s22, 1
    s_add_u32 s27, s27, s28
    s_lshl_b32 s28, s26, 2
    s_add_u32 s28, s28, s22
    s_sub_u32 s28, s28, 4
    s_lshl_b32 s28, s28, 6
    s_add_u32 s28, s28, s25
    s_add_u32 s28, s28, 32
    s_cmp_ge_u32 s22, 4
    s_cselect_b32 s52, s28, s27
    s_lshl_b32 s52, s52, 7
    s_add_u32 s52, s52, 3276800
    s_cmp_ge_u32 s22, 4
    s_cbranch_scc1 p2_kernel_t
    v_lshrrev_b32 v160, 3, v1
    v_lshlrev_b32 v160, 12, v160
    v_and_b32 v161, 7, v1
    v_lshrrev_b32 v162, 4, v1
    v_xor_b32 v161, v161, v162
    v_lshl_add_u32 v2, v161, 4, v160
    v_xor_b32 v3, 64, v2
    v_lshlrev_b32 v4, 4, v1
    s_lshl_b32 s27, s23, 7
    s_lshl_b32 s28, s22, 5
    s_add_u32 s27, s27, s28
    s_lshl_b32 s28, s27, 1
    v_and_b32 v165, 15, v1
    v_lshlrev_b32 v166, 1, v165
    buffer_load_ushort v169, v166, s[16:19], s28 offen
    buffer_load_ushort v170, v166, s[16:19], s28 offen offset:32
    s_lshl_b32 s31, s27, 12
    s_mul_i32 s32, s24, 589824
    s_add_u32 s32, s32, 15466496
    s_mov_b32 s35, 27262976
    s_lshl_b32 s28, s22, 10
    s_add_u32 s29, s32, 16384
    s_add_u32 s29, s29, s28
    s_add_u32 s32, s32, s28
    s_lshl_b32 s36, s22, 12
    s_add_u32 s37, s28, 65536
    s_add_u32 s42, s28, 139264
    s_add_u32 s38, s37, 16384
    s_mov_b32 s34, 147456
    s_add_u32 s39, s42, 2048
    s_movk_i32 s40, 6144
    s_cmp_lt_u32 s22, 2
    s_cselect_b32 s33, s29, s35
    s_cselect_b32 s34, 18432, s34
    s_mov_b32 s50, 73728
    s_cselect_b32 s50, 18432, s50
    s_cselect_b32 s38, s38, s39
    s_cselect_b32 s29, 18432, s40
    s_cselect_b64 s[54:55], -1, 0
    s_add_u32 s39, s38, s29
    s_add_u32 s40, s39, s29
    s_add_u32 s41, s40, s29
    s_mul_i32 s29, s25, 18
    s_lshr_b32 s46, s29, 3
    s_lshl_b32 s46, s46, 5
    s_add_u32 s29, s29, 2208
    s_lshl_b32 s28, s22, 6
    s_add_u32 m0, s36, 0
    s_add_u32 s27, s31, 0
    buffer_load_dwordx4 v2, s[12:15], s27 offen lds
    s_add_u32 m0, s36, 1024
    s_add_u32 s27, s31, 32768
    buffer_load_dwordx4 v3, s[12:15], s27 offen lds
    s_add_u32 m0, s36, 2048
    s_add_u32 s27, s31, 65536
    buffer_load_dwordx4 v2, s[12:15], s27 offen lds
    s_add_u32 m0, s36, 3072
    s_add_u32 s27, s31, 98304
    buffer_load_dwordx4 v3, s[12:15], s27 offen lds
    s_add_u32 m0, s37, 0
    s_add_u32 s27, s32, 0
    buffer_load_dwordx4 v4, s[8:11], s27 offen lds
    s_add_u32 m0, s37, 4096
    s_add_u32 s27, s32, 4096
    buffer_load_dwordx4 v4, s[8:11], s27 offen lds
    s_add_u32 m0, s37, 8192
    s_add_u32 s27, s32, 8192
    buffer_load_dwordx4 v4, s[8:11], s27 offen lds
    s_add_u32 m0, s37, 12288
    s_add_u32 s27, s32, 12288
    buffer_load_dwordx4 v4, s[8:11], s27 offen lds
    s_add_u32 s31, s31, 128
    s_add_u32 s32, s32, 18432
    v_add_u32 v176, s28, v1
    v_add_u32 v176, 0, v176
    v_cmp_lt_u32 vcc, 167, v176
    s_nop 1
    v_cndmask_b32 v177, 0, 1, vcc
    v_cmp_lt_u32 vcc, 335, v176
    s_nop 1
    v_cndmask_b32 v177, v177, 2, vcc
    v_mul_u32_u24 v178, 168, v177
    v_sub_u32 v178, v176, v178
    v_subrev_u32 v179, 96, v178
    v_mul_u32_u24 v179, 3641, v179
    v_lshrrev_b32 v179, 16, v179
    v_mul_u32_u24 v179, 558, v179
    v_add3_u32 v179, v179, v178, s29
    v_add_u32 v180, s46, v178
    v_cmp_gt_u32 vcc, 96, v178
    s_nop 1
    v_cndmask_b32 v179, v179, v180, vcc
    v_mul_u32_u24 v177, 4608, v177
    v_add_lshl_u32 v13, v179, v177, 4
    s_and_b32 s28, s28, 64
    v_add_u32 v176, s28, v1
    v_add_u32 v176, 256, v176
    v_cmp_lt_u32 vcc, 167, v176
    s_nop 1
    v_cndmask_b32 v177, 0, 1, vcc
    v_cmp_lt_u32 vcc, 335, v176
    s_nop 1
    v_cndmask_b32 v177, v177, 2, vcc
    v_mul_u32_u24 v178, 168, v177
    v_sub_u32 v178, v176, v178
    v_subrev_u32 v179, 96, v178
    v_mul_u32_u24 v179, 3641, v179
    v_lshrrev_b32 v179, 16, v179
    v_mul_u32_u24 v179, 558, v179
    v_add3_u32 v179, v179, v178, s29
    v_add_u32 v180, s46, v178
    v_cmp_gt_u32 vcc, 96, v178
    s_nop 1
    v_cndmask_b32 v179, v179, v180, vcc
    v_mul_u32_u24 v177, 4608, v177
    v_add_lshl_u32 v15, v179, v177, 4
    s_lshl_b32 s51, s28, 4
    v_cndmask_b32 v14, v15, v4, s[54:55]
    s_add_u32 m0, s42, 0
    s_nop 0
    buffer_load_dwordx4 v13, s[8:11], s35 offen lds
    s_add_u32 s35, s35, 147456
    s_mov_b32 m0, s38
    s_nop 0
    buffer_load_dwordx4 v14, s[8:11], s33 offen lds
    s_add_u32 s33, s33, s34
    s_add_u32 m0, s42, 6144
    s_nop 0
    buffer_load_dwordx4 v13, s[8:11], s35 offen lds
    s_add_u32 s35, s35, 73728
    s_mov_b32 m0, s39
    s_nop 0
    buffer_load_dwordx4 v14, s[8:11], s33 offen lds
    s_add_u32 s33, s33, s50
    s_add_u32 m0, s36, 16384
    s_add_u32 s27, s31, 0
    buffer_load_dwordx4 v2, s[12:15], s27 offen lds
    s_add_u32 m0, s36, 17408
    s_add_u32 s27, s31, 32768
    buffer_load_dwordx4 v3, s[12:15], s27 offen lds
    s_add_u32 m0, s36, 18432
    s_add_u32 s27, s31, 65536
    buffer_load_dwordx4 v2, s[12:15], s27 offen lds
    s_add_u32 m0, s36, 19456
    s_add_u32 s27, s31, 98304
    buffer_load_dwordx4 v3, s[12:15], s27 offen lds
    s_add_u32 m0, s37, 18432
    s_add_u32 s27, s32, 0
    buffer_load_dwordx4 v4, s[8:11], s27 offen lds
    s_add_u32 m0, s37, 22528
    s_add_u32 s27, s32, 4096
    buffer_load_dwordx4 v4, s[8:11], s27 offen lds
    s_add_u32 m0, s37, 26624
    s_add_u32 s27, s32, 8192
    buffer_load_dwordx4 v4, s[8:11], s27 offen lds
    s_add_u32 m0, s37, 30720
    s_add_u32 s27, s32, 12288
    buffer_load_dwordx4 v4, s[8:11], s27 offen lds
    s_add_u32 s31, s31, 128
    s_add_u32 s32, s32, 18432
    s_and_b32 s29, s22, 1
    s_lshl_b32 s28, s22, 12
    v_lshlrev_b32 v160, 7, v165
    v_add_u32 v160, s28, v160
    v_bfe_u32 v161, v1, 1, 3
    v_xor_b32 v161, v161, v162
    v_lshl_add_u32 v160, v161, 4, v160
    s_lshl_b32 s28, s29, 6
    v_xor_b32 v5, s28, v160
    v_xor_b32 v12, 4096, v5
    s_mul_i32 s28, s29, 9216
    s_add_u32 s28, s28, 65536
    v_add_u32 v6, s28, v4
    v_add_u32 v7, 36864, v6
    v_lshlrev_b32 v160, 4, v165
    v_lshl_add_u32 v8, v162, 8, v160
    v_lshrrev_b32 v161, 5, v1
    v_lshl_add_u32 v160, v161, 8, v160
    v_and_b32 v161, 1, v162
    v_lshl_add_u32 v160, v161, 3, v160
    v_add_u32 v9, 4096, v160
    s_lshl_b32 s43, s23, 2
    s_add_u32 s43, s43, s22
    s_mul_i32 s43, s43, 184320
    s_mul_i32 s28, s24, 4608
    s_add_u32 s43, s43, s28
    s_add_u32 s43, s43, 3670016
    s_add_u32 s47, s43, 92160
    s_mul_i32 s28, s22, 18432
    s_add_u32 s28, s28, 65536
    s_cmp_eq_u32 s22, 3
    s_cselect_b32 s28, 30720, s28
    v_add_u32 v10, s28, v4
    s_xor_b32 s29, s22, 1
    s_mul_i32 s28, s29, 18432
    s_add_u32 s28, s28, 65536
    s_cmp_eq_u32 s29, 3
    s_cselect_b32 s28, 30720, s28
    v_add_u32 v11, s28, v4
    s_waitcnt vmcnt(20)
    v_lshlrev_b32 v169, 16, v169
    v_lshlrev_b32 v170, 16, v170
    v_mov_b32 v16, v169
    v_mov_b32 v17, v169
    v_mov_b32 v18, v169
    v_mov_b32 v19, v169
    v_mov_b32 v20, v169
    v_mov_b32 v21, v169
    v_mov_b32 v22, v169
    v_mov_b32 v23, v169
    v_mov_b32 v24, v169
    v_mov_b32 v25, v169
    v_mov_b32 v26, v169
    v_mov_b32 v27, v169
    v_mov_b32 v28, v169
    v_mov_b32 v29, v169
    v_mov_b32 v30, v169
    v_mov_b32 v31, v169
    v_mov_b32 v32, v169
    v_mov_b32 v33, v169
    v_mov_b32 v34, v169
    v_mov_b32 v35, v169
    v_mov_b32 v36, v169
    v_mov_b32 v37, v169
    v_mov_b32 v38, v169
    v_mov_b32 v39, v169
    v_mov_b32 v40, v169
    v_mov_b32 v41, v169
    v_mov_b32 v42, v169
    v_mov_b32 v43, v169
    v_mov_b32 v44, v169
    v_mov_b32 v45, v169
    v_mov_b32 v46, v169
    v_mov_b32 v47, v169
    v_mov_b32 v48, v169
    v_mov_b32 v49, v169
    v_mov_b32 v50, v169
    v_mov_b32 v51, v169
    v_mov_b32 v52, v170
    v_mov_b32 v53, v170
    v_mov_b32 v54, v170
    v_mov_b32 v55, v170
    v_mov_b32 v56, v170
    v_mov_b32 v57, v170
    v_mov_b32 v58, v170
    v_mov_b32 v59, v170
    v_mov_b32 v60, v170
    v_mov_b32 v61, v170
    v_mov_b32 v62, v170
    v_mov_b32 v63, v170
    v_mov_b32 v64, v170
    v_mov_b32 v65, v170
    v_mov_b32 v66, v170
    v_mov_b32 v67, v170
    v_mov_b32 v68, v170
    v_mov_b32 v69, v170
    v_mov_b32 v70, v170
    v_mov_b32 v71, v170
    v_mov_b32 v72, v170
    v_mov_b32 v73, v170
    v_mov_b32 v74, v170
    v_mov_b32 v75, v170
    v_mov_b32 v76, v170
    v_mov_b32 v77, v170
    v_mov_b32 v78, v170
    v_mov_b32 v79, v170
    v_mov_b32 v80, v170
    v_mov_b32 v81, v170
    v_mov_b32 v82, v170
    v_mov_b32 v83, v170
    v_mov_b32 v84, v170
    v_mov_b32 v85, v170
    v_mov_b32 v86, v170
    v_mov_b32 v87, v170
    v_mov_b32 v88, 0
    v_mov_b32 v89, 0
    v_mov_b32 v90, 0
    v_mov_b32 v91, 0
    v_mov_b32 v92, 0
    v_mov_b32 v93, 0
    v_mov_b32 v94, 0
    v_mov_b32 v95, 0
    v_mov_b32 v96, 0
    v_mov_b32 v97, 0
    v_mov_b32 v98, 0
    v_mov_b32 v99, 0
    v_mov_b32 v100, 0
    v_mov_b32 v101, 0
    v_mov_b32 v102, 0
    v_mov_b32 v103, 0
    v_mov_b32 v104, 0
    v_mov_b32 v105, 0
    v_mov_b32 v106, 0
    v_mov_b32 v107, 0
    v_mov_b32 v108, 0
    v_mov_b32 v109, 0
    v_mov_b32 v110, 0
    v_mov_b32 v111, 0
    v_mov_b32 v112, 0
    v_mov_b32 v113, 0
    v_mov_b32 v114, 0
    v_mov_b32 v115, 0
    v_mov_b32 v116, 0
    v_mov_b32 v117, 0
    v_mov_b32 v118, 0
    v_mov_b32 v119, 0
    v_mov_b32 v120, 0
    v_mov_b32 v121, 0
    v_mov_b32 v122, 0
    v_mov_b32 v123, 0
    v_mov_b32 v124, 0
    v_mov_b32 v125, 0
    v_mov_b32 v126, 0
    v_mov_b32 v127, 0
    v_mov_b32 v128, 0
    v_mov_b32 v129, 0
    v_mov_b32 v130, 0
    v_mov_b32 v131, 0
    v_mov_b32 v132, 0
    v_mov_b32 v133, 0
    v_mov_b32 v134, 0
    v_mov_b32 v135, 0
    v_mov_b32 v136, 0
    v_mov_b32 v137, 0
    v_mov_b32 v138, 0
    v_mov_b32 v139, 0
    v_mov_b32 v140, 0
    v_mov_b32 v141, 0
    v_mov_b32 v142, 0
    v_mov_b32 v143, 0
    v_mov_b32 v144, 0
    v_mov_b32 v145, 0
    v_mov_b32 v146, 0
    v_mov_b32 v147, 0
    v_mov_b32 v148, 0
    v_mov_b32 v149, 0
    v_mov_b32 v150, 0
    v_mov_b32 v151, 0
    v_mov_b32 v152, 0
    v_mov_b32 v153, 0
    v_mov_b32 v154, 0
    v_mov_b32 v155, 0
    v_mov_b32 v156, 0
    v_mov_b32 v157, 0
    v_mov_b32 v158, 0
    v_mov_b32 v159, 0
    s_waitcnt vmcnt(10) lgkmcnt(0)
    s_barrier
    s_setprio 1
    s_add_u32 m0, s42, 12288
    s_nop 0
    buffer_load_dwordx4 v13, s[8:11], s35 offen lds
    s_add_u32 s35, s35, 147456
    s_mov_b32 m0, s40
    s_nop 0
    buffer_load_dwordx4 v14, s[8:11], s33 offen lds
    s_add_u32 s33, s33, s34
    s_add_u32 m0, s36, 32768
    s_add_u32 s27, s31, 0
    buffer_load_dwordx4 v2, s[12:15], s27 offen lds
    s_add_u32 m0, s36, 33792
    s_add_u32 s27, s31, 32768
    buffer_load_dwordx4 v3, s[12:15], s27 offen lds
    s_add_u32 m0, s36, 34816
    s_add_u32 s27, s31, 65536
    buffer_load_dwordx4 v2, s[12:15], s27 offen lds
    s_add_u32 m0, s36, 35840
    s_add_u32 s27, s31, 98304
    buffer_load_dwordx4 v3, s[12:15], s27 offen lds
    s_add_u32 m0, s37, 36864
    s_add_u32 s27, s32, 0
    buffer_load_dwordx4 v4, s[8:11], s27 offen lds
    s_add_u32 m0, s37, 40960
    s_add_u32 s27, s32, 4096
    buffer_load_dwordx4 v4, s[8:11], s27 offen lds
    s_add_u32 m0, s37, 45056
    s_add_u32 s27, s32, 8192
    buffer_load_dwordx4 v4, s[8:11], s27 offen lds
    s_add_u32 m0, s37, 49152
    s_add_u32 s27, s32, 12288
    buffer_load_dwordx4 v4, s[8:11], s27 offen lds
    s_add_u32 s31, s31, 128
    s_add_u32 s32, s32, 18432
    ds_read_b128 v[160:163], v5 offset:0
    ds_read_b128 v[164:167], v5 offset:2048
    ds_read_b128 v[168:171], v12 offset:0
    ds_read_b128 v[172:175], v12 offset:2048
    ds_read_b128 v[192:195], v6 offset:0
    ds_read_b128 v[196:199], v6 offset:1024
    ds_read_b128 v[200:203], v6 offset:2048
    s_mov_b32 s30, 7
g_loop_122:
    s_waitcnt vmcnt(10)
    s_barrier
    ds_read_b128 v[204:207], v6 offset:3072
    s_waitcnt lgkmcnt(3)
    v_mfma_f32_16x16x32_bf16 v[16:19], v[192:195], v[160:163], v[16:19]
    v_mfma_f32_16x16x32_bf16 v[52:55], v[192:195], v[164:167], v[52:55]
    s_add_u32 m0, s42, 18432
    s_nop 0
    buffer_load_dwordx4 v13, s[8:11], s35 offen lds
    s_add_u32 s35, s35, 73728
    v_mfma_f32_16x16x32_bf16 v[88:91], v[192:195], v[168:171], v[88:91]
    v_mfma_f32_16x16x32_bf16 v[124:127], v[192:195], v[172:175], v[124:127]
    s_mov_b32 m0, s41
    s_nop 0
    buffer_load_dwordx4 v14, s[8:11], s33 offen lds
    s_add_u32 s33, s33, s50
    ds_read_b128 v[208:211], v6 offset:4096
    ds_read_b128 v[176:179], v5 offset:16384
    s_waitcnt lgkmcnt(4)
    v_mfma_f32_16x16x32_bf16 v[20:23], v[196:199], v[160:163], v[20:23]
    v_mfma_f32_16x16x32_bf16 v[56:59], v[196:199], v[164:167], v[56:59]
    s_add_u32 m0, s36, 49152
    s_add_u32 s27, s31, 0
    buffer_load_dwordx4 v2, s[12:15], s27 offen lds
    v_mfma_f32_16x16x32_bf16 v[92:95], v[196:199], v[168:171], v[92:95]
    v_mfma_f32_16x16x32_bf16 v[128:131], v[196:199], v[172:175], v[128:131]
    ds_read_b128 v[212:215], v6 offset:5120
    ds_read_b128 v[180:183], v5 offset:18432
    s_waitcnt lgkmcnt(5)
    v_mfma_f32_16x16x32_bf16 v[24:27], v[200:203], v[160:163], v[24:27]
    v_mfma_f32_16x16x32_bf16 v[60:63], v[200:203], v[164:167], v[60:63]
    s_add_u32 m0, s36, 50176
    s_add_u32 s27, s31, 32768
    buffer_load_dwordx4 v3, s[12:15], s27 offen lds
    v_mfma_f32_16x16x32_bf16 v[96:99], v[200:203], v[168:171], v[96:99]
    v_mfma_f32_16x16x32_bf16 v[132:135], v[200:203], v[172:175], v[132:135]
    ds_read_b128 v[192:195], v6 offset:6144
    ds_read_b128 v[184:187], v12 offset:16384
    s_waitcnt lgkmcnt(6)
    v_mfma_f32_16x16x32_bf16 v[28:31], v[204:207], v[160:163], v[28:31]
    v_mfma_f32_16x16x32_bf16 v[64:67], v[204:207], v[164:167], v[64:67]
    s_add_u32 m0, s36, 51200
    s_add_u32 s27, s31, 65536
    buffer_load_dwordx4 v2, s[12:15], s27 offen lds
    v_mfma_f32_16x16x32_bf16 v[100:103], v[204:207], v[168:171], v[100:103]
    v_mfma_f32_16x16x32_bf16 v[136:139], v[204:207], v[172:175], v[136:139]
    ds_read_b128 v[196:199], v6 offset:7168
    ds_read_b128 v[188:191], v12 offset:18432
    s_waitcnt lgkmcnt(7)
    v_mfma_f32_16x16x32_bf16 v[32:35], v[208:211], v[160:163], v[32:35]
    v_mfma_f32_16x16x32_bf16 v[68:71], v[208:211], v[164:167], v[68:71]
    s_add_u32 m0, s36, 52224
    s_add_u32 s27, s31, 98304
    buffer_load_dwordx4 v3, s[12:15], s27 offen lds
    v_mfma_f32_16x16x32_bf16 v[104:107], v[208:211], v[168:171], v[104:107]
    v_mfma_f32_16x16x32_bf16 v[140:143], v[208:211], v[172:175], v[140:143]
    ds_read_b128 v[200:203], v6 offset:8192
    s_waitcnt lgkmcnt(6)
    v_mfma_f32_16x16x32_bf16 v[36:39], v[212:215], v[160:163], v[36:39]
    v_mfma_f32_16x16x32_bf16 v[72:75], v[212:215], v[164:167], v[72:75]
    s_add_u32 m0, s37, 55296
    s_add_u32 s27, s32, 0
    buffer_load_dwordx4 v4, s[8:11], s27 offen lds
    v_mfma_f32_16x16x32_bf16 v[108:111], v[212:215], v[168:171], v[108:111]
    v_mfma_f32_16x16x32_bf16 v[144:147], v[212:215], v[172:175], v[144:147]
    ds_read_b128 v[204:207], v6 offset:18432
    s_waitcnt lgkmcnt(5)
    v_mfma_f32_16x16x32_bf16 v[40:43], v[192:195], v[160:163], v[40:43]
    v_mfma_f32_16x16x32_bf16 v[76:79], v[192:195], v[164:167], v[76:79]
    s_add_u32 m0, s37, 59392
    s_add_u32 s27, s32, 4096
    buffer_load_dwordx4 v4, s[8:11], s27 offen lds
    v_mfma_f32_16x16x32_bf16 v[112:115], v[192:195], v[168:171], v[112:115]
    v_mfma_f32_16x16x32_bf16 v[148:151], v[192:195], v[172:175], v[148:151]
    ds_read_b128 v[208:211], v6 offset:19456
    s_waitcnt lgkmcnt(4)
    v_mfma_f32_16x16x32_bf16 v[44:47], v[196:199], v[160:163], v[44:47]
    v_mfma_f32_16x16x32_bf16 v[80:83], v[196:199], v[164:167], v[80:83]
    s_add_u32 m0, s37, 63488
    s_add_u32 s27, s32, 8192
    buffer_load_dwordx4 v4, s[8:11], s27 offen lds
    v_mfma_f32_16x16x32_bf16 v[116:119], v[196:199], v[168:171], v[116:119]
    v_mfma_f32_16x16x32_bf16 v[152:155], v[196:199], v[172:175], v[152:155]
    ds_read_b128 v[212:215], v6 offset:20480
    s_waitcnt lgkmcnt(3)
    v_mfma_f32_16x16x32_bf16 v[48:51], v[200:203], v[160:163], v[48:51]
    v_mfma_f32_16x16x32_bf16 v[84:87], v[200:203], v[164:167], v[84:87]
    s_add_u32 m0, s37, 67584
    s_add_u32 s27, s32, 12288
    buffer_load_dwordx4 v4, s[8:11], s27 offen lds
    s_add_u32 s31, s31, 128
    s_add_u32 s32, s32, 18432
    v_mfma_f32_16x16x32_bf16 v[120:123], v[200:203], v[168:171], v[120:123]
    v_mfma_f32_16x16x32_bf16 v[156:159], v[200:203], v[172:175], v[156:159]
    s_waitcnt vmcnt(10)
    s_barrier
    ds_read_b128 v[192:195], v6 offset:21504
    s_waitcnt lgkmcnt(3)
    v_mfma_f32_16x16x32_bf16 v[16:19], v[204:207], v[176:179], v[16:19]
    v_mfma_f32_16x16x32_bf16 v[52:55], v[204:207], v[180:183], v[52:55]
    s_add_u32 m0, s42, 0
    s_nop 0
    buffer_load_dwordx4 v13, s[8:11], s35 offen lds
    s_add_u32 s35, s35, 147456
    v_mfma_f32_16x16x32_bf16 v[88:91], v[204:207], v[184:187], v[88:91]
    v_mfma_f32_16x16x32_bf16 v[124:127], v[204:207], v[188:191], v[124:127]
    s_mov_b32 m0, s38
    s_nop 0
    buffer_load_dwordx4 v14, s[8:11], s33 offen lds
    s_add_u32 s33, s33, s34
    ds_read_b128 v[196:199], v6 offset:22528
    ds_read_b128 v[160:163], v5 offset:32768
    s_waitcnt lgkmcnt(4)
    v_mfma_f32_16x16x32_bf16 v[20:23], v[208:211], v[176:179], v[20:23]
    v_mfma_f32_16x16x32_bf16 v[56:59], v[208:211], v[180:183], v[56:59]
    s_add_u32 m0, s36, 0
    s_add_u32 s27, s31, 0
    buffer_load_dwordx4 v2, s[12:15], s27 offen lds
    v_mfma_f32_16x16x32_bf16 v[92:95], v[208:211], v[184:187], v[92:95]
    v_mfma_f32_16x16x32_bf16 v[128:131], v[208:211], v[188:191], v[128:131]
    ds_read_b128 v[200:203], v6 offset:23552
    ds_read_b128 v[164:167], v5 offset:34816
    s_waitcnt lgkmcnt(5)
    v_mfma_f32_16x16x32_bf16 v[24:27], v[212:215], v[176:179], v[24:27]
    v_mfma_f32_16x16x32_bf16 v[60:63], v[212:215], v[180:183], v[60:63]
    s_add_u32 m0, s36, 1024
    s_add_u32 s27, s31, 32768
    buffer_load_dwordx4 v3, s[12:15], s27 offen lds
    v_mfma_f32_16x16x32_bf16 v[96:99], v[212:215], v[184:187], v[96:99]
    v_mfma_f32_16x16x32_bf16 v[132:135], v[212:215], v[188:191], v[132:135]
    ds_read_b128 v[204:207], v6 offset:24576
    ds_read_b128 v[168:171], v12 offset:32768
    s_waitcnt lgkmcnt(6)
    v_mfma_f32_16x16x32_bf16 v[28:31], v[192:195], v[176:179], v[28:31]
    v_mfma_f32_16x16x32_bf16 v[64:67], v[192:195], v[180:183], v[64:67]
    s_add_u32 m0, s36, 2048
    s_add_u32 s27, s31, 65536
    buffer_load_dwordx4 v2, s[12:15], s27 offen lds
    v_mfma_f32_16x16x32_bf16 v[100:103], v[192:195], v[184:187], v[100:103]
    v_mfma_f32_16x16x32_bf16 v[136:139], v[192:195], v[188:191], v[136:139]
    ds_read_b128 v[208:211], v6 offset:25600
    ds_read_b128 v[172:175], v12 offset:34816
    s_waitcnt lgkmcnt(7)
    v_mfma_f32_16x16x32_bf16 v[32:35], v[196:199], v[176:179], v[32:35]
    v_mfma_f32_16x16x32_bf16 v[68:71], v[196:199], v[180:183], v[68:71]
    s_add_u32 m0, s36, 3072
    s_add_u32 s27, s31, 98304
    buffer_load_dwordx4 v3, s[12:15], s27 offen lds
    v_mfma_f32_16x16x32_bf16 v[104:107], v[196:199], v[184:187], v[104:107]
    v_mfma_f32_16x16x32_bf16 v[140:143], v[196:199], v[188:191], v[140:143]
    ds_read_b128 v[212:215], v6 offset:26624
    s_waitcnt lgkmcnt(6)
    v_mfma_f32_16x16x32_bf16 v[36:39], v[200:203], v[176:179], v[36:39]
    v_mfma_f32_16x16x32_bf16 v[72:75], v[200:203], v[180:183], v[72:75]
    s_add_u32 m0, s37, 0
    s_add_u32 s27, s32, 0
    buffer_load_dwordx4 v4, s[8:11], s27 offen lds
    v_mfma_f32_16x16x32_bf16 v[108:111], v[200:203], v[184:187], v[108:111]
    v_mfma_f32_16x16x32_bf16 v[144:147], v[200:203], v[188:191], v[144:147]
    ds_read_b128 v[192:195], v7 offset:0
    s_waitcnt lgkmcnt(5)
    v_mfma_f32_16x16x32_bf16 v[40:43], v[204:207], v[176:179], v[40:43]
    v_mfma_f32_16x16x32_bf16 v[76:79], v[204:207], v[180:183], v[76:79]
    s_add_u32 m0, s37, 4096
    s_add_u32 s27, s32, 4096
    buffer_load_dwordx4 v4, s[8:11], s27 offen lds
    v_mfma_f32_16x16x32_bf16 v[112:115], v[204:207], v[184:187], v[112:115]
    v_mfma_f32_16x16x32_bf16 v[148:151], v[204:207], v[188:191], v[148:151]
    ds_read_b128 v[196:199], v7 offset:1024
    s_waitcnt lgkmcnt(4)
    v_mfma_f32_16x16x32_bf16 v[44:47], v[208:211], v[176:179], v[44:47]
    v_mfma_f32_16x16x32_bf16 v[80:83], v[208:211], v[180:183], v[80:83]
    s_add_u32 m0, s37, 8192
    s_add_u32 s27, s32, 8192
    buffer_load_dwordx4 v4, s[8:11], s27 offen lds
    v_mfma_f32_16x16x32_bf16 v[116:119], v[208:211], v[184:187], v[116:119]
    v_mfma_f32_16x16x32_bf16 v[152:155], v[208:211], v[188:191], v[152:155]
    ds_read_b128 v[200:203], v7 offset:2048
    s_waitcnt lgkmcnt(3)
    v_mfma_f32_16x16x32_bf16 v[48:51], v[212:215], v[176:179], v[48:51]
    v_mfma_f32_16x16x32_bf16 v[84:87], v[212:215], v[180:183], v[84:87]
    s_add_u32 m0, s37, 12288
    s_add_u32 s27, s32, 12288
    buffer_load_dwordx4 v4, s[8:11], s27 offen lds
    s_add_u32 s31, s31, 128
    s_add_u32 s32, s32, 18432
    v_mfma_f32_16x16x32_bf16 v[120:123], v[212:215], v[184:187], v[120:123]
    v_mfma_f32_16x16x32_bf16 v[156:159], v[212:215], v[188:191], v[156:159]
    s_waitcnt vmcnt(10)
    s_barrier
    ds_read_b128 v[204:207], v7 offset:3072
    s_waitcnt lgkmcnt(3)
    v_mfma_f32_16x16x32_bf16 v[16:19], v[192:195], v[160:163], v[16:19]
    v_mfma_f32_16x16x32_bf16 v[52:55], v[192:195], v[164:167], v[52:55]
    s_add_u32 m0, s42, 6144
    s_nop 0
    buffer_load_dwordx4 v13, s[8:11], s35 offen lds
    s_add_u32 s35, s35, 73728
    v_mfma_f32_16x16x32_bf16 v[88:91], v[192:195], v[168:171], v[88:91]
    v_mfma_f32_16x16x32_bf16 v[124:127], v[192:195], v[172:175], v[124:127]
    s_mov_b32 m0, s39
    s_nop 0
    buffer_load_dwordx4 v14, s[8:11], s33 offen lds
    s_add_u32 s33, s33, s50
    ds_read_b128 v[208:211], v7 offset:4096
    ds_read_b128 v[176:179], v5 offset:49152
    s_waitcnt lgkmcnt(4)
    v_mfma_f32_16x16x32_bf16 v[20:23], v[196:199], v[160:163], v[20:23]
    v_mfma_f32_16x16x32_bf16 v[56:59], v[196:199], v[164:167], v[56:59]
    s_add_u32 m0, s36, 16384
    s_add_u32 s27, s31, 0
    buffer_load_dwordx4 v2, s[12:15], s27 offen lds
    v_mfma_f32_16x16x32_bf16 v[92:95], v[196:199], v[168:171], v[92:95]
    v_mfma_f32_16x16x32_bf16 v[128:131], v[196:199], v[172:175], v[128:131]
    ds_read_b128 v[212:215], v7 offset:5120
    ds_read_b128 v[180:183], v5 offset:51200
    s_waitcnt lgkmcnt(5)
    v_mfma_f32_16x16x32_bf16 v[24:27], v[200:203], v[160:163], v[24:27]
    v_mfma_f32_16x16x32_bf16 v[60:63], v[200:203], v[164:167], v[60:63]
    s_add_u32 m0, s36, 17408
    s_add_u32 s27, s31, 32768
    buffer_load_dwordx4 v3, s[12:15], s27 offen lds
    v_mfma_f32_16x16x32_bf16 v[96:99], v[200:203], v[168:171], v[96:99]
    v_mfma_f32_16x16x32_bf16 v[132:135], v[200:203], v[172:175], v[132:135]
    ds_read_b128 v[192:195], v7 offset:6144
    ds_read_b128 v[184:187], v12 offset:49152
    s_waitcnt lgkmcnt(6)
    v_mfma_f32_16x16x32_bf16 v[28:31], v[204:207], v[160:163], v[28:31]
    v_mfma_f32_16x16x32_bf16 v[64:67], v[204:207], v[164:167], v[64:67]
    s_add_u32 m0, s36, 18432
    s_add_u32 s27, s31, 65536
    buffer_load_dwordx4 v2, s[12:15], s27 offen lds
    v_mfma_f32_16x16x32_bf16 v[100:103], v[204:207], v[168:171], v[100:103]
    v_mfma_f32_16x16x32_bf16 v[136:139], v[204:207], v[172:175], v[136:139]
    ds_read_b128 v[196:199], v7 offset:7168
    ds_read_b128 v[188:191], v12 offset:51200
    s_waitcnt lgkmcnt(7)
    v_mfma_f32_16x16x32_bf16 v[32:35], v[208:211], v[160:163], v[32:35]
    v_mfma_f32_16x16x32_bf16 v[68:71], v[208:211], v[164:167], v[68:71]
    s_add_u32 m0, s36, 19456
    s_add_u32 s27, s31, 98304
    buffer_load_dwordx4 v3, s[12:15], s27 offen lds
    v_mfma_f32_16x16x32_bf16 v[104:107], v[208:211], v[168:171], v[104:107]
    v_mfma_f32_16x16x32_bf16 v[140:143], v[208:211], v[172:175], v[140:143]
    ds_read_b128 v[200:203], v7 offset:8192
    s_waitcnt lgkmcnt(6)
    v_mfma_f32_16x16x32_bf16 v[36:39], v[212:215], v[160:163], v[36:39]
    v_mfma_f32_16x16x32_bf16 v[72:75], v[212:215], v[164:167], v[72:75]
    s_add_u32 m0, s37, 18432
    s_add_u32 s27, s32, 0
    buffer_load_dwordx4 v4, s[8:11], s27 offen lds
    v_mfma_f32_16x16x32_bf16 v[108:111], v[212:215], v[168:171], v[108:111]
    v_mfma_f32_16x16x32_bf16 v[144:147], v[212:215], v[172:175], v[144:147]
    ds_read_b128 v[204:207], v7 offset:18432
    s_waitcnt lgkmcnt(5)
    v_mfma_f32_16x16x32_bf16 v[40:43], v[192:195], v[160:163], v[40:43]
    v_mfma_f32_16x16x32_bf16 v[76:79], v[192:195], v[164:167], v[76:79]
    s_add_u32 m0, s37, 22528
    s_add_u32 s27, s32, 4096
    buffer_load_dwordx4 v4, s[8:11], s27 offen lds
    v_mfma_f32_16x16x32_bf16 v[112:115], v[192:195], v[168:171], v[112:115]
    v_mfma_f32_16x16x32_bf16 v[148:151], v[192:195], v[172:175], v[148:151]
    ds_read_b128 v[208:211], v7 offset:19456
    s_waitcnt lgkmcnt(4)
    v_mfma_f32_16x16x32_bf16 v[44:47], v[196:199], v[160:163], v[44:47]
    v_mfma_f32_16x16x32_bf16 v[80:83], v[196:199], v[164:167], v[80:83]
    s_add_u32 m0, s37, 26624
    s_add_u32 s27, s32, 8192
    buffer_load_dwordx4 v4, s[8:11], s27 offen lds
    v_mfma_f32_16x16x32_bf16 v[116:119], v[196:199], v[168:171], v[116:119]
    v_mfma_f32_16x16x32_bf16 v[152:155], v[196:199], v[172:175], v[152:155]
    ds_read_b128 v[212:215], v7 offset:20480
    s_waitcnt lgkmcnt(3)
    v_mfma_f32_16x16x32_bf16 v[48:51], v[200:203], v[160:163], v[48:51]
    v_mfma_f32_16x16x32_bf16 v[84:87], v[200:203], v[164:167], v[84:87]
    s_add_u32 m0, s37, 30720
    s_add_u32 s27, s32, 12288
    buffer_load_dwordx4 v4, s[8:11], s27 offen lds
    s_add_u32 s31, s31, 128
    s_add_u32 s32, s32, 18432
    v_mfma_f32_16x16x32_bf16 v[120:123], v[200:203], v[168:171], v[120:123]
    v_mfma_f32_16x16x32_bf16 v[156:159], v[200:203], v[172:175], v[156:159]
    s_waitcnt vmcnt(10)
    s_barrier
    ds_read_b128 v[192:195], v7 offset:21504
    s_waitcnt lgkmcnt(3)
    v_mfma_f32_16x16x32_bf16 v[16:19], v[204:207], v[176:179], v[16:19]
    v_mfma_f32_16x16x32_bf16 v[52:55], v[204:207], v[180:183], v[52:55]
    s_add_u32 m0, s42, 12288
    s_nop 0
    buffer_load_dwordx4 v13, s[8:11], s35 offen lds
    s_add_u32 s35, s35, 147456
    v_mfma_f32_16x16x32_bf16 v[88:91], v[204:207], v[184:187], v[88:91]
    v_mfma_f32_16x16x32_bf16 v[124:127], v[204:207], v[188:191], v[124:127]
    s_mov_b32 m0, s40
    s_nop 0
    buffer_load_dwordx4 v14, s[8:11], s33 offen lds
    s_add_u32 s33, s33, s34
    ds_read_b128 v[196:199], v7 offset:22528
    ds_read_b128 v[160:163], v5 offset:0
    s_waitcnt lgkmcnt(4)
    v_mfma_f32_16x16x32_bf16 v[20:23], v[208:211], v[176:179], v[20:23]
    v_mfma_f32_16x16x32_bf16 v[56:59], v[208:211], v[180:183], v[56:59]
    s_add_u32 m0, s36, 32768
    s_add_u32 s27, s31, 0
    buffer_load_dwordx4 v2, s[12:15], s27 offen lds
    v_mfma_f32_16x16x32_bf16 v[92:95], v[208:211], v[184:187], v[92:95]
    v_mfma_f32_16x16x32_bf16 v[128:131], v[208:211], v[188:191], v[128:131]
    ds_read_b128 v[200:203], v7 offset:23552
    ds_read_b128 v[164:167], v5 offset:2048
    s_waitcnt lgkmcnt(5)
    v_mfma_f32_16x16x32_bf16 v[24:27], v[212:215], v[176:179], v[24:27]
    v_mfma_f32_16x16x32_bf16 v[60:63], v[212:215], v[180:183], v[60:63]
    s_add_u32 m0, s36, 33792
    s_add_u32 s27, s31, 32768
    buffer_load_dwordx4 v3, s[12:15], s27 offen lds
    v_mfma_f32_16x16x32_bf16 v[96:99], v[212:215], v[184:187], v[96:99]
    v_mfma_f32_16x16x32_bf16 v[132:135], v[212:215], v[188:191], v[132:135]
    ds_read_b128 v[204:207], v7 offset:24576
    ds_read_b128 v[168:171], v12 offset:0
    s_waitcnt lgkmcnt(6)
    v_mfma_f32_16x16x32_bf16 v[28:31], v[192:195], v[176:179], v[28:31]
    v_mfma_f32_16x16x32_bf16 v[64:67], v[192:195], v[180:183], v[64:67]
    s_add_u32 m0, s36, 34816
    s_add_u32 s27, s31, 65536
    buffer_load_dwordx4 v2, s[12:15], s27 offen lds
    v_mfma_f32_16x16x32_bf16 v[100:103], v[192:195], v[184:187], v[100:103]
    v_mfma_f32_16x16x32_bf16 v[136:139], v[192:195], v[188:191], v[136:139]
    ds_read_b128 v[208:211], v7 offset:25600
    ds_read_b128 v[172:175], v12 offset:2048
    s_waitcnt lgkmcnt(7)
    v_mfma_f32_16x16x32_bf16 v[32:35], v[196:199], v[176:179], v[32:35]
    v_mfma_f32_16x16x32_bf16 v[68:71], v[196:199], v[180:183], v[68:71]
    s_add_u32 m0, s36, 35840
    s_add_u32 s27, s31, 98304
    buffer_load_dwordx4 v3, s[12:15], s27 offen lds
    v_mfma_f32_16x16x32_bf16 v[104:107], v[196:199], v[184:187], v[104:107]
    v_mfma_f32_16x16x32_bf16 v[140:143], v[196:199], v[188:191], v[140:143]
    ds_read_b128 v[212:215], v7 offset:26624
    s_waitcnt lgkmcnt(6)
    v_mfma_f32_16x16x32_bf16 v[36:39], v[200:203], v[176:179], v[36:39]
    v_mfma_f32_16x16x32_bf16 v[72:75], v[200:203], v[180:183], v[72:75]
    s_add_u32 m0, s37, 36864
    s_add_u32 s27, s32, 0
    buffer_load_dwordx4 v4, s[8:11], s27 offen lds
    v_mfma_f32_16x16x32_bf16 v[108:111], v[200:203], v[184:187], v[108:111]
    v_mfma_f32_16x16x32_bf16 v[144:147], v[200:203], v[188:191], v[144:147]
    ds_read_b128 v[192:195], v6 offset:0
    s_waitcnt lgkmcnt(5)
    v_mfma_f32_16x16x32_bf16 v[40:43], v[204:207], v[176:179], v[40:43]
    v_mfma_f32_16x16x32_bf16 v[76:79], v[204:207], v[180:183], v[76:79]
    s_add_u32 m0, s37, 40960
    s_add_u32 s27, s32, 4096
    buffer_load_dwordx4 v4, s[8:11], s27 offen lds
    v_mfma_f32_16x16x32_bf16 v[112:115], v[204:207], v[184:187], v[112:115]
    v_mfma_f32_16x16x32_bf16 v[148:151], v[204:207], v[188:191], v[148:151]
    ds_read_b128 v[196:199], v6 offset:1024
    s_waitcnt lgkmcnt(4)
    v_mfma_f32_16x16x32_bf16 v[44:47], v[208:211], v[176:179], v[44:47]
    v_mfma_f32_16x16x32_bf16 v[80:83], v[208:211], v[180:183], v[80:83]
    s_add_u32 m0, s37, 45056
    s_add_u32 s27, s32, 8192
    buffer_load_dwordx4 v4, s[8:11], s27 offen lds
    v_mfma_f32_16x16x32_bf16 v[116:119], v[208:211], v[184:187], v[116:119]
    v_mfma_f32_16x16x32_bf16 v[152:155], v[208:211], v[188:191], v[152:155]
    ds_read_b128 v[200:203], v6 offset:2048
    s_waitcnt lgkmcnt(3)
    v_mfma_f32_16x16x32_bf16 v[48:51], v[212:215], v[176:179], v[48:51]
    v_mfma_f32_16x16x32_bf16 v[84:87], v[212:215], v[180:183], v[84:87]
    s_add_u32 m0, s37, 49152
    s_add_u32 s27, s32, 12288
    buffer_load_dwordx4 v4, s[8:11], s27 offen lds
    s_add_u32 s31, s31, 128
    s_add_u32 s32, s32, 18432
    v_mfma_f32_16x16x32_bf16 v[120:123], v[212:215], v[184:187], v[120:123]
    v_mfma_f32_16x16x32_bf16 v[156:159], v[212:215], v[188:191], v[156:159]
    s_sub_u32 s30, s30, 1
    s_cmp_lg_u32 s30, 0
    s_cbranch_scc1 g_loop_122
    s_waitcnt vmcnt(10)
    s_barrier
    ds_read_b128 v[204:207], v6 offset:3072
    s_waitcnt lgkmcnt(3)
    v_mfma_f32_16x16x32_bf16 v[16:19], v[192:195], v[160:163], v[16:19]
    v_mfma_f32_16x16x32_bf16 v[52:55], v[192:195], v[164:167], v[52:55]
    s_add_u32 m0, s42, 18432
    s_nop 0
    buffer_load_dwordx4 v13, s[8:11], s35 offen lds
    s_add_u32 s35, s35, 73728
    v_mfma_f32_16x16x32_bf16 v[88:91], v[192:195], v[168:171], v[88:91]
    v_mfma_f32_16x16x32_bf16 v[124:127], v[192:195], v[172:175], v[124:127]
    s_mov_b32 m0, s41
    s_nop 0
    buffer_load_dwordx4 v14, s[8:11], s33 offen lds
    s_add_u32 s33, s33, s50
    ds_read_b128 v[208:211], v6 offset:4096
    ds_read_b128 v[176:179], v5 offset:16384
    s_waitcnt lgkmcnt(4)
    v_mfma_f32_16x16x32_bf16 v[20:23], v[196:199], v[160:163], v[20:23]
    v_mfma_f32_16x16x32_bf16 v[56:59], v[196:199], v[164:167], v[56:59]
    s_add_u32 m0, s36, 49152
    s_add_u32 s27, s31, 0
    buffer_load_dwordx4 v2, s[12:15], s27 offen lds
    v_mfma_f32_16x16x32_bf16 v[92:95], v[196:199], v[168:171], v[92:95]
    v_mfma_f32_16x16x32_bf16 v[128:131], v[196:199], v[172:175], v[128:131]
    ds_read_b128 v[212:215], v6 offset:5120
    ds_read_b128 v[180:183], v5 offset:18432
    s_waitcnt lgkmcnt(5)
    v_mfma_f32_16x16x32_bf16 v[24:27], v[200:203], v[160:163], v[24:27]
    v_mfma_f32_16x16x32_bf16 v[60:63], v[200:203], v[164:167], v[60:63]
    s_add_u32 m0, s36, 50176
    s_add_u32 s27, s31, 32768
    buffer_load_dwordx4 v3, s[12:15], s27 offen lds
    v_mfma_f32_16x16x32_bf16 v[96:99], v[200:203], v[168:171], v[96:99]
    v_mfma_f32_16x16x32_bf16 v[132:135], v[200:203], v[172:175], v[132:135]
    ds_read_b128 v[192:195], v6 offset:6144
    ds_read_b128 v[184:187], v12 offset:16384
    s_waitcnt lgkmcnt(6)
    v_mfma_f32_16x16x32_bf16 v[28:31], v[204:207], v[160:163], v[28:31]
    v_mfma_f32_16x16x32_bf16 v[64:67], v[204:207], v[164:167], v[64:67]
    s_add_u32 m0, s36, 51200
    s_add_u32 s27, s31, 65536
    buffer_load_dwordx4 v2, s[12:15], s27 offen lds
    v_mfma_f32_16x16x32_bf16 v[100:103], v[204:207], v[168:171], v[100:103]
    v_mfma_f32_16x16x32_bf16 v[136:139], v[204:207], v[172:175], v[136:139]
    ds_read_b128 v[196:199], v6 offset:7168
    ds_read_b128 v[188:191], v12 offset:18432
    s_waitcnt lgkmcnt(7)
    v_mfma_f32_16x16x32_bf16 v[32:35], v[208:211], v[160:163], v[32:35]
    v_mfma_f32_16x16x32_bf16 v[68:71], v[208:211], v[164:167], v[68:71]
    s_add_u32 m0, s36, 52224
    s_add_u32 s27, s31, 98304
    buffer_load_dwordx4 v3, s[12:15], s27 offen lds
    v_mfma_f32_16x16x32_bf16 v[104:107], v[208:211], v[168:171], v[104:107]
    v_mfma_f32_16x16x32_bf16 v[140:143], v[208:211], v[172:175], v[140:143]
    ds_read_b128 v[200:203], v6 offset:8192
    s_waitcnt lgkmcnt(6)
    v_mfma_f32_16x16x32_bf16 v[36:39], v[212:215], v[160:163], v[36:39]
    v_mfma_f32_16x16x32_bf16 v[72:75], v[212:215], v[164:167], v[72:75]
    s_add_u32 m0, s37, 55296
    s_add_u32 s27, s32, 0
    buffer_load_dwordx4 v4, s[8:11], s27 offen lds
    v_mfma_f32_16x16x32_bf16 v[108:111], v[212:215], v[168:171], v[108:111]
    v_mfma_f32_16x16x32_bf16 v[144:147], v[212:215], v[172:175], v[144:147]
    ds_read_b128 v[204:207], v6 offset:18432
    s_waitcnt lgkmcnt(5)
    v_mfma_f32_16x16x32_bf16 v[40:43], v[192:195], v[160:163], v[40:43]
    v_mfma_f32_16x16x32_bf16 v[76:79], v[192:195], v[164:167], v[76:79]
    s_add_u32 m0, s37, 59392
    s_add_u32 s27, s32, 4096
    buffer_load_dwordx4 v4, s[8:11], s27 offen lds
    v_mfma_f32_16x16x32_bf16 v[112:115], v[192:195], v[168:171], v[112:115]
    v_mfma_f32_16x16x32_bf16 v[148:151], v[192:195], v[172:175], v[148:151]
    ds_read_b128 v[208:211], v6 offset:19456
    s_waitcnt lgkmcnt(4)
    v_mfma_f32_16x16x32_bf16 v[44:47], v[196:199], v[160:163], v[44:47]
    v_mfma_f32_16x16x32_bf16 v[80:83], v[196:199], v[164:167], v[80:83]
    s_add_u32 m0, s37, 63488
    s_add_u32 s27, s32, 8192
    buffer_load_dwordx4 v4, s[8:11], s27 offen lds
    v_mfma_f32_16x16x32_bf16 v[116:119], v[196:199], v[168:171], v[116:119]
    v_mfma_f32_16x16x32_bf16 v[152:155], v[196:199], v[172:175], v[152:155]
    ds_read_b128 v[212:215], v6 offset:20480
    s_waitcnt lgkmcnt(3)
    v_mfma_f32_16x16x32_bf16 v[48:51], v[200:203], v[160:163], v[48:51]
    v_mfma_f32_16x16x32_bf16 v[84:87], v[200:203], v[164:167], v[84:87]
    s_add_u32 m0, s37, 67584
    s_add_u32 s27, s32, 12288
    buffer_load_dwordx4 v4, s[8:11], s27 offen lds
    s_add_u32 s31, s31, 128
    s_add_u32 s32, s32, 18432
    v_mfma_f32_16x16x32_bf16 v[120:123], v[200:203], v[168:171], v[120:123]
    v_mfma_f32_16x16x32_bf16 v[156:159], v[200:203], v[172:175], v[156:159]
    s_waitcnt vmcnt(10)
    s_barrier
    ds_read_b128 v[192:195], v6 offset:21504
    s_waitcnt lgkmcnt(3)
    v_mfma_f32_16x16x32_bf16 v[16:19], v[204:207], v[176:179], v[16:19]
    v_mfma_f32_16x16x32_bf16 v[52:55], v[204:207], v[180:183], v[52:55]
    s_add_u32 m0, s42, 0x0
    s_mov_b32 s27, 30801920
    buffer_load_dwordx4 v13, s[8:11], s27 offen lds
    v_mfma_f32_16x16x32_bf16 v[88:91], v[204:207], v[184:187], v[88:91]
    v_mfma_f32_16x16x32_bf16 v[124:127], v[204:207], v[188:191], v[124:127]
    s_add_u32 m0, s51, 143360
    s_nop 0
    buffer_load_dwordx4 v15, s[8:11], s27 offen lds
    ds_read_b128 v[196:199], v6 offset:22528
    ds_read_b128 v[160:163], v5 offset:32768
    s_waitcnt lgkmcnt(4)
    v_mfma_f32_16x16x32_bf16 v[20:23], v[208:211], v[176:179], v[20:23]
    v_mfma_f32_16x16x32_bf16 v[56:59], v[208:211], v[180:183], v[56:59]
    buffer_load_dwordx4 v[216:219], v8, s[8:11], s43 offen offset:0
    v_mfma_f32_16x16x32_bf16 v[92:95], v[208:211], v[184:187], v[92:95]
    v_mfma_f32_16x16x32_bf16 v[128:131], v[208:211], v[188:191], v[128:131]
    buffer_load_dwordx4 v[220:223], v8, s[8:11], s43 offen offset:1024
    ds_read_b128 v[200:203], v6 offset:23552
    ds_read_b128 v[164:167], v5 offset:34816
    s_waitcnt lgkmcnt(5)
    v_mfma_f32_16x16x32_bf16 v[24:27], v[212:215], v[176:179], v[24:27]
    v_mfma_f32_16x16x32_bf16 v[60:63], v[212:215], v[180:183], v[60:63]
    buffer_load_dwordx4 v[224:227], v8, s[8:11], s43 offen offset:2048
    v_mfma_f32_16x16x32_bf16 v[96:99], v[212:215], v[184:187], v[96:99]
    v_mfma_f32_16x16x32_bf16 v[132:135], v[212:215], v[188:191], v[132:135]
    buffer_load_dwordx4 v[228:231], v8, s[8:11], s43 offen offset:3072
    ds_read_b128 v[204:207], v6 offset:24576
    ds_read_b128 v[168:171], v12 offset:32768
    s_waitcnt lgkmcnt(6)
    v_mfma_f32_16x16x32_bf16 v[28:31], v[192:195], v[176:179], v[28:31]
    v_mfma_f32_16x16x32_bf16 v[64:67], v[192:195], v[180:183], v[64:67]
    buffer_load_dwordx4 v[232:235], v8, s[8:11], s47 offen offset:0
    v_mfma_f32_16x16x32_bf16 v[100:103], v[192:195], v[184:187], v[100:103]
    v_mfma_f32_16x16x32_bf16 v[136:139], v[192:195], v[188:191], v[136:139]
    buffer_load_dwordx4 v[236:239], v8, s[8:11], s47 offen offset:1024
    ds_read_b128 v[208:211], v6 offset:25600
    ds_read_b128 v[172:175], v12 offset:34816
    s_waitcnt lgkmcnt(7)
    v_mfma_f32_16x16x32_bf16 v[32:35], v[196:199], v[176:179], v[32:35]
    v_mfma_f32_16x16x32_bf16 v[68:71], v[196:199], v[180:183], v[68:71]
    buffer_load_dwordx4 v[240:243], v8, s[8:11], s47 offen offset:2048
    v_mfma_f32_16x16x32_bf16 v[104:107], v[196:199], v[184:187], v[104:107]
    v_mfma_f32_16x16x32_bf16 v[140:143], v[196:199], v[188:191], v[140:143]
    buffer_load_dwordx4 v[244:247], v8, s[8:11], s47 offen offset:3072
    ds_read_b128 v[212:215], v6 offset:26624
    s_waitcnt lgkmcnt(6)
    v_mfma_f32_16x16x32_bf16 v[36:39], v[200:203], v[176:179], v[36:39]
    v_mfma_f32_16x16x32_bf16 v[72:75], v[200:203], v[180:183], v[72:75]
    buffer_load_dwordx2 v[248:249], v9, s[8:11], s43 offen
    v_mfma_f32_16x16x32_bf16 v[108:111], v[200:203], v[184:187], v[108:111]
    v_mfma_f32_16x16x32_bf16 v[144:147], v[200:203], v[188:191], v[144:147]
    buffer_load_dwordx2 v[250:251], v9, s[8:11], s47 offen
    ds_read_b128 v[192:195], v7 offset:0
    s_waitcnt lgkmcnt(5)
    v_mfma_f32_16x16x32_bf16 v[40:43], v[204:207], v[176:179], v[40:43]
    v_mfma_f32_16x16x32_bf16 v[76:79], v[204:207], v[180:183], v[76:79]
    s_add_u32 m0, s42, 0xfffde000
    s_mov_b32 s27, 31244288
    buffer_load_dwordx4 v13, s[8:11], s27 offen lds
    v_mfma_f32_16x16x32_bf16 v[112:115], v[204:207], v[184:187], v[112:115]
    v_mfma_f32_16x16x32_bf16 v[148:151], v[204:207], v[188:191], v[148:151]
    s_add_u32 m0, s51, 4096
    s_nop 0
    buffer_load_dwordx4 v15, s[8:11], s27 offen lds
    ds_read_b128 v[196:199], v7 offset:1024
    s_waitcnt lgkmcnt(4)
    v_mfma_f32_16x16x32_bf16 v[44:47], v[208:211], v[176:179], v[44:47]
    v_mfma_f32_16x16x32_bf16 v[80:83], v[208:211], v[180:183], v[80:83]
    s_add_u32 m0, s42, 0xfffdf800
    s_mov_b32 s27, 31391744
    buffer_load_dwordx4 v13, s[8:11], s27 offen lds
    v_mfma_f32_16x16x32_bf16 v[116:119], v[208:211], v[184:187], v[116:119]
    v_mfma_f32_16x16x32_bf16 v[152:155], v[208:211], v[188:191], v[152:155]
    ds_read_b128 v[200:203], v7 offset:2048
    s_waitcnt lgkmcnt(3)
    v_mfma_f32_16x16x32_bf16 v[48:51], v[212:215], v[176:179], v[48:51]
    v_mfma_f32_16x16x32_bf16 v[84:87], v[212:215], v[180:183], v[84:87]
    s_add_u32 m0, s51, 10240
    s_nop 0
    buffer_load_dwordx4 v15, s[8:11], s27 offen lds
    v_mfma_f32_16x16x32_bf16 v[120:123], v[212:215], v[184:187], v[120:123]
    v_mfma_f32_16x16x32_bf16 v[156:159], v[212:215], v[188:191], v[156:159]
    s_waitcnt vmcnt(16)
    s_barrier
    ds_read_b128 v[204:207], v7 offset:3072
    s_waitcnt lgkmcnt(3)
    v_mfma_f32_16x16x32_bf16 v[16:19], v[192:195], v[160:163], v[16:19]
    v_mfma_f32_16x16x32_bf16 v[52:55], v[192:195], v[164:167], v[52:55]
    s_add_u32 m0, s42, 0x1800
    s_mov_b32 s27, 30949376
    buffer_load_dwordx4 v13, s[8:11], s27 offen lds
    v_mfma_f32_16x16x32_bf16 v[88:91], v[192:195], v[168:171], v[88:91]
    v_mfma_f32_16x16x32_bf16 v[124:127], v[192:195], v[172:175], v[124:127]
    s_add_u32 m0, s51, 149504
    s_nop 0
    buffer_load_dwordx4 v15, s[8:11], s27 offen lds
    ds_read_b128 v[208:211], v7 offset:4096
    ds_read_b128 v[176:179], v5 offset:49152
    s_waitcnt lgkmcnt(4)
    v_mfma_f32_16x16x32_bf16 v[20:23], v[196:199], v[160:163], v[20:23]
    v_mfma_f32_16x16x32_bf16 v[56:59], v[196:199], v[164:167], v[56:59]
    s_add_u32 m0, s42, 0xfffe1000
    s_mov_b32 s27, 31539200
    buffer_load_dwordx4 v13, s[8:11], s27 offen lds
    v_mfma_f32_16x16x32_bf16 v[92:95], v[196:199], v[168:171], v[92:95]
    v_mfma_f32_16x16x32_bf16 v[128:131], v[196:199], v[172:175], v[128:131]
    ds_read_b128 v[212:215], v7 offset:5120
    ds_read_b128 v[180:183], v5 offset:51200
    s_waitcnt lgkmcnt(5)
    v_mfma_f32_16x16x32_bf16 v[24:27], v[200:203], v[160:163], v[24:27]
    v_mfma_f32_16x16x32_bf16 v[60:63], v[200:203], v[164:167], v[60:63]
    s_add_u32 m0, s51, 16384
    s_nop 0
    buffer_load_dwordx4 v15, s[8:11], s27 offen lds
    v_mfma_f32_16x16x32_bf16 v[96:99], v[200:203], v[168:171], v[96:99]
    v_mfma_f32_16x16x32_bf16 v[132:135], v[200:203], v[172:175], v[132:135]
    ds_read_b128 v[192:195], v7 offset:6144
    ds_read_b128 v[184:187], v12 offset:49152
    s_waitcnt lgkmcnt(6)
    v_mfma_f32_16x16x32_bf16 v[28:31], v[204:207], v[160:163], v[28:31]
    v_mfma_f32_16x16x32_bf16 v[64:67], v[204:207], v[164:167], v[64:67]
    s_add_u32 m0, s42, 0xfffe2800
    s_mov_b32 s27, 31686656
    buffer_load_dwordx4 v13, s[8:11], s27 offen lds
    v_mfma_f32_16x16x32_bf16 v[100:103], v[204:207], v[168:171], v[100:103]
    v_mfma_f32_16x16x32_bf16 v[136:139], v[204:207], v[172:175], v[136:139]
    ds_read_b128 v[196:199], v7 offset:7168
    ds_read_b128 v[188:191], v12 offset:51200
    s_waitcnt lgkmcnt(7)
    v_mfma_f32_16x16x32_bf16 v[32:35], v[208:211], v[160:163], v[32:35]
    v_mfma_f32_16x16x32_bf16 v[68:71], v[208:211], v[164:167], v[68:71]
    s_add_u32 m0, s51, 22528
    s_nop 0
    buffer_load_dwordx4 v15, s[8:11], s27 offen lds
    v_mfma_f32_16x16x32_bf16 v[104:107], v[208:211], v[168:171], v[104:107]
    v_mfma_f32_16x16x32_bf16 v[140:143], v[208:211], v[172:175], v[140:143]
    ds_read_b128 v[200:203], v7 offset:8192
    s_waitcnt lgkmcnt(6)
    v_mfma_f32_16x16x32_bf16 v[36:39], v[212:215], v[160:163], v[36:39]
    v_mfma_f32_16x16x32_bf16 v[72:75], v[212:215], v[164:167], v[72:75]
    s_add_u32 m0, s42, 0xfffe4000
    s_mov_b32 s27, 31834112
    buffer_load_dwordx4 v13, s[8:11], s27 offen lds
    v_mfma_f32_16x16x32_bf16 v[108:111], v[212:215], v[168:171], v[108:111]
    v_mfma_f32_16x16x32_bf16 v[144:147], v[212:215], v[172:175], v[144:147]
    ds_read_b128 v[204:207], v7 offset:18432
    s_waitcnt lgkmcnt(5)
    v_mfma_f32_16x16x32_bf16 v[40:43], v[192:195], v[160:163], v[40:43]
    v_mfma_f32_16x16x32_bf16 v[76:79], v[192:195], v[164:167], v[76:79]
    s_add_u32 m0, s51, 28672
    s_nop 0
    buffer_load_dwordx4 v15, s[8:11], s27 offen lds
    v_mfma_f32_16x16x32_bf16 v[112:115], v[192:195], v[168:171], v[112:115]
    v_mfma_f32_16x16x32_bf16 v[148:151], v[192:195], v[172:175], v[148:151]
    ds_read_b128 v[208:211], v7 offset:19456
    s_waitcnt lgkmcnt(4)
    v_mfma_f32_16x16x32_bf16 v[44:47], v[196:199], v[160:163], v[44:47]
    v_mfma_f32_16x16x32_bf16 v[80:83], v[196:199], v[164:167], v[80:83]
    v_mfma_f32_16x16x32_bf16 v[116:119], v[196:199], v[168:171], v[116:119]
    v_mfma_f32_16x16x32_bf16 v[152:155], v[196:199], v[172:175], v[152:155]
    ds_read_b128 v[212:215], v7 offset:20480
    s_waitcnt lgkmcnt(3)
    v_mfma_f32_16x16x32_bf16 v[48:51], v[200:203], v[160:163], v[48:51]
    v_mfma_f32_16x16x32_bf16 v[84:87], v[200:203], v[164:167], v[84:87]
    v_mfma_f32_16x16x32_bf16 v[120:123], v[200:203], v[168:171], v[120:123]
    v_mfma_f32_16x16x32_bf16 v[156:159], v[200:203], v[172:175], v[156:159]
    s_waitcnt vmcnt(22)
    s_barrier
    ds_read_b128 v[192:195], v7 offset:21504
    s_waitcnt lgkmcnt(3)
    v_mfma_f32_16x16x32_bf16 v[16:19], v[204:207], v[176:179], v[16:19]
    v_mfma_f32_16x16x32_bf16 v[52:55], v[204:207], v[180:183], v[52:55]
    s_add_u32 m0, s42, 0x3000
    s_mov_b32 s27, 31096832
    buffer_load_dwordx4 v13, s[8:11], s27 offen lds
    v_mfma_f32_16x16x32_bf16 v[88:91], v[204:207], v[184:187], v[88:91]
    v_mfma_f32_16x16x32_bf16 v[124:127], v[204:207], v[188:191], v[124:127]
    s_add_u32 m0, s51, 155648
    s_nop 0
    buffer_load_dwordx4 v15, s[8:11], s27 offen lds
    ds_read_b128 v[196:199], v7 offset:22528
    s_waitcnt lgkmcnt(3)
    v_mfma_f32_16x16x32_bf16 v[20:23], v[208:211], v[176:179], v[20:23]
    v_mfma_f32_16x16x32_bf16 v[56:59], v[208:211], v[180:183], v[56:59]
    v_mfma_f32_16x16x32_bf16 v[92:95], v[208:211], v[184:187], v[92:95]
    v_mfma_f32_16x16x32_bf16 v[128:131], v[208:211], v[188:191], v[128:131]
    ds_read_b128 v[200:203], v7 offset:23552
    ds_write_b128 v10, v[88:91] offset:0
    ds_write_b128 v10, v[124:127] offset:9216
    s_waitcnt lgkmcnt(5)
    v_mfma_f32_16x16x32_bf16 v[24:27], v[212:215], v[176:179], v[24:27]
    v_mfma_f32_16x16x32_bf16 v[60:63], v[212:215], v[180:183], v[60:63]
    v_mfma_f32_16x16x32_bf16 v[96:99], v[212:215], v[184:187], v[96:99]
    v_mfma_f32_16x16x32_bf16 v[132:135], v[212:215], v[188:191], v[132:135]
    ds_read_b128 v[204:207], v7 offset:24576
    ds_write_b128 v10, v[92:95] offset:1024
    ds_write_b128 v10, v[128:131] offset:10240
    s_waitcnt lgkmcnt(7)
    v_mfma_f32_16x16x32_bf16 v[28:31], v[192:195], v[176:179], v[28:31]
    v_mfma_f32_16x16x32_bf16 v[64:67], v[192:195], v[180:183], v[64:67]
    v_mfma_f32_16x16x32_bf16 v[100:103], v[192:195], v[184:187], v[100:103]
    v_mfma_f32_16x16x32_bf16 v[136:139], v[192:195], v[188:191], v[136:139]
    ds_read_b128 v[208:211], v7 offset:25600
    ds_write_b128 v10, v[96:99] offset:2048
    ds_write_b128 v10, v[132:135] offset:11264
    s_waitcnt lgkmcnt(9)
    v_mfma_f32_16x16x32_bf16 v[32:35], v[196:199], v[176:179], v[32:35]
    v_mfma_f32_16x16x32_bf16 v[68:71], v[196:199], v[180:183], v[68:71]
    v_mfma_f32_16x16x32_bf16 v[104:107], v[196:199], v[184:187], v[104:107]
    v_mfma_f32_16x16x32_bf16 v[140:143], v[196:199], v[188:191], v[140:143]
    ds_read_b128 v[212:215], v7 offset:26624
    ds_write_b128 v10, v[100:103] offset:3072
    ds_write_b128 v10, v[136:139] offset:12288
    s_waitcnt lgkmcnt(11)
    v_mfma_f32_16x16x32_bf16 v[36:39], v[200:203], v[176:179], v[36:39]
    v_mfma_f32_16x16x32_bf16 v[72:75], v[200:203], v[180:183], v[72:75]
    v_mfma_f32_16x16x32_bf16 v[108:111], v[200:203], v[184:187], v[108:111]
    v_mfma_f32_16x16x32_bf16 v[144:147], v[200:203], v[188:191], v[144:147]
    ds_write_b128 v10, v[104:107] offset:4096
    ds_write_b128 v10, v[140:143] offset:13312
    s_waitcnt lgkmcnt(10)
    v_mfma_f32_16x16x32_bf16 v[40:43], v[204:207], v[176:179], v[40:43]
    v_mfma_f32_16x16x32_bf16 v[76:79], v[204:207], v[180:183], v[76:79]
    v_mfma_f32_16x16x32_bf16 v[112:115], v[204:207], v[184:187], v[112:115]
    v_mfma_f32_16x16x32_bf16 v[148:151], v[204:207], v[188:191], v[148:151]
    ds_write_b128 v10, v[108:111] offset:5120
    ds_write_b128 v10, v[144:147] offset:14336
    s_waitcnt lgkmcnt(9)
    v_mfma_f32_16x16x32_bf16 v[44:47], v[208:211], v[176:179], v[44:47]
    v_mfma_f32_16x16x32_bf16 v[80:83], v[208:211], v[180:183], v[80:83]
    v_mfma_f32_16x16x32_bf16 v[116:119], v[208:211], v[184:187], v[116:119]
    v_mfma_f32_16x16x32_bf16 v[152:155], v[208:211], v[188:191], v[152:155]
    ds_write_b128 v10, v[112:115] offset:6144
    ds_write_b128 v10, v[148:151] offset:15360
    s_waitcnt lgkmcnt(8)
    v_mfma_f32_16x16x32_bf16 v[48:51], v[212:215], v[176:179], v[48:51]
    v_mfma_f32_16x16x32_bf16 v[84:87], v[212:215], v[180:183], v[84:87]
    v_mfma_f32_16x16x32_bf16 v[120:123], v[212:215], v[184:187], v[120:123]
    v_mfma_f32_16x16x32_bf16 v[156:159], v[212:215], v[188:191], v[156:159]
    s_setprio 3
    s_nop 7
    ds_write_b128 v10, v[116:119] offset:7168
    ds_write_b128 v10, v[152:155] offset:16384
    ds_write_b128 v10, v[120:123] offset:8192
    ds_write_b128 v10, v[156:159] offset:17408
    v_mov_b32 v13, 163328
    v_mov_b32 v14, 0
    v_mov_b32 v15, 0
    ds_write_b64 v13, v[14:15]
    s_waitcnt vmcnt(0) lgkmcnt(0)
    s_barrier
    s_and_b32 s27, s2, 1
    s_lshl_b32 s27, s27, 2
    s_bfe_u32 s28, s2, 0x20003
    s_add_u32 s27, s27, s28
    s_mul_i32 s27, s27, 90
    s_mul_i32 s28, s22, 18
    s_add_u32 s27, s27, s28
    s_mul_i32 s27, s27, 4608
    s_add_u32 s27, s27, 32505856
    v_and_b32 v160, 15, v1
    v_lshrrev_b32 v161, 4, v1
    v_lshlrev_b32 v162, 4, v160
    v_lshl_add_u32 v162, v161, 7, v162
    v_add_u32 v162, 4096, v162
    v_mov_b32 v163, 0x7f000000
    v_cmp_gt_u32 vcc, 8, v160
    s_nop 1
    v_cndmask_b32 v252, v163, v162, vcc
    buffer_load_dwordx4 v[168:171], v4, s[8:11], s27 offen offset:0
    buffer_load_dwordx4 v[172:175], v4, s[8:11], s27 offen offset:1024
    buffer_load_dwordx4 v[176:179], v4, s[8:11], s27 offen offset:2048
    buffer_load_dwordx4 v[180:183], v4, s[8:11], s27 offen offset:3072
    buffer_load_dwordx4 v[184:187], v252, s[8:11], s27 offen
    s_add_u32 s27, s27, 4608
    buffer_load_dwordx4 v[188:191], v4, s[8:11], s27 offen offset:0
    buffer_load_dwordx4 v[192:195], v4, s[8:11], s27 offen offset:1024
    buffer_load_dwordx4 v[196:199], v4, s[8:11], s27 offen offset:2048
    buffer_load_dwordx4 v[200:203], v4, s[8:11], s27 offen offset:3072
    buffer_load_dwordx4 v[204:207], v252, s[8:11], s27 offen
    s_add_u32 s27, s27, 4608
    ds_read_b128 v[88:91], v11 offset:0
    ds_read_b128 v[92:95], v11 offset:1024
    ds_read_b128 v[96:99], v11 offset:2048
    ds_read_b128 v[100:103], v11 offset:3072
    ds_read_b128 v[104:107], v11 offset:4096
    ds_read_b128 v[108:111], v11 offset:5120
    ds_read_b128 v[112:115], v11 offset:6144
    ds_read_b128 v[116:119], v11 offset:7168
    ds_read_b128 v[120:123], v11 offset:8192
    ds_read_b128 v[124:127], v11 offset:9216
    ds_read_b128 v[128:131], v11 offset:10240
    ds_read_b128 v[132:135], v11 offset:11264
    ds_read_b128 v[136:139], v11 offset:12288
    ds_read_b128 v[140:143], v11 offset:13312
    s_waitcnt lgkmcnt(8)
    ds_read_b128 v[144:147], v11 offset:14336
    ds_read_b128 v[148:151], v11 offset:15360
    ds_read_b128 v[152:155], v11 offset:16384
    ds_read_b128 v[156:159], v11 offset:17408
    s_waitcnt lgkmcnt(15)
    v_add_f32 v16, v16, v88
    v_add_f32 v17, v17, v89
    v_lshlrev_b32 v160, 16, v216
    v_and_b32 v161, 0xffff0000, v216
    v_mul_f32 v16, v16, v160
    v_mul_f32 v17, v17, v161
    v_cvt_pk_bf16_f32 v216, v16, v17
    v_add_f32 v18, v18, v90
    v_add_f32 v19, v19, v91
    v_lshlrev_b32 v162, 16, v217
    v_and_b32 v163, 0xffff0000, v217
    v_mul_f32 v18, v18, v162
    v_mul_f32 v19, v19, v163
    v_cvt_pk_bf16_f32 v217, v18, v19
    v_add_f32 v20, v20, v92
    v_add_f32 v21, v21, v93
    v_lshlrev_b32 v164, 16, v218
    v_and_b32 v165, 0xffff0000, v218
    v_mul_f32 v20, v20, v164
    v_mul_f32 v21, v21, v165
    v_cvt_pk_bf16_f32 v218, v20, v21
    v_add_f32 v22, v22, v94
    v_add_f32 v23, v23, v95
    v_lshlrev_b32 v166, 16, v219
    v_and_b32 v167, 0xffff0000, v219
    v_mul_f32 v22, v22, v166
    v_mul_f32 v23, v23, v167
    v_cvt_pk_bf16_f32 v219, v22, v23
    buffer_store_dwordx4 v[216:219], v8, s[8:11], s43 offen offset:0 sc1
    s_waitcnt lgkmcnt(14)
    v_add_f32 v24, v24, v96
    v_add_f32 v25, v25, v97
    v_lshlrev_b32 v160, 16, v220
    v_and_b32 v161, 0xffff0000, v220
    v_mul_f32 v24, v24, v160
    v_mul_f32 v25, v25, v161
    v_cvt_pk_bf16_f32 v220, v24, v25
    v_add_f32 v26, v26, v98
    v_add_f32 v27, v27, v99
    v_lshlrev_b32 v162, 16, v221
    v_and_b32 v163, 0xffff0000, v221
    v_mul_f32 v26, v26, v162
    v_mul_f32 v27, v27, v163
    v_cvt_pk_bf16_f32 v221, v26, v27
    v_add_f32 v28, v28, v100
    v_add_f32 v29, v29, v101
    v_lshlrev_b32 v164, 16, v222
    v_and_b32 v165, 0xffff0000, v222
    v_mul_f32 v28, v28, v164
    v_mul_f32 v29, v29, v165
    v_cvt_pk_bf16_f32 v222, v28, v29
    v_add_f32 v30, v30, v102
    v_add_f32 v31, v31, v103
    v_lshlrev_b32 v166, 16, v223
    v_and_b32 v167, 0xffff0000, v223
    v_mul_f32 v30, v30, v166
    v_mul_f32 v31, v31, v167
    v_cvt_pk_bf16_f32 v223, v30, v31
    buffer_store_dwordx4 v[220:223], v8, s[8:11], s43 offen offset:1024 sc1
    s_waitcnt lgkmcnt(12)
    v_add_f32 v32, v32, v104
    v_add_f32 v33, v33, v105
    v_lshlrev_b32 v160, 16, v224
    v_and_b32 v161, 0xffff0000, v224
    v_mul_f32 v32, v32, v160
    v_mul_f32 v33, v33, v161
    v_cvt_pk_bf16_f32 v224, v32, v33
    v_add_f32 v34, v34, v106
    v_add_f32 v35, v35, v107
    v_lshlrev_b32 v162, 16, v225
    v_and_b32 v163, 0xffff0000, v225
    v_mul_f32 v34, v34, v162
    v_mul_f32 v35, v35, v163
    v_cvt_pk_bf16_f32 v225, v34, v35
    v_add_f32 v36, v36, v108
    v_add_f32 v37, v37, v109
    v_lshlrev_b32 v164, 16, v226
    v_and_b32 v165, 0xffff0000, v226
    v_mul_f32 v36, v36, v164
    v_mul_f32 v37, v37, v165
    v_cvt_pk_bf16_f32 v226, v36, v37
    v_add_f32 v38, v38, v110
    v_add_f32 v39, v39, v111
    v_lshlrev_b32 v166, 16, v227
    v_and_b32 v167, 0xffff0000, v227
    v_mul_f32 v38, v38, v166
    v_mul_f32 v39, v39, v167
    v_cvt_pk_bf16_f32 v227, v38, v39
    buffer_store_dwordx4 v[224:227], v8, s[8:11], s43 offen offset:2048 sc1
    s_waitcnt lgkmcnt(10)
    v_add_f32 v40, v40, v112
    v_add_f32 v41, v41, v113
    v_lshlrev_b32 v160, 16, v228
    v_and_b32 v161, 0xffff0000, v228
    v_mul_f32 v40, v40, v160
    v_mul_f32 v41, v41, v161
    v_cvt_pk_bf16_f32 v228, v40, v41
    v_add_f32 v42, v42, v114
    v_add_f32 v43, v43, v115
    v_lshlrev_b32 v162, 16, v229
    v_and_b32 v163, 0xffff0000, v229
    v_mul_f32 v42, v42, v162
    v_mul_f32 v43, v43, v163
    v_cvt_pk_bf16_f32 v229, v42, v43
    v_add_f32 v44, v44, v116
    v_add_f32 v45, v45, v117
    v_lshlrev_b32 v164, 16, v230
    v_and_b32 v165, 0xffff0000, v230
    v_mul_f32 v44, v44, v164
    v_mul_f32 v45, v45, v165
    v_cvt_pk_bf16_f32 v230, v44, v45
    v_add_f32 v46, v46, v118
    v_add_f32 v47, v47, v119
    v_lshlrev_b32 v166, 16, v231
    v_and_b32 v167, 0xffff0000, v231
    v_mul_f32 v46, v46, v166
    v_mul_f32 v47, v47, v167
    v_cvt_pk_bf16_f32 v231, v46, v47
    buffer_store_dwordx4 v[228:231], v8, s[8:11], s43 offen offset:3072 sc1
    s_waitcnt lgkmcnt(9)
    v_add_f32 v48, v48, v120
    v_add_f32 v49, v49, v121
    v_lshlrev_b32 v160, 16, v248
    v_and_b32 v161, 0xffff0000, v248
    v_mul_f32 v48, v48, v160
    v_mul_f32 v49, v49, v161
    v_cvt_pk_bf16_f32 v248, v48, v49
    v_add_f32 v50, v50, v122
    v_add_f32 v51, v51, v123
    v_lshlrev_b32 v162, 16, v249
    v_and_b32 v163, 0xffff0000, v249
    v_mul_f32 v50, v50, v162
    v_mul_f32 v51, v51, v163
    v_cvt_pk_bf16_f32 v249, v50, v51
    buffer_store_dwordx2 v[248:249], v9, s[8:11], s43 offen sc1
    s_waitcnt lgkmcnt(7)
    v_add_f32 v52, v52, v124
    v_add_f32 v53, v53, v125
    v_lshlrev_b32 v160, 16, v232
    v_and_b32 v161, 0xffff0000, v232
    v_mul_f32 v52, v52, v160
    v_mul_f32 v53, v53, v161
    v_cvt_pk_bf16_f32 v232, v52, v53
    v_add_f32 v54, v54, v126
    v_add_f32 v55, v55, v127
    v_lshlrev_b32 v162, 16, v233
    v_and_b32 v163, 0xffff0000, v233
    v_mul_f32 v54, v54, v162
    v_mul_f32 v55, v55, v163
    v_cvt_pk_bf16_f32 v233, v54, v55
    v_add_f32 v56, v56, v128
    v_add_f32 v57, v57, v129
    v_lshlrev_b32 v164, 16, v234
    v_and_b32 v165, 0xffff0000, v234
    v_mul_f32 v56, v56, v164
    v_mul_f32 v57, v57, v165
    v_cvt_pk_bf16_f32 v234, v56, v57
    v_add_f32 v58, v58, v130
    v_add_f32 v59, v59, v131
    v_lshlrev_b32 v166, 16, v235
    v_and_b32 v167, 0xffff0000, v235
    v_mul_f32 v58, v58, v166
    v_mul_f32 v59, v59, v167
    v_cvt_pk_bf16_f32 v235, v58, v59
    buffer_store_dwordx4 v[232:235], v8, s[8:11], s47 offen offset:0 sc1
    s_waitcnt lgkmcnt(5)
    v_add_f32 v60, v60, v132
    v_add_f32 v61, v61, v133
    v_lshlrev_b32 v160, 16, v236
    v_and_b32 v161, 0xffff0000, v236
    v_mul_f32 v60, v60, v160
    v_mul_f32 v61, v61, v161
    v_cvt_pk_bf16_f32 v236, v60, v61
    v_add_f32 v62, v62, v134
    v_add_f32 v63, v63, v135
    v_lshlrev_b32 v162, 16, v237
    v_and_b32 v163, 0xffff0000, v237
    v_mul_f32 v62, v62, v162
    v_mul_f32 v63, v63, v163
    v_cvt_pk_bf16_f32 v237, v62, v63
    v_add_f32 v64, v64, v136
    v_add_f32 v65, v65, v137
    v_lshlrev_b32 v164, 16, v238
    v_and_b32 v165, 0xffff0000, v238
    v_mul_f32 v64, v64, v164
    v_mul_f32 v65, v65, v165
    v_cvt_pk_bf16_f32 v238, v64, v65
    v_add_f32 v66, v66, v138
    v_add_f32 v67, v67, v139
    v_lshlrev_b32 v166, 16, v239
    v_and_b32 v167, 0xffff0000, v239
    v_mul_f32 v66, v66, v166
    v_mul_f32 v67, v67, v167
    v_cvt_pk_bf16_f32 v239, v66, v67
    buffer_store_dwordx4 v[236:239], v8, s[8:11], s47 offen offset:1024 sc1
    s_waitcnt lgkmcnt(3)
    v_add_f32 v68, v68, v140
    v_add_f32 v69, v69, v141
    v_lshlrev_b32 v160, 16, v240
    v_and_b32 v161, 0xffff0000, v240
    v_mul_f32 v68, v68, v160
    v_mul_f32 v69, v69, v161
    v_cvt_pk_bf16_f32 v240, v68, v69
    v_add_f32 v70, v70, v142
    v_add_f32 v71, v71, v143
    v_lshlrev_b32 v162, 16, v241
    v_and_b32 v163, 0xffff0000, v241
    v_mul_f32 v70, v70, v162
    v_mul_f32 v71, v71, v163
    v_cvt_pk_bf16_f32 v241, v70, v71
    v_add_f32 v72, v72, v144
    v_add_f32 v73, v73, v145
    v_lshlrev_b32 v164, 16, v242
    v_and_b32 v165, 0xffff0000, v242
    v_mul_f32 v72, v72, v164
    v_mul_f32 v73, v73, v165
    v_cvt_pk_bf16_f32 v242, v72, v73
    v_add_f32 v74, v74, v146
    v_add_f32 v75, v75, v147
    v_lshlrev_b32 v166, 16, v243
    v_and_b32 v167, 0xffff0000, v243
    v_mul_f32 v74, v74, v166
    v_mul_f32 v75, v75, v167
    v_cvt_pk_bf16_f32 v243, v74, v75
    buffer_store_dwordx4 v[240:243], v8, s[8:11], s47 offen offset:2048 sc1
    s_waitcnt lgkmcnt(1)
    v_add_f32 v76, v76, v148
    v_add_f32 v77, v77, v149
    v_lshlrev_b32 v160, 16, v244
    v_and_b32 v161, 0xffff0000, v244
    v_mul_f32 v76, v76, v160
    v_mul_f32 v77, v77, v161
    v_cvt_pk_bf16_f32 v244, v76, v77
    v_add_f32 v78, v78, v150
    v_add_f32 v79, v79, v151
    v_lshlrev_b32 v162, 16, v245
    v_and_b32 v163, 0xffff0000, v245
    v_mul_f32 v78, v78, v162
    v_mul_f32 v79, v79, v163
    v_cvt_pk_bf16_f32 v245, v78, v79
    v_add_f32 v80, v80, v152
    v_add_f32 v81, v81, v153
    v_lshlrev_b32 v164, 16, v246
    v_and_b32 v165, 0xffff0000, v246
    v_mul_f32 v80, v80, v164
    v_mul_f32 v81, v81, v165
    v_cvt_pk_bf16_f32 v246, v80, v81
    v_add_f32 v82, v82, v154
    v_add_f32 v83, v83, v155
    v_lshlrev_b32 v166, 16, v247
    v_and_b32 v167, 0xffff0000, v247
    v_mul_f32 v82, v82, v166
    v_mul_f32 v83, v83, v167
    v_cvt_pk_bf16_f32 v247, v82, v83
    buffer_store_dwordx4 v[244:247], v8, s[8:11], s47 offen offset:3072 sc1
    s_waitcnt lgkmcnt(0)
    v_add_f32 v84, v84, v156
    v_add_f32 v85, v85, v157
    v_lshlrev_b32 v160, 16, v250
    v_and_b32 v161, 0xffff0000, v250
    v_mul_f32 v84, v84, v160
    v_mul_f32 v85, v85, v161
    v_cvt_pk_bf16_f32 v250, v84, v85
    v_add_f32 v86, v86, v158
    v_add_f32 v87, v87, v159
    v_lshlrev_b32 v162, 16, v251
    v_and_b32 v163, 0xffff0000, v251
    v_mul_f32 v86, v86, v162
    v_mul_f32 v87, v87, v163
    v_cvt_pk_bf16_f32 v251, v86, v87
    buffer_store_dwordx2 v[250:251], v9, s[8:11], s47 offen sc1
    v_mov_b32 v14, 1
    s_mov_b64 exec, 1
    ds_add_u32 v13, v14 offset:4
    s_mov_b64 exec, -1
    s_branch p2_kernel_end
p2_kernel_t:
    s_sub_u32 s27, s22, 4
    s_lshl_b32 s27, s27, 1
    s_lshl_b32 s26, s26, 3
    s_add_u32 s26, s26, s27
    s_mul_i32 s27, s26, 36864
    s_mul_i32 s29, s25, 18
    s_lshr_b32 s28, s29, 3
    s_lshl_b32 s28, s28, 9
    s_add_u32 s27, s27, s28
    s_add_u32 s27, s27, 24903680
    s_add_u32 s46, s27, 36864
    v_lshlrev_b32 v2, 4, v1
    v_and_b32 v6, 31, v1
    v_lshrrev_b32 v7, 5, v1
    buffer_load_dwordx4 v[128:131], v2, s[8:11], s27 offen
    buffer_load_dwordx4 v[132:135], v2, s[8:11], s27 offen offset:1024
    buffer_load_dwordx4 v[136:139], v2, s[8:11], s46 offen
    buffer_load_dwordx4 v[140:143], v2, s[8:11], s46 offen offset:1024
    v_add_u32 v3, 139264, v2
    v_and_b32 v10, 0x13, v6
    v_bfe_u32 v11, v6, 2, 1
    v_lshl_add_u32 v10, v11, 3, v10
    v_bfe_u32 v11, v6, 3, 1
    v_lshl_add_u32 v10, v11, 2, v10
    v_mul_u32_u24 v5, 18, v7
    v_add_lshl_u32 v5, v5, v10, 4
    v_add_u32 v5, 140800, v5
    v_mul_u32_u24 v9, 576, v7
    v_add_lshl_u32 v9, v9, v10, 4
    s_bfe_u32 s29, s29, 0x20001
    v_lshlrev_b32 v8, 2, v7
    v_subrev_u32 v8, s29, v8
    s_mov_b32 s53, 0
    s_mov_b32 s44, 0x3ffff
    s_mov_b32 s45, 0x3ffff
    v_mov_b32 v148, 0
    v_mov_b32 v149, 0
    v_mov_b32 v150, 0
    v_mov_b32 v151, 0
    v_mov_b32 v156, 0
    v_mov_b32 v157, 0
    v_mov_b32 v158, 0
    v_mov_b32 v159, 0
    v_and_b32 v10, 27, v6
    v_cmp_eq_u32 vcc, 24, v10
    v_mov_b32 v10, 0x3f803f80
    s_nop 0
    v_cndmask_b32 v10, 0, v10, vcc
    v_mov_b32 v160, v10
    v_mov_b32 v161, v10
    v_mov_b32 v162, v10
    v_mov_b32 v163, v10
    v_mov_b32 v164, v10
    v_mov_b32 v165, v10
    v_mov_b32 v166, v10
    v_mov_b32 v167, v10
    v_mov_b32 v168, v10
    v_mov_b32 v169, v10
    v_mov_b32 v170, v10
    v_mov_b32 v171, v10
    v_mov_b32 v172, v10
    v_mov_b32 v173, v10
    v_mov_b32 v174, v10
    v_mov_b32 v175, v10
    v_mov_b32 v64, 0
    v_mov_b32 v65, 0
    v_mov_b32 v66, 0
    v_mov_b32 v67, 0
    v_mov_b32 v68, 0
    v_mov_b32 v69, 0
    v_mov_b32 v70, 0
    v_mov_b32 v71, 0
    v_mov_b32 v72, 0
    v_mov_b32 v73, 0
    v_mov_b32 v74, 0
    v_mov_b32 v75, 0
    v_mov_b32 v76, 0
    v_mov_b32 v77, 0
    v_mov_b32 v78, 0
    v_mov_b32 v79, 0
    v_mov_b32 v80, 0
    v_mov_b32 v81, 0
    v_mov_b32 v82, 0
    v_mov_b32 v83, 0
    v_mov_b32 v84, 0
    v_mov_b32 v85, 0
    v_mov_b32 v86, 0
    v_mov_b32 v87, 0
    v_mov_b32 v88, 0
    v_mov_b32 v89, 0
    v_mov_b32 v90, 0
    v_mov_b32 v91, 0
    v_mov_b32 v92, 0
    v_mov_b32 v93, 0
    v_mov_b32 v94, 0
    v_mov_b32 v95, 0
    v_mov_b32 v56, 0
    v_mov_b32 v57, 0
    v_mov_b32 v58, 0
    v_mov_b32 v59, 0
    v_mov_b32 v60, 0
    v_mov_b32 v61, 0
    v_mov_b32 v62, 0
    v_mov_b32 v63, 0
    s_waitcnt vmcnt(0) lgkmcnt(0)
    v_add_u32 v10, 0, v8
    v_cmp_gt_u32 vcc, 9, v10
    s_nop 1
    v_cndmask_b32 v128, 0, v128, vcc
    v_cndmask_b32 v136, 0, v136, vcc
    v_add_u32 v10, 1, v8
    v_cmp_gt_u32 vcc, 9, v10
    s_nop 1
    v_cndmask_b32 v129, 0, v129, vcc
    v_cndmask_b32 v137, 0, v137, vcc
    v_add_u32 v10, 2, v8
    v_cmp_gt_u32 vcc, 9, v10
    s_nop 1
    v_cndmask_b32 v130, 0, v130, vcc
    v_cndmask_b32 v138, 0, v138, vcc
    v_add_u32 v10, 3, v8
    v_cmp_gt_u32 vcc, 9, v10
    s_nop 1
    v_cndmask_b32 v131, 0, v131, vcc
    v_cndmask_b32 v139, 0, v139, vcc
    v_add_u32 v10, 8, v8
    v_cmp_gt_u32 vcc, 9, v10
    s_nop 1
    v_cndmask_b32 v132, 0, v132, vcc
    v_cndmask_b32 v140, 0, v140, vcc
    v_add_u32 v10, 9, v8
    v_cmp_gt_u32 vcc, 9, v10
    s_nop 1
    v_cndmask_b32 v133, 0, v133, vcc
    v_cndmask_b32 v141, 0, v141, vcc
    v_add_u32 v10, 10, v8
    v_cmp_gt_u32 vcc, 9, v10
    s_nop 1
    v_cndmask_b32 v134, 0, v134, vcc
    v_cndmask_b32 v142, 0, v142, vcc
    v_add_u32 v10, 11, v8
    v_cmp_gt_u32 vcc, 9, v10
    s_nop 1
    v_cndmask_b32 v135, 0, v135, vcc
    v_cndmask_b32 v143, 0, v143, vcc
    s_barrier
    ds_read_b128 v[144:147], v3 offset:0
    s_mov_b64 exec, 0xffffffff
    ds_read_b128 v[148:151], v3 offset:1024
    s_mov_b64 exec, -1
    s_waitcnt lgkmcnt(0)
    v_mfma_f32_32x32x16_bf16 v[16:31], v[144:147], v[128:131], 0
    v_mfma_f32_32x32x16_bf16 v[16:31], v[148:151], v[132:135], v[16:31]
    v_mfma_f32_32x32x16_bf16 v[32:47], v[144:147], v[136:139], 0
    v_mfma_f32_32x32x16_bf16 v[32:47], v[148:151], v[140:143], v[32:47]
    s_nop 9
    v_max3_f32 v10, v16, v17, v18
    v_max_f32 v10, v10, v19
    v_max3_f32 v10, v10, v20, v21
    v_max3_f32 v10, v10, v22, v23
    v_max3_f32 v10, v10, v24, v25
    v_max3_f32 v10, v10, v26, v27
    v_max3_f32 v10, v10, v28, v29
    v_max3_f32 v10, v10, v30, v31
    v_max3_f32 v11, v32, v33, v34
    v_max_f32 v11, v11, v35
    v_max3_f32 v11, v11, v36, v37
    v_max3_f32 v11, v11, v38, v39
    v_max3_f32 v11, v11, v40, v41
    v_max3_f32 v11, v11, v42, v43
    v_max3_f32 v11, v11, v44, v45
    v_max3_f32 v11, v11, v46, v47
    v_mov_b32 v12, v10
    s_nop 1
    v_permlane32_swap_b32 v12, v10
    v_max_f32 v10, v10, v12
    v_sub_f32 v10, 0, v10
    v_mov_b32 v96, v10
    v_mov_b32 v97, v10
    v_mov_b32 v98, v10
    v_mov_b32 v99, v10
    v_mov_b32 v100, v10
    v_mov_b32 v101, v10
    v_mov_b32 v102, v10
    v_mov_b32 v103, v10
    v_mov_b32 v104, v10
    v_mov_b32 v105, v10
    v_mov_b32 v106, v10
    v_mov_b32 v107, v10
    v_mov_b32 v108, v10
    v_mov_b32 v109, v10
    v_mov_b32 v110, v10
    v_mov_b32 v111, v10
    v_mov_b32 v12, v11
    s_nop 1
    v_permlane32_swap_b32 v12, v11
    v_max_f32 v11, v11, v12
    v_sub_f32 v11, 0, v11
    v_mov_b32 v112, v11
    v_mov_b32 v113, v11
    v_mov_b32 v114, v11
    v_mov_b32 v115, v11
    v_mov_b32 v116, v11
    v_mov_b32 v117, v11
    v_mov_b32 v118, v11
    v_mov_b32 v119, v11
    v_mov_b32 v120, v11
    v_mov_b32 v121, v11
    v_mov_b32 v122, v11
    v_mov_b32 v123, v11
    v_mov_b32 v124, v11
    v_mov_b32 v125, v11
    v_mov_b32 v126, v11
    v_mov_b32 v127, v11
    v_mfma_f32_32x32x16_bf16 v[16:31], v[144:147], v[128:131], v[96:111]
    v_mfma_f32_32x32x16_bf16 v[16:31], v[148:151], v[132:135], v[16:31]
    s_nop 7
    s_nop 3
    s_setprio 2
    s_mov_b32 s30, 8
t_loop_123:
    s_barrier
    ds_read_b128 v[152:155], v3 offset:2688
    s_mov_b64 exec, 0xffffffff
    ds_read_b128 v[156:159], v3 offset:3712
    s_mov_b64 exec, s[44:45]
    ds_read_b128 v[160:163], v5 offset:0
    ds_read_b128 v[164:167], v5 offset:576
    s_mov_b64 exec, -1
    v_mfma_f32_32x32x16_bf16 v[32:47], v[144:147], v[136:139], v[112:127]
    v_exp_f32 v16, v16
    v_exp_f32 v17, v17
    v_exp_f32 v18, v18
    v_exp_f32 v19, v19
    v_cvt_pk_bf16_f32 v48, v16, v17
    v_cvt_pk_bf16_f32 v49, v18, v19
    v_mfma_f32_32x32x16_bf16 v[32:47], v[148:151], v[140:143], v[32:47]
    v_exp_f32 v20, v20
    v_exp_f32 v21, v21
    v_exp_f32 v22, v22
    v_exp_f32 v23, v23
    v_cvt_pk_bf16_f32 v50, v20, v21
    v_cvt_pk_bf16_f32 v51, v22, v23
    v_mfma_f32_32x32x16_bf16 v[80:95], v[168:171], v[56:59], v[80:95]
    v_exp_f32 v24, v24
    v_exp_f32 v25, v25
    v_exp_f32 v26, v26
    v_exp_f32 v27, v27
    v_cvt_pk_bf16_f32 v52, v24, v25
    v_cvt_pk_bf16_f32 v53, v26, v27
    v_mfma_f32_32x32x16_bf16 v[80:95], v[172:175], v[60:63], v[80:95]
    v_exp_f32 v28, v28
    v_exp_f32 v29, v29
    v_exp_f32 v30, v30
    v_exp_f32 v31, v31
    v_cvt_pk_bf16_f32 v54, v28, v29
    v_cvt_pk_bf16_f32 v55, v30, v31
    s_waitcnt lgkmcnt(0)
    v_mfma_f32_32x32x16_bf16 v[16:31], v[152:155], v[128:131], v[96:111]
    v_exp_f32 v32, v32
    v_exp_f32 v33, v33
    v_exp_f32 v34, v34
    v_exp_f32 v35, v35
    v_cvt_pk_bf16_f32 v56, v32, v33
    v_cvt_pk_bf16_f32 v57, v34, v35
    v_mfma_f32_32x32x16_bf16 v[16:31], v[156:159], v[132:135], v[16:31]
    v_exp_f32 v36, v36
    v_exp_f32 v37, v37
    v_exp_f32 v38, v38
    v_exp_f32 v39, v39
    v_cvt_pk_bf16_f32 v58, v36, v37
    v_cvt_pk_bf16_f32 v59, v38, v39
    v_mfma_f32_32x32x16_bf16 v[64:79], v[160:163], v[48:51], v[64:79]
    v_exp_f32 v40, v40
    v_exp_f32 v41, v41
    v_exp_f32 v42, v42
    v_exp_f32 v43, v43
    v_cvt_pk_bf16_f32 v60, v40, v41
    v_cvt_pk_bf16_f32 v61, v42, v43
    v_mfma_f32_32x32x16_bf16 v[64:79], v[164:167], v[52:55], v[64:79]
    v_exp_f32 v44, v44
    v_exp_f32 v45, v45
    v_exp_f32 v46, v46
    v_exp_f32 v47, v47
    v_cvt_pk_bf16_f32 v62, v44, v45
    v_cvt_pk_bf16_f32 v63, v46, v47
    ds_read_b128 v[144:147], v3 offset:6144
    s_mov_b64 exec, 0xffffffff
    ds_read_b128 v[148:151], v3 offset:7168
    s_mov_b64 exec, s[44:45]
    ds_read_b128 v[168:171], v5 offset:2688
    ds_read_b128 v[172:175], v5 offset:3264
    s_mov_b64 exec, -1
    v_mfma_f32_32x32x16_bf16 v[32:47], v[152:155], v[136:139], v[112:127]
    v_exp_f32 v16, v16
    v_exp_f32 v17, v17
    v_exp_f32 v18, v18
    v_exp_f32 v19, v19
    v_cvt_pk_bf16_f32 v48, v16, v17
    v_cvt_pk_bf16_f32 v49, v18, v19
    v_mfma_f32_32x32x16_bf16 v[32:47], v[156:159], v[140:143], v[32:47]
    v_exp_f32 v20, v20
    v_exp_f32 v21, v21
    v_exp_f32 v22, v22
    v_exp_f32 v23, v23
    v_cvt_pk_bf16_f32 v50, v20, v21
    v_cvt_pk_bf16_f32 v51, v22, v23
    v_mfma_f32_32x32x16_bf16 v[80:95], v[160:163], v[56:59], v[80:95]
    v_exp_f32 v24, v24
    v_exp_f32 v25, v25
    v_exp_f32 v26, v26
    v_exp_f32 v27, v27
    v_cvt_pk_bf16_f32 v52, v24, v25
    v_cvt_pk_bf16_f32 v53, v26, v27
    v_mfma_f32_32x32x16_bf16 v[80:95], v[164:167], v[60:63], v[80:95]
    v_exp_f32 v28, v28
    v_exp_f32 v29, v29
    v_exp_f32 v30, v30
    v_exp_f32 v31, v31
    v_cvt_pk_bf16_f32 v54, v28, v29
    v_cvt_pk_bf16_f32 v55, v30, v31
    s_waitcnt lgkmcnt(0)
    s_barrier
    v_mfma_f32_32x32x16_bf16 v[16:31], v[144:147], v[128:131], v[96:111]
    v_exp_f32 v32, v32
    v_exp_f32 v33, v33
    v_exp_f32 v34, v34
    v_exp_f32 v35, v35
    v_cvt_pk_bf16_f32 v56, v32, v33
    v_cvt_pk_bf16_f32 v57, v34, v35
    v_mfma_f32_32x32x16_bf16 v[16:31], v[148:151], v[132:135], v[16:31]
    v_exp_f32 v36, v36
    v_exp_f32 v37, v37
    v_exp_f32 v38, v38
    v_exp_f32 v39, v39
    v_cvt_pk_bf16_f32 v58, v36, v37
    v_cvt_pk_bf16_f32 v59, v38, v39
    v_mfma_f32_32x32x16_bf16 v[64:79], v[168:171], v[48:51], v[64:79]
    v_exp_f32 v40, v40
    v_exp_f32 v41, v41
    v_exp_f32 v42, v42
    v_exp_f32 v43, v43
    v_cvt_pk_bf16_f32 v60, v40, v41
    v_cvt_pk_bf16_f32 v61, v42, v43
    v_mfma_f32_32x32x16_bf16 v[64:79], v[172:175], v[52:55], v[64:79]
    v_exp_f32 v44, v44
    v_exp_f32 v45, v45
    v_exp_f32 v46, v46
    v_exp_f32 v47, v47
    v_cvt_pk_bf16_f32 v62, v44, v45
    v_cvt_pk_bf16_f32 v63, v46, v47
    ds_read_b128 v[152:155], v3 offset:12288
    s_mov_b64 exec, 0xffffffff
    ds_read_b128 v[156:159], v3 offset:13312
    s_mov_b64 exec, s[44:45]
    ds_read_b128 v[160:163], v5 offset:6144
    ds_read_b128 v[164:167], v5 offset:6720
    s_mov_b64 exec, -1
    v_mfma_f32_32x32x16_bf16 v[32:47], v[144:147], v[136:139], v[112:127]
    v_exp_f32 v16, v16
    v_exp_f32 v17, v17
    v_exp_f32 v18, v18
    v_exp_f32 v19, v19
    v_cvt_pk_bf16_f32 v48, v16, v17
    v_cvt_pk_bf16_f32 v49, v18, v19
    v_mfma_f32_32x32x16_bf16 v[32:47], v[148:151], v[140:143], v[32:47]
    v_exp_f32 v20, v20
    v_exp_f32 v21, v21
    v_exp_f32 v22, v22
    v_exp_f32 v23, v23
    v_cvt_pk_bf16_f32 v50, v20, v21
    v_cvt_pk_bf16_f32 v51, v22, v23
    v_mfma_f32_32x32x16_bf16 v[80:95], v[168:171], v[56:59], v[80:95]
    v_exp_f32 v24, v24
    v_exp_f32 v25, v25
    v_exp_f32 v26, v26
    v_exp_f32 v27, v27
    v_cvt_pk_bf16_f32 v52, v24, v25
    v_cvt_pk_bf16_f32 v53, v26, v27
    v_mfma_f32_32x32x16_bf16 v[80:95], v[172:175], v[60:63], v[80:95]
    v_exp_f32 v28, v28
    v_exp_f32 v29, v29
    v_exp_f32 v30, v30
    v_exp_f32 v31, v31
    v_cvt_pk_bf16_f32 v54, v28, v29
    v_cvt_pk_bf16_f32 v55, v30, v31
    s_waitcnt lgkmcnt(0)
    v_mfma_f32_32x32x16_bf16 v[16:31], v[152:155], v[128:131], v[96:111]
    v_exp_f32 v32, v32
    v_exp_f32 v33, v33
    v_exp_f32 v34, v34
    v_exp_f32 v35, v35
    v_cvt_pk_bf16_f32 v56, v32, v33
    v_cvt_pk_bf16_f32 v57, v34, v35
    v_mfma_f32_32x32x16_bf16 v[16:31], v[156:159], v[132:135], v[16:31]
    v_exp_f32 v36, v36
    v_exp_f32 v37, v37
    v_exp_f32 v38, v38
    v_exp_f32 v39, v39
    v_cvt_pk_bf16_f32 v58, v36, v37
    v_cvt_pk_bf16_f32 v59, v38, v39
    v_mfma_f32_32x32x16_bf16 v[64:79], v[160:163], v[48:51], v[64:79]
    v_exp_f32 v40, v40
    v_exp_f32 v41, v41
    v_exp_f32 v42, v42
    v_exp_f32 v43, v43
    v_cvt_pk_bf16_f32 v60, v40, v41
    v_cvt_pk_bf16_f32 v61, v42, v43
    v_mfma_f32_32x32x16_bf16 v[64:79], v[164:167], v[52:55], v[64:79]
    v_exp_f32 v44, v44
    v_exp_f32 v45, v45
    v_exp_f32 v46, v46
    v_exp_f32 v47, v47
    v_cvt_pk_bf16_f32 v62, v44, v45
    v_cvt_pk_bf16_f32 v63, v46, v47
    s_barrier
    ds_read_b128 v[144:147], v3 offset:14976
    s_mov_b64 exec, 0xffffffff
    ds_read_b128 v[148:151], v3 offset:16000
    s_mov_b64 exec, s[44:45]
    ds_read_b128 v[168:171], v5 offset:12288
    ds_read_b128 v[172:175], v5 offset:12864
    s_mov_b64 exec, -1
    v_mfma_f32_32x32x16_bf16 v[32:47], v[152:155], v[136:139], v[112:127]
    v_exp_f32 v16, v16
    v_exp_f32 v17, v17
    v_exp_f32 v18, v18
    v_exp_f32 v19, v19
    v_cvt_pk_bf16_f32 v48, v16, v17
    v_cvt_pk_bf16_f32 v49, v18, v19
    v_mfma_f32_32x32x16_bf16 v[32:47], v[156:159], v[140:143], v[32:47]
    v_exp_f32 v20, v20
    v_exp_f32 v21, v21
    v_exp_f32 v22, v22
    v_exp_f32 v23, v23
    v_cvt_pk_bf16_f32 v50, v20, v21
    v_cvt_pk_bf16_f32 v51, v22, v23
    v_mfma_f32_32x32x16_bf16 v[80:95], v[160:163], v[56:59], v[80:95]
    v_exp_f32 v24, v24
    v_exp_f32 v25, v25
    v_exp_f32 v26, v26
    v_exp_f32 v27, v27
    v_cvt_pk_bf16_f32 v52, v24, v25
    v_cvt_pk_bf16_f32 v53, v26, v27
    v_mfma_f32_32x32x16_bf16 v[80:95], v[164:167], v[60:63], v[80:95]
    v_exp_f32 v28, v28
    v_exp_f32 v29, v29
    v_exp_f32 v30, v30
    v_exp_f32 v31, v31
    v_cvt_pk_bf16_f32 v54, v28, v29
    v_cvt_pk_bf16_f32 v55, v30, v31
    s_waitcnt lgkmcnt(0)
    v_mfma_f32_32x32x16_bf16 v[16:31], v[144:147], v[128:131], v[96:111]
    v_exp_f32 v32, v32
    v_exp_f32 v33, v33
    v_exp_f32 v34, v34
    v_exp_f32 v35, v35
    v_cvt_pk_bf16_f32 v56, v32, v33
    v_cvt_pk_bf16_f32 v57, v34, v35
    v_mfma_f32_32x32x16_bf16 v[16:31], v[148:151], v[132:135], v[16:31]
    v_exp_f32 v36, v36
    v_exp_f32 v37, v37
    v_exp_f32 v38, v38
    v_exp_f32 v39, v39
    v_cvt_pk_bf16_f32 v58, v36, v37
    v_cvt_pk_bf16_f32 v59, v38, v39
    v_mfma_f32_32x32x16_bf16 v[64:79], v[168:171], v[48:51], v[64:79]
    v_exp_f32 v40, v40
    v_exp_f32 v41, v41
    v_exp_f32 v42, v42
    v_exp_f32 v43, v43
    v_cvt_pk_bf16_f32 v60, v40, v41
    v_cvt_pk_bf16_f32 v61, v42, v43
    v_mfma_f32_32x32x16_bf16 v[64:79], v[172:175], v[52:55], v[64:79]
    v_exp_f32 v44, v44
    v_exp_f32 v45, v45
    v_exp_f32 v46, v46
    v_exp_f32 v47, v47
    v_cvt_pk_bf16_f32 v62, v44, v45
    v_cvt_pk_bf16_f32 v63, v46, v47
    ds_read_b128 v[152:155], v3 offset:18432
    s_mov_b64 exec, 0xffffffff
    ds_read_b128 v[156:159], v3 offset:19456
    s_mov_b64 exec, s[44:45]
    ds_read_b128 v[160:163], v5 offset:14976
    ds_read_b128 v[164:167], v5 offset:15552
    s_mov_b64 exec, -1
    v_mfma_f32_32x32x16_bf16 v[32:47], v[144:147], v[136:139], v[112:127]
    v_exp_f32 v16, v16
    v_exp_f32 v17, v17
    v_exp_f32 v18, v18
    v_exp_f32 v19, v19
    v_cvt_pk_bf16_f32 v48, v16, v17
    v_cvt_pk_bf16_f32 v49, v18, v19
    v_mfma_f32_32x32x16_bf16 v[32:47], v[148:151], v[140:143], v[32:47]
    v_exp_f32 v20, v20
    v_exp_f32 v21, v21
    v_exp_f32 v22, v22
    v_exp_f32 v23, v23
    v_cvt_pk_bf16_f32 v50, v20, v21
    v_cvt_pk_bf16_f32 v51, v22, v23
    v_mfma_f32_32x32x16_bf16 v[80:95], v[168:171], v[56:59], v[80:95]
    v_exp_f32 v24, v24
    v_exp_f32 v25, v25
    v_exp_f32 v26, v26
    v_exp_f32 v27, v27
    v_cvt_pk_bf16_f32 v52, v24, v25
    v_cvt_pk_bf16_f32 v53, v26, v27
    v_mfma_f32_32x32x16_bf16 v[80:95], v[172:175], v[60:63], v[80:95]
    v_exp_f32 v28, v28
    v_exp_f32 v29, v29
    v_exp_f32 v30, v30
    v_exp_f32 v31, v31
    v_cvt_pk_bf16_f32 v54, v28, v29
    v_cvt_pk_bf16_f32 v55, v30, v31
    s_waitcnt lgkmcnt(0)
    s_barrier
    v_mfma_f32_32x32x16_bf16 v[16:31], v[152:155], v[128:131], v[96:111]
    v_exp_f32 v32, v32
    v_exp_f32 v33, v33
    v_exp_f32 v34, v34
    v_exp_f32 v35, v35
    v_cvt_pk_bf16_f32 v56, v32, v33
    v_cvt_pk_bf16_f32 v57, v34, v35
    v_mfma_f32_32x32x16_bf16 v[16:31], v[156:159], v[132:135], v[16:31]
    v_exp_f32 v36, v36
    v_exp_f32 v37, v37
    v_exp_f32 v38, v38
    v_exp_f32 v39, v39
    v_cvt_pk_bf16_f32 v58, v36, v37
    v_cvt_pk_bf16_f32 v59, v38, v39
    v_mfma_f32_32x32x16_bf16 v[64:79], v[160:163], v[48:51], v[64:79]
    v_exp_f32 v40, v40
    v_exp_f32 v41, v41
    v_exp_f32 v42, v42
    v_exp_f32 v43, v43
    v_cvt_pk_bf16_f32 v60, v40, v41
    v_cvt_pk_bf16_f32 v61, v42, v43
    v_mfma_f32_32x32x16_bf16 v[64:79], v[164:167], v[52:55], v[64:79]
    v_exp_f32 v44, v44
    v_exp_f32 v45, v45
    v_exp_f32 v46, v46
    v_exp_f32 v47, v47
    v_cvt_pk_bf16_f32 v62, v44, v45
    v_cvt_pk_bf16_f32 v63, v46, v47
    ds_read_b128 v[144:147], v3 offset:0
    s_mov_b64 exec, 0xffffffff
    ds_read_b128 v[148:151], v3 offset:1024
    s_mov_b64 exec, s[44:45]
    ds_read_b128 v[168:171], v5 offset:18432
    ds_read_b128 v[172:175], v5 offset:19008
    s_mov_b64 exec, -1
    v_mfma_f32_32x32x16_bf16 v[32:47], v[152:155], v[136:139], v[112:127]
    v_exp_f32 v16, v16
    v_exp_f32 v17, v17
    v_exp_f32 v18, v18
    v_exp_f32 v19, v19
    v_cvt_pk_bf16_f32 v48, v16, v17
    v_cvt_pk_bf16_f32 v49, v18, v19
    v_mfma_f32_32x32x16_bf16 v[32:47], v[156:159], v[140:143], v[32:47]
    v_exp_f32 v20, v20
    v_exp_f32 v21, v21
    v_exp_f32 v22, v22
    v_exp_f32 v23, v23
    v_cvt_pk_bf16_f32 v50, v20, v21
    v_cvt_pk_bf16_f32 v51, v22, v23
    v_mfma_f32_32x32x16_bf16 v[80:95], v[160:163], v[56:59], v[80:95]
    v_exp_f32 v24, v24
    v_exp_f32 v25, v25
    v_exp_f32 v26, v26
    v_exp_f32 v27, v27
    v_cvt_pk_bf16_f32 v52, v24, v25
    v_cvt_pk_bf16_f32 v53, v26, v27
    v_mfma_f32_32x32x16_bf16 v[80:95], v[164:167], v[60:63], v[80:95]
    v_exp_f32 v28, v28
    v_exp_f32 v29, v29
    v_exp_f32 v30, v30
    v_exp_f32 v31, v31
    v_cvt_pk_bf16_f32 v54, v28, v29
    v_cvt_pk_bf16_f32 v55, v30, v31
    s_waitcnt lgkmcnt(0)
    v_mfma_f32_32x32x16_bf16 v[16:31], v[144:147], v[128:131], v[96:111]
    v_exp_f32 v32, v32
    v_exp_f32 v33, v33
    v_exp_f32 v34, v34
    v_exp_f32 v35, v35
    v_cvt_pk_bf16_f32 v56, v32, v33
    v_cvt_pk_bf16_f32 v57, v34, v35
    v_mfma_f32_32x32x16_bf16 v[16:31], v[148:151], v[132:135], v[16:31]
    v_exp_f32 v36, v36
    v_exp_f32 v37, v37
    v_exp_f32 v38, v38
    v_exp_f32 v39, v39
    v_cvt_pk_bf16_f32 v58, v36, v37
    v_cvt_pk_bf16_f32 v59, v38, v39
    v_mfma_f32_32x32x16_bf16 v[64:79], v[168:171], v[48:51], v[64:79]
    v_exp_f32 v40, v40
    v_exp_f32 v41, v41
    v_exp_f32 v42, v42
    v_exp_f32 v43, v43
    v_cvt_pk_bf16_f32 v60, v40, v41
    v_cvt_pk_bf16_f32 v61, v42, v43
    v_mfma_f32_32x32x16_bf16 v[64:79], v[172:175], v[52:55], v[64:79]
    v_exp_f32 v44, v44
    v_exp_f32 v45, v45
    v_exp_f32 v46, v46
    v_exp_f32 v47, v47
    v_cvt_pk_bf16_f32 v62, v44, v45
    v_cvt_pk_bf16_f32 v63, v46, v47
    s_sub_u32 s30, s30, 1
    s_cmp_lg_u32 s30, 0
    s_cbranch_scc1 t_loop_123
    s_and_b32 s27, s2, 1
    s_lshl_b32 s27, s27, 2
    s_bfe_u32 s28, s2, 131075
    s_add_u32 s27, s27, s28
    s_mul_i32 s27, s27, 90
    s_mul_i32 s28, s22, 5
    s_add_u32 s28, s28, 52
    s_min_u32 s28, s28, 86
    s_add_u32 s27, s27, s28
    s_mul_i32 s27, s27, 4608
    s_add_u32 s27, s27, 32505856
    v_and_b32 v244, 15, v1
    v_lshrrev_b32 v245, 4, v1
    v_lshlrev_b32 v246, 4, v244
    v_lshl_add_u32 v246, v245, 7, v246
    v_add_u32 v246, 4096, v246
    v_mov_b32 v247, 0x7f000000
    v_cmp_gt_u32 vcc, 8, v244
    s_nop 1
    v_cndmask_b32 v179, v247, v246, vcc
    buffer_load_dwordx4 v[184:187], v2, s[8:11], s27 offen offset:0
    buffer_load_dwordx4 v[188:191], v2, s[8:11], s27 offen offset:1024
    buffer_load_dwordx4 v[192:195], v2, s[8:11], s27 offen offset:2048
    buffer_load_dwordx4 v[196:199], v2, s[8:11], s27 offen offset:3072
    buffer_load_dwordx4 v[200:203], v179, s[8:11], s27 offen
    s_add_u32 s27, s27, 4608
    buffer_load_dwordx4 v[204:207], v2, s[8:11], s27 offen offset:0
    buffer_load_dwordx4 v[208:211], v2, s[8:11], s27 offen offset:1024
    buffer_load_dwordx4 v[212:215], v2, s[8:11], s27 offen offset:2048
    buffer_load_dwordx4 v[216:219], v2, s[8:11], s27 offen offset:3072
    buffer_load_dwordx4 v[220:223], v179, s[8:11], s27 offen
    s_add_u32 s27, s27, 4608
    buffer_load_dwordx4 v[224:227], v2, s[8:11], s27 offen offset:0
    buffer_load_dwordx4 v[228:231], v2, s[8:11], s27 offen offset:1024
    buffer_load_dwordx4 v[232:235], v2, s[8:11], s27 offen offset:2048
    buffer_load_dwordx4 v[236:239], v2, s[8:11], s27 offen offset:3072
    buffer_load_dwordx4 v[240:243], v179, s[8:11], s27 offen
    s_add_u32 s27, s27, 4608
    s_barrier
    s_setprio 1
    s_mov_b32 s30, 8
    v_add_u32 v176, 6144, v3
t_post_124:
    ds_read_b128 v[152:155], v3 offset:2688
    s_mov_b64 exec, 0xffffffff
    ds_read_b128 v[156:159], v3 offset:3712
    s_mov_b64 exec, s[44:45]
    ds_read_b128 v[160:163], v5 offset:0
    ds_read_b128 v[164:167], v5 offset:576
    s_mov_b64 exec, -1
    v_mfma_f32_32x32x16_bf16 v[32:47], v[144:147], v[136:139], v[112:127]
    v_exp_f32 v16, v16
    v_exp_f32 v17, v17
    v_exp_f32 v18, v18
    v_exp_f32 v19, v19
    v_cvt_pk_bf16_f32 v48, v16, v17
    v_cvt_pk_bf16_f32 v49, v18, v19
    v_mfma_f32_32x32x16_bf16 v[32:47], v[148:151], v[140:143], v[32:47]
    v_exp_f32 v20, v20
    v_exp_f32 v21, v21
    v_exp_f32 v22, v22
    v_exp_f32 v23, v23
    v_cvt_pk_bf16_f32 v50, v20, v21
    v_cvt_pk_bf16_f32 v51, v22, v23
    v_mfma_f32_32x32x16_bf16 v[80:95], v[168:171], v[56:59], v[80:95]
    v_exp_f32 v24, v24
    v_exp_f32 v25, v25
    v_exp_f32 v26, v26
    v_exp_f32 v27, v27
    v_cvt_pk_bf16_f32 v52, v24, v25
    v_cvt_pk_bf16_f32 v53, v26, v27
    v_mfma_f32_32x32x16_bf16 v[80:95], v[172:175], v[60:63], v[80:95]
    v_exp_f32 v28, v28
    v_exp_f32 v29, v29
    v_exp_f32 v30, v30
    v_exp_f32 v31, v31
    v_cvt_pk_bf16_f32 v54, v28, v29
    v_cvt_pk_bf16_f32 v55, v30, v31
    s_waitcnt lgkmcnt(0)
    v_mfma_f32_32x32x16_bf16 v[16:31], v[152:155], v[128:131], v[96:111]
    v_exp_f32 v32, v32
    v_exp_f32 v33, v33
    v_exp_f32 v34, v34
    v_exp_f32 v35, v35
    v_cvt_pk_bf16_f32 v56, v32, v33
    v_cvt_pk_bf16_f32 v57, v34, v35
    v_mfma_f32_32x32x16_bf16 v[16:31], v[156:159], v[132:135], v[16:31]
    v_exp_f32 v36, v36
    v_exp_f32 v37, v37
    v_exp_f32 v38, v38
    v_exp_f32 v39, v39
    v_cvt_pk_bf16_f32 v58, v36, v37
    v_cvt_pk_bf16_f32 v59, v38, v39
    v_mfma_f32_32x32x16_bf16 v[64:79], v[160:163], v[48:51], v[64:79]
    v_exp_f32 v40, v40
    v_exp_f32 v41, v41
    v_exp_f32 v42, v42
    v_exp_f32 v43, v43
    v_cvt_pk_bf16_f32 v60, v40, v41
    v_cvt_pk_bf16_f32 v61, v42, v43
    v_mfma_f32_32x32x16_bf16 v[64:79], v[164:167], v[52:55], v[64:79]
    v_exp_f32 v44, v44
    v_exp_f32 v45, v45
    v_exp_f32 v46, v46
    v_exp_f32 v47, v47
    v_cvt_pk_bf16_f32 v62, v44, v45
    v_cvt_pk_bf16_f32 v63, v46, v47
    ds_read_b128 v[144:147], v176 offset:0
    s_mov_b64 exec, 0xffffffff
    ds_read_b128 v[148:151], v176 offset:1024
    s_mov_b64 exec, s[44:45]
    ds_read_b128 v[168:171], v5 offset:2688
    ds_read_b128 v[172:175], v5 offset:3264
    s_mov_b64 exec, -1
    v_mfma_f32_32x32x16_bf16 v[32:47], v[152:155], v[136:139], v[112:127]
    v_exp_f32 v16, v16
    v_exp_f32 v17, v17
    v_exp_f32 v18, v18
    v_exp_f32 v19, v19
    v_cvt_pk_bf16_f32 v48, v16, v17
    v_cvt_pk_bf16_f32 v49, v18, v19
    v_mfma_f32_32x32x16_bf16 v[32:47], v[156:159], v[140:143], v[32:47]
    v_exp_f32 v20, v20
    v_exp_f32 v21, v21
    v_exp_f32 v22, v22
    v_exp_f32 v23, v23
    v_cvt_pk_bf16_f32 v50, v20, v21
    v_cvt_pk_bf16_f32 v51, v22, v23
    v_mfma_f32_32x32x16_bf16 v[80:95], v[160:163], v[56:59], v[80:95]
    v_exp_f32 v24, v24
    v_exp_f32 v25, v25
    v_exp_f32 v26, v26
    v_exp_f32 v27, v27
    v_cvt_pk_bf16_f32 v52, v24, v25
    v_cvt_pk_bf16_f32 v53, v26, v27
    v_mfma_f32_32x32x16_bf16 v[80:95], v[164:167], v[60:63], v[80:95]
    v_exp_f32 v28, v28
    v_exp_f32 v29, v29
    v_exp_f32 v30, v30
    v_exp_f32 v31, v31
    v_cvt_pk_bf16_f32 v54, v28, v29
    v_cvt_pk_bf16_f32 v55, v30, v31
    s_waitcnt lgkmcnt(0)
    s_cmp_eq_u32 s30, 6
    s_movk_i32 s27, 6144
    s_cselect_b32 s27, 0xfffdb000, s27
    s_cmp_eq_u32 s30, 7
    s_movk_i32 s28, 6144
    s_cselect_b32 s28, 0xfffdb000, s28
    v_add_u32 v3, s27, v3
    v_add_u32 v5, s27, v5
    v_add_u32 v176, s28, v176
    v_mfma_f32_32x32x16_bf16 v[16:31], v[144:147], v[128:131], v[96:111]
    v_exp_f32 v32, v32
    v_exp_f32 v33, v33
    v_exp_f32 v34, v34
    v_exp_f32 v35, v35
    v_cvt_pk_bf16_f32 v56, v32, v33
    v_cvt_pk_bf16_f32 v57, v34, v35
    v_mfma_f32_32x32x16_bf16 v[16:31], v[148:151], v[132:135], v[16:31]
    v_exp_f32 v36, v36
    v_exp_f32 v37, v37
    v_exp_f32 v38, v38
    v_exp_f32 v39, v39
    v_cvt_pk_bf16_f32 v58, v36, v37
    v_cvt_pk_bf16_f32 v59, v38, v39
    v_mfma_f32_32x32x16_bf16 v[64:79], v[168:171], v[48:51], v[64:79]
    v_exp_f32 v40, v40
    v_exp_f32 v41, v41
    v_exp_f32 v42, v42
    v_exp_f32 v43, v43
    v_cvt_pk_bf16_f32 v60, v40, v41
    v_cvt_pk_bf16_f32 v61, v42, v43
    v_mfma_f32_32x32x16_bf16 v[64:79], v[172:175], v[52:55], v[64:79]
    v_exp_f32 v44, v44
    v_exp_f32 v45, v45
    v_exp_f32 v46, v46
    v_exp_f32 v47, v47
    v_cvt_pk_bf16_f32 v62, v44, v45
    v_cvt_pk_bf16_f32 v63, v46, v47
    s_sub_u32 s30, s30, 1
    s_cmp_lg_u32 s30, 0
    s_cbranch_scc1 t_post_124
    v_mov_b32 v177, 163328
    v_mov_b32 v178, 1
    s_mov_b64 exec, 1
    ds_add_u32 v177, v178
    s_mov_b64 exec, -1
    v_mfma_f32_32x32x16_bf16 v[80:95], v[168:171], v[56:59], v[80:95]
    v_mfma_f32_32x32x16_bf16 v[80:95], v[172:175], v[60:63], v[80:95]
    s_setprio 3
    s_nop 7
    s_nop 3
    s_mov_b32 s27, 0x4e800000
    v_cmp_nlt_f32 vcc, v76, s27
    v_cmp_nlt_f32 s[48:49], v92, s27
    s_or_b64 vcc, vcc, s[48:49]
    s_cmp_lg_u64 vcc, 0
    s_cbranch_scc1 t_fb_125
t_ep_126:
    v_lshrrev_b32 v11, 4, v6
    v_mul_u32_u24 v11, 92160, v11
    v_and_b32 v12, 15, v6
    v_lshl_add_u32 v11, v12, 4, v11
    v_lshl_add_u32 v10, v7, 8, v11
    s_mul_i32 s27, s26, 184320
    s_add_u32 s27, s27, 3743744
    s_lshl_b32 s28, s25, 9
    s_add_u32 s28, s28, s27
    s_add_u32 s29, s28, 184320
    s_lshr_b32 s32, s25, 2
    s_lshl_b32 s32, s32, 8
    s_and_b32 s33, s25, 3
    s_lshl_b32 s33, s33, 2
    s_add_u32 s32, s32, s33
    s_add_u32 s32, s32, s27
    s_add_u32 s32, s32, 16384
    s_add_u32 s33, s32, 184320
    v_rcp_f32 v14, v76
    s_nop 0
    v_mul_f32 v64, v64, v14
    v_mul_f32 v65, v65, v14
    v_mul_f32 v66, v66, v14
    v_mul_f32 v67, v67, v14
    v_mul_f32 v68, v68, v14
    v_mul_f32 v69, v69, v14
    v_mul_f32 v70, v70, v14
    v_mul_f32 v71, v71, v14
    v_mul_f32 v72, v72, v14
    v_mul_f32 v73, v73, v14
    v_cvt_pk_bf16_f32 v48, v64, v65
    v_cvt_pk_bf16_f32 v49, v66, v67
    v_cvt_pk_bf16_f32 v50, v68, v69
    v_cvt_pk_bf16_f32 v51, v70, v71
    v_cvt_pk_bf16_f32 v52, v72, v73
    buffer_store_dwordx4 v[48:51], v10, s[8:11], s28 offen sc1
    v_rcp_f32 v14, v92
    s_nop 0
    v_mul_f32 v80, v80, v14
    v_mul_f32 v81, v81, v14
    v_mul_f32 v82, v82, v14
    v_mul_f32 v83, v83, v14
    v_mul_f32 v84, v84, v14
    v_mul_f32 v85, v85, v14
    v_mul_f32 v86, v86, v14
    v_mul_f32 v87, v87, v14
    v_mul_f32 v88, v88, v14
    v_mul_f32 v89, v89, v14
    v_cvt_pk_bf16_f32 v56, v80, v81
    v_cvt_pk_bf16_f32 v57, v82, v83
    v_cvt_pk_bf16_f32 v58, v84, v85
    v_cvt_pk_bf16_f32 v59, v86, v87
    v_cvt_pk_bf16_f32 v60, v88, v89
    buffer_store_dwordx4 v[56:59], v10, s[8:11], s29 offen sc1
    s_mov_b64 exec, 0xffffffff
    buffer_store_dword v52, v11, s[8:11], s32 offen sc1
    buffer_store_dword v60, v11, s[8:11], s33 offen sc1
    s_mov_b64 exec, -1
    s_branch t_end_127
t_fb_125:
    s_mul_i32 s29, s25, 18
    s_lshr_b32 s27, s29, 3
    s_lshl_b32 s27, s27, 9
    s_lshl_b32 s29, s29, 4
    s_sub_u32 s29, s29, s27
    s_add_u32 s29, s29, 36864
    v_add_u32 v9, s29, v9
    v_add_u32 v4, 18432, v9
    s_add_u32 s27, s27, 27262976
    s_mov_b32 s28, s27
    s_mov_b32 s30, 64
    v_mov_b32 v10, 0xff800000
    v_mov_b32 v11, 0xff800000
t_fb1_128:
    buffer_load_dwordx4 v[144:147], v2, s[8:11], s28 offen
    s_mov_b64 exec, 0xffffffff
    buffer_load_dwordx4 v[148:151], v2, s[8:11], s28 offen offset:1024
    s_mov_b64 exec, -1
    s_waitcnt vmcnt(0)
    v_mfma_f32_32x32x16_bf16 v[16:31], v[144:147], v[128:131], 0
    v_mfma_f32_32x32x16_bf16 v[16:31], v[148:151], v[132:135], v[16:31]
    v_mfma_f32_32x32x16_bf16 v[32:47], v[144:147], v[136:139], 0
    v_mfma_f32_32x32x16_bf16 v[32:47], v[148:151], v[140:143], v[32:47]
    s_nop 9
    v_max3_f32 v10, v10, v16, v17
    v_max3_f32 v10, v10, v18, v19
    v_max3_f32 v10, v10, v20, v21
    v_max3_f32 v10, v10, v22, v23
    v_max3_f32 v10, v10, v24, v25
    v_max3_f32 v10, v10, v26, v27
    v_max3_f32 v10, v10, v28, v29
    v_max3_f32 v10, v10, v30, v31
    v_max3_f32 v11, v11, v32, v33
    v_max3_f32 v11, v11, v34, v35
    v_max3_f32 v11, v11, v36, v37
    v_max3_f32 v11, v11, v38, v39
    v_max3_f32 v11, v11, v40, v41
    v_max3_f32 v11, v11, v42, v43
    v_max3_f32 v11, v11, v44, v45
    v_max3_f32 v11, v11, v46, v47
    s_add_u32 s28, s28, 73728
    s_sub_u32 s30, s30, 1
    s_cmp_lg_u32 s30, 0
    s_cbranch_scc1 t_fb1_128
    v_mov_b32 v12, v10
    s_nop 1
    v_permlane32_swap_b32 v12, v10
    v_max_f32 v10, v10, v12
    v_sub_f32 v10, 0, v10
    v_mov_b32 v96, v10
    v_mov_b32 v97, v10
    v_mov_b32 v98, v10
    v_mov_b32 v99, v10
    v_mov_b32 v100, v10
    v_mov_b32 v101, v10
    v_mov_b32 v102, v10
    v_mov_b32 v103, v10
    v_mov_b32 v104, v10
    v_mov_b32 v105, v10
    v_mov_b32 v106, v10
    v_mov_b32 v107, v10
    v_mov_b32 v108, v10
    v_mov_b32 v109, v10
    v_mov_b32 v110, v10
    v_mov_b32 v111, v10
    v_mov_b32 v12, v11
    s_nop 1
    v_permlane32_swap_b32 v12, v11
    v_max_f32 v11, v11, v12
    v_sub_f32 v11, 0, v11
    v_mov_b32 v112, v11
    v_mov_b32 v113, v11
    v_mov_b32 v114, v11
    v_mov_b32 v115, v11
    v_mov_b32 v116, v11
    v_mov_b32 v117, v11
    v_mov_b32 v118, v11
    v_mov_b32 v119, v11
    v_mov_b32 v120, v11
    v_mov_b32 v121, v11
    v_mov_b32 v122, v11
    v_mov_b32 v123, v11
    v_mov_b32 v124, v11
    v_mov_b32 v125, v11
    v_mov_b32 v126, v11
    v_mov_b32 v127, v11
    v_mov_b32 v64, 0
    v_mov_b32 v65, 0
    v_mov_b32 v66, 0
    v_mov_b32 v67, 0
    v_mov_b32 v68, 0
    v_mov_b32 v69, 0
    v_mov_b32 v70, 0
    v_mov_b32 v71, 0
    v_mov_b32 v72, 0
    v_mov_b32 v73, 0
    v_mov_b32 v74, 0
    v_mov_b32 v75, 0
    v_mov_b32 v76, 0
    v_mov_b32 v77, 0
    v_mov_b32 v78, 0
    v_mov_b32 v79, 0
    v_mov_b32 v80, 0
    v_mov_b32 v81, 0
    v_mov_b32 v82, 0
    v_mov_b32 v83, 0
    v_mov_b32 v84, 0
    v_mov_b32 v85, 0
    v_mov_b32 v86, 0
    v_mov_b32 v87, 0
    v_mov_b32 v88, 0
    v_mov_b32 v89, 0
    v_mov_b32 v90, 0
    v_mov_b32 v91, 0
    v_mov_b32 v92, 0
    v_mov_b32 v93, 0
    v_mov_b32 v94, 0
    v_mov_b32 v95, 0
    s_mov_b32 s28, s27
    s_mov_b32 s30, 64
t_fb2_129:
    buffer_load_dwordx4 v[144:147], v2, s[8:11], s28 offen
    s_mov_b64 exec, 0xffffffff
    buffer_load_dwordx4 v[148:151], v2, s[8:11], s28 offen offset:1024
    s_mov_b64 exec, -1
    s_mov_b64 exec, s[44:45]
    buffer_load_dwordx4 v[160:163], v9, s[8:11], s28 offen
    buffer_load_dwordx4 v[164:167], v4, s[8:11], s28 offen
    s_mov_b64 exec, -1
    s_waitcnt vmcnt(0)
    v_mfma_f32_32x32x16_bf16 v[16:31], v[144:147], v[128:131], v[96:111]
    v_mfma_f32_32x32x16_bf16 v[16:31], v[148:151], v[132:135], v[16:31]
    v_mfma_f32_32x32x16_bf16 v[32:47], v[144:147], v[136:139], v[112:127]
    v_mfma_f32_32x32x16_bf16 v[32:47], v[148:151], v[140:143], v[32:47]
    s_nop 9
    v_exp_f32 v16, v16
    v_exp_f32 v17, v17
    v_exp_f32 v18, v18
    v_exp_f32 v19, v19
    v_exp_f32 v20, v20
    v_exp_f32 v21, v21
    v_exp_f32 v22, v22
    v_exp_f32 v23, v23
    v_exp_f32 v24, v24
    v_exp_f32 v25, v25
    v_exp_f32 v26, v26
    v_exp_f32 v27, v27
    v_exp_f32 v28, v28
    v_exp_f32 v29, v29
    v_exp_f32 v30, v30
    v_exp_f32 v31, v31
    v_cvt_pk_bf16_f32 v48, v16, v17
    v_cvt_pk_bf16_f32 v49, v18, v19
    v_cvt_pk_bf16_f32 v50, v20, v21
    v_cvt_pk_bf16_f32 v51, v22, v23
    v_cvt_pk_bf16_f32 v52, v24, v25
    v_cvt_pk_bf16_f32 v53, v26, v27
    v_cvt_pk_bf16_f32 v54, v28, v29
    v_cvt_pk_bf16_f32 v55, v30, v31
    v_mfma_f32_32x32x16_bf16 v[64:79], v[160:163], v[48:51], v[64:79]
    s_nop 0
    v_mfma_f32_32x32x16_bf16 v[64:79], v[164:167], v[52:55], v[64:79]
    v_exp_f32 v32, v32
    v_exp_f32 v33, v33
    v_exp_f32 v34, v34
    v_exp_f32 v35, v35
    v_exp_f32 v36, v36
    v_exp_f32 v37, v37
    v_exp_f32 v38, v38
    v_exp_f32 v39, v39
    v_exp_f32 v40, v40
    v_exp_f32 v41, v41
    v_exp_f32 v42, v42
    v_exp_f32 v43, v43
    v_exp_f32 v44, v44
    v_exp_f32 v45, v45
    v_exp_f32 v46, v46
    v_exp_f32 v47, v47
    v_cvt_pk_bf16_f32 v56, v32, v33
    v_cvt_pk_bf16_f32 v57, v34, v35
    v_cvt_pk_bf16_f32 v58, v36, v37
    v_cvt_pk_bf16_f32 v59, v38, v39
    v_cvt_pk_bf16_f32 v60, v40, v41
    v_cvt_pk_bf16_f32 v61, v42, v43
    v_cvt_pk_bf16_f32 v62, v44, v45
    v_cvt_pk_bf16_f32 v63, v46, v47
    v_mfma_f32_32x32x16_bf16 v[80:95], v[160:163], v[56:59], v[80:95]
    s_nop 0
    v_mfma_f32_32x32x16_bf16 v[80:95], v[164:167], v[60:63], v[80:95]
    s_add_u32 s28, s28, 73728
    s_sub_u32 s30, s30, 1
    s_cmp_lg_u32 s30, 0
    s_cbranch_scc1 t_fb2_129
    s_nop 7
    s_nop 3
    s_branch t_ep_126
t_end_127:
p2_kernel_end:
    s_load_dwordx2 s[6:7], s[0:1], 0
    s_load_dwordx2 s[48:49], s[0:1], 64
    s_and_b32 s27, s2, 7
    s_lshr_b32 s28, s2, 3
    s_lshr_b32 s23, s27, 1
    s_lshl_b32 s23, s23, 3
    s_lshr_b32 s29, s28, 2
    s_add_u32 s23, s23, s29
    s_and_b32 s24, s27, 1
    s_lshl_b32 s24, s24, 2
    s_and_b32 s29, s28, 3
    s_add_u32 s24, s24, s29
    v_lshlrev_b32 v2, 4, v1
    v_and_b32 v96, 15, v1
    v_lshrrev_b32 v97, 4, v1
    v_lshlrev_b32 v98, 4, v96
    v_lshl_add_u32 v98, v97, 7, v98
    v_add_u32 v98, 4096, v98
    v_mov_b32 v99, 0x7f000000
    v_cmp_gt_u32 vcc, 8, v96
    s_nop 1
    v_cndmask_b32 v3, v99, v98, vcc
    s_mul_i32 s27, s22, 18
    s_cmp_eq_u32 s22, 5
    s_cselect_b32 s27, 77, s27
    s_cmp_eq_u32 s22, 6
    s_cselect_b32 s27, 82, s27
    s_cmp_eq_u32 s22, 7
    s_cselect_b32 s27, 86, s27
    s_mul_i32 s25, s23, 368640
    s_lshl_b32 s28, s27, 10
    s_add_u32 s25, s25, s28
    s_add_u32 s25, s25, 3670016
    s_mul_i32 s26, s24, 414720
    s_mul_i32 s28, s27, 4608
    s_add_u32 s26, s26, s28
    s_add_u32 s26, s26, 32505856
    s_mov_b32 s31, 0x40000
    s_waitcnt vmcnt(0)
    v_mov_b32 v12, s100
    v_mov_b32 v13, s101
    v_lshlrev_b32 v14, 3, v1
    s_mov_b64 exec, 0xffff
    buffer_store_dwordx2 v[12:13], v14, s[8:11], s52 offen sc1
    s_mov_b64 exec, -1
    s_cmp_ge_u32 s22, 4
    s_cbranch_scc1 p3e_130
    s_setprio 2
    s_add_u32 s26, s26, 9216
    buffer_load_dwordx4 v[208:211], v2, s[8:11], s26 offen offset:0
    buffer_load_dwordx4 v[212:215], v2, s[8:11], s26 offen offset:1024
    buffer_load_dwordx4 v[216:219], v2, s[8:11], s26 offen offset:2048
    buffer_load_dwordx4 v[220:223], v2, s[8:11], s26 offen offset:3072
    buffer_load_dwordx4 v[224:227], v3, s[8:11], s26 offen
    s_add_u32 s26, s26, 4608
    buffer_load_dwordx4 v[228:231], v2, s[8:11], s26 offen offset:0
    buffer_load_dwordx4 v[232:235], v2, s[8:11], s26 offen offset:1024
    buffer_load_dwordx4 v[236:239], v2, s[8:11], s26 offen offset:2048
    buffer_load_dwordx4 v[240:243], v2, s[8:11], s26 offen offset:3072
    buffer_load_dwordx4 v[244:247], v3, s[8:11], s26 offen
    s_add_u32 s26, s26, 4608
    buffer_load_dwordx4 v[148:151], v2, s[8:11], s26 offen offset:0
    buffer_load_dwordx4 v[152:155], v2, s[8:11], s26 offen offset:1024
    buffer_load_dwordx4 v[156:159], v2, s[8:11], s26 offen offset:2048
    buffer_load_dwordx4 v[160:163], v2, s[8:11], s26 offen offset:3072
    buffer_load_dwordx4 v[164:167], v3, s[8:11], s26 offen
    s_add_u32 s26, s26, 4608
    s_branch p3e_131
p3e_130:
    s_add_u32 s26, s26, 13824
    buffer_load_dwordx4 v[144:147], v2, s[8:11], s26 offen offset:0
    buffer_load_dwordx4 v[148:151], v2, s[8:11], s26 offen offset:1024
    buffer_load_dwordx4 v[152:155], v2, s[8:11], s26 offen offset:2048
    buffer_load_dwordx4 v[156:159], v2, s[8:11], s26 offen offset:3072
    buffer_load_dwordx4 v[160:163], v3, s[8:11], s26 offen
    s_add_u32 s26, s26, 4608
    s_cmp_ge_u32 s22, 6
    s_cbranch_scc1 p3e_131
    buffer_load_dwordx4 v[164:167], v2, s[8:11], s26 offen offset:0
    buffer_load_dwordx4 v[168:171], v2, s[8:11], s26 offen offset:1024
    buffer_load_dwordx4 v[172:175], v2, s[8:11], s26 offen offset:2048
    buffer_load_dwordx4 v[176:179], v2, s[8:11], s26 offen offset:3072
    buffer_load_dwordx4 v[180:183], v3, s[8:11], s26 offen
    s_add_u32 s26, s26, 4608
p3e_131:
    s_waitcnt lgkmcnt(0)
    s_mov_b32 s12, s6
    s_mov_b32 s13, s7
    s_mov_b32 s14, 0x240000
    s_mov_b32 s15, 0x00020000
    s_mov_b32 s16, s48
    s_mov_b32 s17, s49
    s_mov_b32 s18, 0x240000
    s_mov_b32 s19, 0x00020000
    s_mul_i32 s30, s23, 73728
    s_mul_i32 s28, s24, 144
    s_add_u32 s30, s30, s28
    v_add_u32 v96, 0, v0
    v_mul_u32_u24 v97, 3641, v96
    v_lshrrev_b32 v97, 16, v97
    v_mul_u32_u24 v98, 18, v97
    v_sub_u32 v98, v96, v98
    v_mul_u32_u24 v5, 1152, v97
    v_lshl_add_u32 v5, v98, 3, v5
    v_lshrrev_b32 v99, 4, v97
    v_mul_u32_u24 v99, 4896, v99
    v_mul_u32_u24 v98, 272, v98
    v_and_b32 v97, 15, v97
    v_lshl_add_u32 v99, v97, 4, v99
    v_add_u32 v8, v99, v98
    v_add_u32 v96, 512, v0
    v_mul_u32_u24 v97, 3641, v96
    v_lshrrev_b32 v97, 16, v97
    v_mul_u32_u24 v98, 18, v97
    v_sub_u32 v98, v96, v98
    v_mul_u32_u24 v6, 1152, v97
    v_lshl_add_u32 v6, v98, 3, v6
    v_lshrrev_b32 v99, 4, v97
    v_mul_u32_u24 v99, 4896, v99
    v_mul_u32_u24 v98, 272, v98
    v_and_b32 v97, 15, v97
    v_lshl_add_u32 v99, v97, 4, v99
    v_add_u32 v9, v99, v98
    v_add_u32 v96, 1024, v0
    v_mul_u32_u24 v97, 3641, v96
    v_lshrrev_b32 v97, 16, v97
    v_mul_u32_u24 v98, 18, v97
    v_sub_u32 v98, v96, v98
    v_mul_u32_u24 v7, 1152, v97
    v_lshl_add_u32 v7, v98, 3, v7
    v_lshrrev_b32 v99, 4, v97
    v_mul_u32_u24 v99, 4896, v99
    v_mul_u32_u24 v98, 272, v98
    v_and_b32 v97, 15, v97
    v_lshl_add_u32 v99, v97, 4, v99
    v_add_u32 v10, v99, v98
    v_cmp_gt_u32 vcc, 128, v0
    v_mov_b32 v99, 0x7f000000
    s_nop 0
    v_cndmask_b32 v7, v99, v7, vcc
    v_cndmask_b32 v10, 0, v10, vcc
    buffer_load_dwordx2 v[250:251], v5, s[12:15], s30 offen
    buffer_load_dwordx2 v[252:253], v6, s[12:15], s30 offen
    s_cmp_ge_u32 s22, 2
    s_cbranch_scc1 p3x_132
    buffer_load_dwordx2 v[254:255], v7, s[12:15], s30 offen
p3x_132:
    s_add_u32 s27, s22, 2
    s_sub_u32 s28, s22, 4
    s_cmp_ge_u32 s22, 4
    s_cselect_b32 s27, s28, s27
    s_cmp_ge_u32 s22, 6
    s_cselect_b32 s27, s22, s27
    s_mul_i32 s27, s27, 19584
    v_and_b32 v4, 48, v1
    v_add3_u32 v4, s27, v2, v4
    s_lshl_b32 s27, s22, 3
    v_and_b32 v96, 7, v1
    v_add_u32 v96, s27, v96
    v_and_b32 v97, 31, v1
    v_add_u32 v97, 32, v97
    s_cmp_ge_u32 s22, 4
    s_cselect_b64 vcc, -1, 0
    v_cndmask_b32 v96, v96, v97, vcc
    v_lshlrev_b32 v11, 7, v96
    s_lshl_b32 s34, s23, 13
    s_add_u32 s34, s34, 3276800
    v_mov_b32 v16, 0
    v_mov_b32 v17, 0
    v_mov_b32 v18, 0
    v_mov_b32 v19, 0
    v_mov_b32 v20, 0
    v_mov_b32 v21, 0
    v_mov_b32 v22, 0
    v_mov_b32 v23, 0
    v_mov_b32 v24, 0
    v_mov_b32 v25, 0
    v_mov_b32 v26, 0
    v_mov_b32 v27, 0
    v_mov_b32 v28, 0
    v_mov_b32 v29, 0
    v_mov_b32 v30, 0
    v_mov_b32 v31, 0
    v_mov_b32 v32, 0
    v_mov_b32 v33, 0
    v_mov_b32 v34, 0
    v_mov_b32 v35, 0
    v_mov_b32 v36, 0
    v_mov_b32 v37, 0
    v_mov_b32 v38, 0
    v_mov_b32 v39, 0
    v_mov_b32 v40, 0
    v_mov_b32 v41, 0
    v_mov_b32 v42, 0
    v_mov_b32 v43, 0
    v_mov_b32 v44, 0
    v_mov_b32 v45, 0
    v_mov_b32 v46, 0
    v_mov_b32 v47, 0
    v_mov_b32 v48, 0
    v_mov_b32 v49, 0
    v_mov_b32 v50, 0
    v_mov_b32 v51, 0
    v_mov_b32 v52, 0
    v_mov_b32 v53, 0
    v_mov_b32 v54, 0
    v_mov_b32 v55, 0
    v_mov_b32 v56, 0
    v_mov_b32 v57, 0
    v_mov_b32 v58, 0
    v_mov_b32 v59, 0
    v_mov_b32 v60, 0
    v_mov_b32 v61, 0
    v_mov_b32 v62, 0
    v_mov_b32 v63, 0
    v_mov_b32 v64, 0
    v_mov_b32 v65, 0
    v_mov_b32 v66, 0
    v_mov_b32 v67, 0
    v_mov_b32 v68, 0
    v_mov_b32 v69, 0
    v_mov_b32 v70, 0
    v_mov_b32 v71, 0
    v_mov_b32 v72, 0
    v_mov_b32 v73, 0
    v_mov_b32 v74, 0
    v_mov_b32 v75, 0
    v_mov_b32 v76, 0
    v_mov_b32 v77, 0
    v_mov_b32 v78, 0
    v_mov_b32 v79, 0
    v_mov_b32 v80, 0
    v_mov_b32 v81, 0
    v_mov_b32 v82, 0
    v_mov_b32 v83, 0
    v_mov_b32 v84, 0
    v_mov_b32 v85, 0
    v_mov_b32 v86, 0
    v_mov_b32 v87, 0
    v_mov_b32 v88, 0
    v_mov_b32 v89, 0
    v_mov_b32 v90, 0
    v_mov_b32 v91, 0
    v_mov_b32 v92, 0
    v_mov_b32 v93, 0
    v_mov_b32 v94, 0
    v_mov_b32 v95, 0
    s_mov_b32 exec_lo, 0xff
    s_cmp_eq_u32 s22, 4
    s_cselect_b32 exec_lo, 0x3ff, exec_lo
    s_cmp_eq_u32 s22, 5
    s_cselect_b32 exec_lo, 0xffc00, exec_lo
    s_cmp_eq_u32 s22, 6
    s_cselect_b32 exec_lo, 0xff00000, exec_lo
    s_cmp_eq_u32 s22, 7
    s_cselect_b32 exec_lo, -1, exec_lo
    s_mov_b32 exec_hi, 0
p3poll_133:
    buffer_load_dwordx2 v[12:13], v11, s[8:11], s34 offen sc1
    s_waitcnt vmcnt(0)
    v_cmp_ne_u64 vcc, s[100:101], v[12:13]
    s_cbranch_vccz p3go_134
    s_sleep 6
    s_sub_u32 s31, s31, 1
    s_cmp_gt_i32 s31, 0
    s_cbranch_scc1 p3poll_133
p3go_134:
    s_mov_b64 exec, -1
    s_cmp_ge_u32 s22, 4
    s_cbranch_scc1 p3t_135
    s_setprio 0
    buffer_load_dwordx4 v[96:99], v2, s[8:11], s25 offen sc1
    s_add_u32 s27, s25, 92160
    buffer_load_dwordx4 v[100:103], v2, s[8:11], s27 offen sc1
    s_add_u32 s27, s25, 184320
    buffer_load_dwordx4 v[104:107], v2, s[8:11], s27 offen sc1
    s_add_u32 s27, s25, 276480
    buffer_load_dwordx4 v[108:111], v2, s[8:11], s27 offen sc1
    s_add_u32 s25, s25, 1024
    buffer_load_dwordx4 v[112:115], v2, s[8:11], s25 offen sc1
    s_add_u32 s27, s25, 92160
    buffer_load_dwordx4 v[116:119], v2, s[8:11], s27 offen sc1
    s_add_u32 s27, s25, 184320
    buffer_load_dwordx4 v[120:123], v2, s[8:11], s27 offen sc1
    s_add_u32 s27, s25, 276480
    buffer_load_dwordx4 v[124:127], v2, s[8:11], s27 offen sc1
    s_add_u32 s25, s25, 1024
    buffer_load_dwordx4 v[128:131], v2, s[8:11], s25 offen sc1
    s_add_u32 s27, s25, 92160
    buffer_load_dwordx4 v[132:135], v2, s[8:11], s27 offen sc1
    s_add_u32 s27, s25, 184320
    buffer_load_dwordx4 v[136:139], v2, s[8:11], s27 offen sc1
    s_add_u32 s27, s25, 276480
    buffer_load_dwordx4 v[140:143], v2, s[8:11], s27 offen sc1
    s_add_u32 s25, s25, 1024
    s_waitcnt vmcnt(8)
    v_mfma_f32_16x16x32_bf16 v[16:19], v[168:171], v[96:99], v[16:19]
    v_mfma_f32_16x16x32_bf16 v[20:23], v[172:175], v[96:99], v[20:23]
    v_mfma_f32_16x16x32_bf16 v[24:27], v[176:179], v[96:99], v[24:27]
    v_mfma_f32_16x16x32_bf16 v[28:31], v[180:183], v[96:99], v[28:31]
    v_mfma_f32_16x16x32_bf16 v[32:35], v[184:187], v[96:99], v[32:35]
    buffer_load_dwordx4 v[96:99], v2, s[8:11], s25 offen sc1
    v_mfma_f32_16x16x32_bf16 v[36:39], v[168:171], v[100:103], v[36:39]
    v_mfma_f32_16x16x32_bf16 v[40:43], v[172:175], v[100:103], v[40:43]
    v_mfma_f32_16x16x32_bf16 v[44:47], v[176:179], v[100:103], v[44:47]
    v_mfma_f32_16x16x32_bf16 v[48:51], v[180:183], v[100:103], v[48:51]
    v_mfma_f32_16x16x32_bf16 v[52:55], v[184:187], v[100:103], v[52:55]
    s_add_u32 s27, s25, 92160
    buffer_load_dwordx4 v[100:103], v2, s[8:11], s27 offen sc1
    v_mfma_f32_16x16x32_bf16 v[56:59], v[168:171], v[104:107], v[56:59]
    v_mfma_f32_16x16x32_bf16 v[60:63], v[172:175], v[104:107], v[60:63]
    v_mfma_f32_16x16x32_bf16 v[64:67], v[176:179], v[104:107], v[64:67]
    v_mfma_f32_16x16x32_bf16 v[68:71], v[180:183], v[104:107], v[68:71]
    v_mfma_f32_16x16x32_bf16 v[72:75], v[184:187], v[104:107], v[72:75]
    s_add_u32 s27, s25, 184320
    buffer_load_dwordx4 v[104:107], v2, s[8:11], s27 offen sc1
    v_mfma_f32_16x16x32_bf16 v[76:79], v[168:171], v[108:111], v[76:79]
    v_mfma_f32_16x16x32_bf16 v[80:83], v[172:175], v[108:111], v[80:83]
    v_mfma_f32_16x16x32_bf16 v[84:87], v[176:179], v[108:111], v[84:87]
    v_mfma_f32_16x16x32_bf16 v[88:91], v[180:183], v[108:111], v[88:91]
    v_mfma_f32_16x16x32_bf16 v[92:95], v[184:187], v[108:111], v[92:95]
    s_add_u32 s27, s25, 276480
    buffer_load_dwordx4 v[108:111], v2, s[8:11], s27 offen sc1
    s_add_u32 s25, s25, 1024
    s_waitcnt vmcnt(8)
    v_mfma_f32_16x16x32_bf16 v[16:19], v[188:191], v[112:115], v[16:19]
    buffer_load_dwordx4 v[168:171], v2, s[8:11], s26 offen offset:0
    v_mfma_f32_16x16x32_bf16 v[20:23], v[192:195], v[112:115], v[20:23]
    v_mfma_f32_16x16x32_bf16 v[24:27], v[196:199], v[112:115], v[24:27]
    buffer_load_dwordx4 v[172:175], v2, s[8:11], s26 offen offset:1024
    v_mfma_f32_16x16x32_bf16 v[28:31], v[200:203], v[112:115], v[28:31]
    v_mfma_f32_16x16x32_bf16 v[32:35], v[204:207], v[112:115], v[32:35]
    buffer_load_dwordx4 v[112:115], v2, s[8:11], s25 offen sc1
    v_mfma_f32_16x16x32_bf16 v[36:39], v[188:191], v[116:119], v[36:39]
    v_mfma_f32_16x16x32_bf16 v[40:43], v[192:195], v[116:119], v[40:43]
    v_mfma_f32_16x16x32_bf16 v[44:47], v[196:199], v[116:119], v[44:47]
    buffer_load_dwordx4 v[176:179], v2, s[8:11], s26 offen offset:2048
    v_mfma_f32_16x16x32_bf16 v[48:51], v[200:203], v[116:119], v[48:51]
    v_mfma_f32_16x16x32_bf16 v[52:55], v[204:207], v[116:119], v[52:55]
    s_add_u32 s27, s25, 92160
    buffer_load_dwordx4 v[116:119], v2, s[8:11], s27 offen sc1
    v_mfma_f32_16x16x32_bf16 v[56:59], v[188:191], v[120:123], v[56:59]
    v_mfma_f32_16x16x32_bf16 v[60:63], v[192:195], v[120:123], v[60:63]
    v_mfma_f32_16x16x32_bf16 v[64:67], v[196:199], v[120:123], v[64:67]
    buffer_load_dwordx4 v[180:183], v2, s[8:11], s26 offen offset:3072
    v_mfma_f32_16x16x32_bf16 v[68:71], v[200:203], v[120:123], v[68:71]
    v_mfma_f32_16x16x32_bf16 v[72:75], v[204:207], v[120:123], v[72:75]
    s_add_u32 s27, s25, 184320
    buffer_load_dwordx4 v[120:123], v2, s[8:11], s27 offen sc1
    v_mfma_f32_16x16x32_bf16 v[76:79], v[188:191], v[124:127], v[76:79]
    v_mfma_f32_16x16x32_bf16 v[80:83], v[192:195], v[124:127], v[80:83]
    v_mfma_f32_16x16x32_bf16 v[84:87], v[196:199], v[124:127], v[84:87]
    buffer_load_dwordx4 v[184:187], v3, s[8:11], s26 offen
    s_add_u32 s26, s26, 4608
    v_mfma_f32_16x16x32_bf16 v[88:91], v[200:203], v[124:127], v[88:91]
    v_mfma_f32_16x16x32_bf16 v[92:95], v[204:207], v[124:127], v[92:95]
    s_add_u32 s27, s25, 276480
    buffer_load_dwordx4 v[124:127], v2, s[8:11], s27 offen sc1
    s_add_u32 s25, s25, 1024
    s_waitcnt vmcnt(13)
    v_mfma_f32_16x16x32_bf16 v[16:19], v[208:211], v[128:131], v[16:19]
    buffer_load_dwordx4 v[188:191], v2, s[8:11], s26 offen offset:0
    v_mfma_f32_16x16x32_bf16 v[20:23], v[212:215], v[128:131], v[20:23]
    v_mfma_f32_16x16x32_bf16 v[24:27], v[216:219], v[128:131], v[24:27]
    buffer_load_dwordx4 v[192:195], v2, s[8:11], s26 offen offset:1024
    v_mfma_f32_16x16x32_bf16 v[28:31], v[220:223], v[128:131], v[28:31]
    v_mfma_f32_16x16x32_bf16 v[32:35], v[224:227], v[128:131], v[32:35]
    buffer_load_dwordx4 v[128:131], v2, s[8:11], s25 offen sc1
    v_mfma_f32_16x16x32_bf16 v[36:39], v[208:211], v[132:135], v[36:39]
    v_mfma_f32_16x16x32_bf16 v[40:43], v[212:215], v[132:135], v[40:43]
    v_mfma_f32_16x16x32_bf16 v[44:47], v[216:219], v[132:135], v[44:47]
    buffer_load_dwordx4 v[196:199], v2, s[8:11], s26 offen offset:2048
    v_mfma_f32_16x16x32_bf16 v[48:51], v[220:223], v[132:135], v[48:51]
    v_mfma_f32_16x16x32_bf16 v[52:55], v[224:227], v[132:135], v[52:55]
    s_add_u32 s27, s25, 92160
    buffer_load_dwordx4 v[132:135], v2, s[8:11], s27 offen sc1
    v_mfma_f32_16x16x32_bf16 v[56:59], v[208:211], v[136:139], v[56:59]
    v_mfma_f32_16x16x32_bf16 v[60:63], v[212:215], v[136:139], v[60:63]
    v_mfma_f32_16x16x32_bf16 v[64:67], v[216:219], v[136:139], v[64:67]
    buffer_load_dwordx4 v[200:203], v2, s[8:11], s26 offen offset:3072
    v_mfma_f32_16x16x32_bf16 v[68:71], v[220:223], v[136:139], v[68:71]
    v_mfma_f32_16x16x32_bf16 v[72:75], v[224:227], v[136:139], v[72:75]
    s_add_u32 s27, s25, 184320
    buffer_load_dwordx4 v[136:139], v2, s[8:11], s27 offen sc1
    v_mfma_f32_16x16x32_bf16 v[76:79], v[208:211], v[140:143], v[76:79]
    v_mfma_f32_16x16x32_bf16 v[80:83], v[212:215], v[140:143], v[80:83]
    v_mfma_f32_16x16x32_bf16 v[84:87], v[216:219], v[140:143], v[84:87]
    buffer_load_dwordx4 v[204:207], v3, s[8:11], s26 offen
    s_add_u32 s26, s26, 4608
    v_mfma_f32_16x16x32_bf16 v[88:91], v[220:223], v[140:143], v[88:91]
    v_mfma_f32_16x16x32_bf16 v[92:95], v[224:227], v[140:143], v[92:95]
    s_add_u32 s27, s25, 276480
    buffer_load_dwordx4 v[140:143], v2, s[8:11], s27 offen sc1
    s_add_u32 s25, s25, 1024
    s_waitcnt vmcnt(18)
    v_mfma_f32_16x16x32_bf16 v[16:19], v[228:231], v[96:99], v[16:19]
    buffer_load_dwordx4 v[208:211], v2, s[8:11], s26 offen offset:0
    v_mfma_f32_16x16x32_bf16 v[20:23], v[232:235], v[96:99], v[20:23]
    v_mfma_f32_16x16x32_bf16 v[24:27], v[236:239], v[96:99], v[24:27]
    buffer_load_dwordx4 v[212:215], v2, s[8:11], s26 offen offset:1024
    v_mfma_f32_16x16x32_bf16 v[28:31], v[240:243], v[96:99], v[28:31]
    v_mfma_f32_16x16x32_bf16 v[32:35], v[244:247], v[96:99], v[32:35]
    buffer_load_dwordx4 v[96:99], v2, s[8:11], s25 offen sc1
    v_mfma_f32_16x16x32_bf16 v[36:39], v[228:231], v[100:103], v[36:39]
    v_mfma_f32_16x16x32_bf16 v[40:43], v[232:235], v[100:103], v[40:43]
    v_mfma_f32_16x16x32_bf16 v[44:47], v[236:239], v[100:103], v[44:47]
    buffer_load_dwordx4 v[216:219], v2, s[8:11], s26 offen offset:2048
    v_mfma_f32_16x16x32_bf16 v[48:51], v[240:243], v[100:103], v[48:51]
    v_mfma_f32_16x16x32_bf16 v[52:55], v[244:247], v[100:103], v[52:55]
    s_add_u32 s27, s25, 92160
    buffer_load_dwordx4 v[100:103], v2, s[8:11], s27 offen sc1
    v_mfma_f32_16x16x32_bf16 v[56:59], v[228:231], v[104:107], v[56:59]
    v_mfma_f32_16x16x32_bf16 v[60:63], v[232:235], v[104:107], v[60:63]
    v_mfma_f32_16x16x32_bf16 v[64:67], v[236:239], v[104:107], v[64:67]
    buffer_load_dwordx4 v[220:223], v2, s[8:11], s26 offen offset:3072
    v_mfma_f32_16x16x32_bf16 v[68:71], v[240:243], v[104:107], v[68:71]
    v_mfma_f32_16x16x32_bf16 v[72:75], v[244:247], v[104:107], v[72:75]
    s_add_u32 s27, s25, 184320
    buffer_load_dwordx4 v[104:107], v2, s[8:11], s27 offen sc1
    v_mfma_f32_16x16x32_bf16 v[76:79], v[228:231], v[108:111], v[76:79]
    v_mfma_f32_16x16x32_bf16 v[80:83], v[232:235], v[108:111], v[80:83]
    v_mfma_f32_16x16x32_bf16 v[84:87], v[236:239], v[108:111], v[84:87]
    buffer_load_dwordx4 v[224:227], v3, s[8:11], s26 offen
    s_add_u32 s26, s26, 4608
    v_mfma_f32_16x16x32_bf16 v[88:91], v[240:243], v[108:111], v[88:91]
    v_mfma_f32_16x16x32_bf16 v[92:95], v[244:247], v[108:111], v[92:95]
    s_add_u32 s27, s25, 276480
    buffer_load_dwordx4 v[108:111], v2, s[8:11], s27 offen sc1
    s_add_u32 s25, s25, 1024
    s_waitcnt vmcnt(18)
    v_mfma_f32_16x16x32_bf16 v[16:19], v[148:151], v[112:115], v[16:19]
    buffer_load_dwordx4 v[228:231], v2, s[8:11], s26 offen offset:0
    v_mfma_f32_16x16x32_bf16 v[20:23], v[152:155], v[112:115], v[20:23]
    v_mfma_f32_16x16x32_bf16 v[24:27], v[156:159], v[112:115], v[24:27]
    buffer_load_dwordx4 v[232:235], v2, s[8:11], s26 offen offset:1024
    v_mfma_f32_16x16x32_bf16 v[28:31], v[160:163], v[112:115], v[28:31]
    v_mfma_f32_16x16x32_bf16 v[32:35], v[164:167], v[112:115], v[32:35]
    buffer_load_dwordx4 v[112:115], v2, s[8:11], s25 offen sc1
    v_mfma_f32_16x16x32_bf16 v[36:39], v[148:151], v[116:119], v[36:39]
    v_mfma_f32_16x16x32_bf16 v[40:43], v[152:155], v[116:119], v[40:43]
    v_mfma_f32_16x16x32_bf16 v[44:47], v[156:159], v[116:119], v[44:47]
    buffer_load_dwordx4 v[236:239], v2, s[8:11], s26 offen offset:2048
    v_mfma_f32_16x16x32_bf16 v[48:51], v[160:163], v[116:119], v[48:51]
    v_mfma_f32_16x16x32_bf16 v[52:55], v[164:167], v[116:119], v[52:55]
    s_add_u32 s27, s25, 92160
    buffer_load_dwordx4 v[116:119], v2, s[8:11], s27 offen sc1
    v_mfma_f32_16x16x32_bf16 v[56:59], v[148:151], v[120:123], v[56:59]
    v_mfma_f32_16x16x32_bf16 v[60:63], v[152:155], v[120:123], v[60:63]
    v_mfma_f32_16x16x32_bf16 v[64:67], v[156:159], v[120:123], v[64:67]
    buffer_load_dwordx4 v[240:243], v2, s[8:11], s26 offen offset:3072
    v_mfma_f32_16x16x32_bf16 v[68:71], v[160:163], v[120:123], v[68:71]
    v_mfma_f32_16x16x32_bf16 v[72:75], v[164:167], v[120:123], v[72:75]
    s_add_u32 s27, s25, 184320
    buffer_load_dwordx4 v[120:123], v2, s[8:11], s27 offen sc1
    v_mfma_f32_16x16x32_bf16 v[76:79], v[148:151], v[124:127], v[76:79]
    v_mfma_f32_16x16x32_bf16 v[80:83], v[152:155], v[124:127], v[80:83]
    v_mfma_f32_16x16x32_bf16 v[84:87], v[156:159], v[124:127], v[84:87]
    buffer_load_dwordx4 v[244:247], v3, s[8:11], s26 offen
    s_add_u32 s26, s26, 4608
    v_mfma_f32_16x16x32_bf16 v[88:91], v[160:163], v[124:127], v[88:91]
    v_mfma_f32_16x16x32_bf16 v[92:95], v[164:167], v[124:127], v[92:95]
    s_add_u32 s27, s25, 276480
    buffer_load_dwordx4 v[124:127], v2, s[8:11], s27 offen sc1
    s_add_u32 s25, s25, 1024
    s_waitcnt vmcnt(18)
    v_mfma_f32_16x16x32_bf16 v[16:19], v[168:171], v[128:131], v[16:19]
    buffer_load_dwordx4 v[148:151], v2, s[8:11], s26 offen offset:0
    v_mfma_f32_16x16x32_bf16 v[20:23], v[172:175], v[128:131], v[20:23]
    v_mfma_f32_16x16x32_bf16 v[24:27], v[176:179], v[128:131], v[24:27]
    buffer_load_dwordx4 v[152:155], v2, s[8:11], s26 offen offset:1024
    v_mfma_f32_16x16x32_bf16 v[28:31], v[180:183], v[128:131], v[28:31]
    v_mfma_f32_16x16x32_bf16 v[32:35], v[184:187], v[128:131], v[32:35]
    buffer_load_dwordx4 v[128:131], v2, s[8:11], s25 offen sc1
    v_mfma_f32_16x16x32_bf16 v[36:39], v[168:171], v[132:135], v[36:39]
    v_mfma_f32_16x16x32_bf16 v[40:43], v[172:175], v[132:135], v[40:43]
    v_mfma_f32_16x16x32_bf16 v[44:47], v[176:179], v[132:135], v[44:47]
    buffer_load_dwordx4 v[156:159], v2, s[8:11], s26 offen offset:2048
    v_mfma_f32_16x16x32_bf16 v[48:51], v[180:183], v[132:135], v[48:51]
    v_mfma_f32_16x16x32_bf16 v[52:55], v[184:187], v[132:135], v[52:55]
    s_add_u32 s27, s25, 92160
    buffer_load_dwordx4 v[132:135], v2, s[8:11], s27 offen sc1
    v_mfma_f32_16x16x32_bf16 v[56:59], v[168:171], v[136:139], v[56:59]
    v_mfma_f32_16x16x32_bf16 v[60:63], v[172:175], v[136:139], v[60:63]
    v_mfma_f32_16x16x32_bf16 v[64:67], v[176:179], v[136:139], v[64:67]
    buffer_load_dwordx4 v[160:163], v2, s[8:11], s26 offen offset:3072
    v_mfma_f32_16x16x32_bf16 v[68:71], v[180:183], v[136:139], v[68:71]
    v_mfma_f32_16x16x32_bf16 v[72:75], v[184:187], v[136:139], v[72:75]
    s_add_u32 s27, s25, 184320
    buffer_load_dwordx4 v[136:139], v2, s[8:11], s27 offen sc1
    v_mfma_f32_16x16x32_bf16 v[76:79], v[168:171], v[140:143], v[76:79]
    v_mfma_f32_16x16x32_bf16 v[80:83], v[172:175], v[140:143], v[80:83]
    v_mfma_f32_16x16x32_bf16 v[84:87], v[176:179], v[140:143], v[84:87]
    buffer_load_dwordx4 v[164:167], v3, s[8:11], s26 offen
    s_add_u32 s26, s26, 4608
    v_mfma_f32_16x16x32_bf16 v[88:91], v[180:183], v[140:143], v[88:91]
    v_mfma_f32_16x16x32_bf16 v[92:95], v[184:187], v[140:143], v[92:95]
    s_add_u32 s27, s25, 276480
    buffer_load_dwordx4 v[140:143], v2, s[8:11], s27 offen sc1
    s_add_u32 s25, s25, 1024
    s_waitcnt vmcnt(18)
    v_mfma_f32_16x16x32_bf16 v[16:19], v[188:191], v[96:99], v[16:19]
    buffer_load_dwordx4 v[168:171], v2, s[8:11], s26 offen offset:0
    v_mfma_f32_16x16x32_bf16 v[20:23], v[192:195], v[96:99], v[20:23]
    v_mfma_f32_16x16x32_bf16 v[24:27], v[196:199], v[96:99], v[24:27]
    buffer_load_dwordx4 v[172:175], v2, s[8:11], s26 offen offset:1024
    v_mfma_f32_16x16x32_bf16 v[28:31], v[200:203], v[96:99], v[28:31]
    v_mfma_f32_16x16x32_bf16 v[32:35], v[204:207], v[96:99], v[32:35]
    buffer_load_dwordx4 v[96:99], v2, s[8:11], s25 offen sc1
    v_mfma_f32_16x16x32_bf16 v[36:39], v[188:191], v[100:103], v[36:39]
    v_mfma_f32_16x16x32_bf16 v[40:43], v[192:195], v[100:103], v[40:43]
    v_mfma_f32_16x16x32_bf16 v[44:47], v[196:199], v[100:103], v[44:47]
    buffer_load_dwordx4 v[176:179], v2, s[8:11], s26 offen offset:2048
    v_mfma_f32_16x16x32_bf16 v[48:51], v[200:203], v[100:103], v[48:51]
    v_mfma_f32_16x16x32_bf16 v[52:55], v[204:207], v[100:103], v[52:55]
    s_add_u32 s27, s25, 92160
    buffer_load_dwordx4 v[100:103], v2, s[8:11], s27 offen sc1
    v_mfma_f32_16x16x32_bf16 v[56:59], v[188:191], v[104:107], v[56:59]
    v_mfma_f32_16x16x32_bf16 v[60:63], v[192:195], v[104:107], v[60:63]
    v_mfma_f32_16x16x32_bf16 v[64:67], v[196:199], v[104:107], v[64:67]
    buffer_load_dwordx4 v[180:183], v2, s[8:11], s26 offen offset:3072
    v_mfma_f32_16x16x32_bf16 v[68:71], v[200:203], v[104:107], v[68:71]
    v_mfma_f32_16x16x32_bf16 v[72:75], v[204:207], v[104:107], v[72:75]
    s_add_u32 s27, s25, 184320
    buffer_load_dwordx4 v[104:107], v2, s[8:11], s27 offen sc1
    v_mfma_f32_16x16x32_bf16 v[76:79], v[188:191], v[108:111], v[76:79]
    v_mfma_f32_16x16x32_bf16 v[80:83], v[192:195], v[108:111], v[80:83]
    v_mfma_f32_16x16x32_bf16 v[84:87], v[196:199], v[108:111], v[84:87]
    buffer_load_dwordx4 v[184:187], v3, s[8:11], s26 offen
    s_add_u32 s26, s26, 4608
    v_mfma_f32_16x16x32_bf16 v[88:91], v[200:203], v[108:111], v[88:91]
    v_mfma_f32_16x16x32_bf16 v[92:95], v[204:207], v[108:111], v[92:95]
    s_add_u32 s27, s25, 276480
    buffer_load_dwordx4 v[108:111], v2, s[8:11], s27 offen sc1
    s_add_u32 s25, s25, 1024
    s_waitcnt vmcnt(18)
    v_mfma_f32_16x16x32_bf16 v[16:19], v[208:211], v[112:115], v[16:19]
    buffer_load_dwordx4 v[188:191], v2, s[8:11], s26 offen offset:0
    v_mfma_f32_16x16x32_bf16 v[20:23], v[212:215], v[112:115], v[20:23]
    v_mfma_f32_16x16x32_bf16 v[24:27], v[216:219], v[112:115], v[24:27]
    buffer_load_dwordx4 v[192:195], v2, s[8:11], s26 offen offset:1024
    v_mfma_f32_16x16x32_bf16 v[28:31], v[220:223], v[112:115], v[28:31]
    v_mfma_f32_16x16x32_bf16 v[32:35], v[224:227], v[112:115], v[32:35]
    buffer_load_dwordx4 v[112:115], v2, s[8:11], s25 offen sc1
    v_mfma_f32_16x16x32_bf16 v[36:39], v[208:211], v[116:119], v[36:39]
    v_mfma_f32_16x16x32_bf16 v[40:43], v[212:215], v[116:119], v[40:43]
    v_mfma_f32_16x16x32_bf16 v[44:47], v[216:219], v[116:119], v[44:47]
    buffer_load_dwordx4 v[196:199], v2, s[8:11], s26 offen offset:2048
    v_mfma_f32_16x16x32_bf16 v[48:51], v[220:223], v[116:119], v[48:51]
    v_mfma_f32_16x16x32_bf16 v[52:55], v[224:227], v[116:119], v[52:55]
    s_add_u32 s27, s25, 92160
    buffer_load_dwordx4 v[116:119], v2, s[8:11], s27 offen sc1
    v_mfma_f32_16x16x32_bf16 v[56:59], v[208:211], v[120:123], v[56:59]
    v_mfma_f32_16x16x32_bf16 v[60:63], v[212:215], v[120:123], v[60:63]
    v_mfma_f32_16x16x32_bf16 v[64:67], v[216:219], v[120:123], v[64:67]
    buffer_load_dwordx4 v[200:203], v2, s[8:11], s26 offen offset:3072
    v_mfma_f32_16x16x32_bf16 v[68:71], v[220:223], v[120:123], v[68:71]
    v_mfma_f32_16x16x32_bf16 v[72:75], v[224:227], v[120:123], v[72:75]
    s_add_u32 s27, s25, 184320
    buffer_load_dwordx4 v[120:123], v2, s[8:11], s27 offen sc1
    v_mfma_f32_16x16x32_bf16 v[76:79], v[208:211], v[124:127], v[76:79]
    v_mfma_f32_16x16x32_bf16 v[80:83], v[212:215], v[124:127], v[80:83]
    v_mfma_f32_16x16x32_bf16 v[84:87], v[216:219], v[124:127], v[84:87]
    buffer_load_dwordx4 v[204:207], v3, s[8:11], s26 offen
    s_add_u32 s26, s26, 4608
    v_mfma_f32_16x16x32_bf16 v[88:91], v[220:223], v[124:127], v[88:91]
    v_mfma_f32_16x16x32_bf16 v[92:95], v[224:227], v[124:127], v[92:95]
    s_add_u32 s27, s25, 276480
    buffer_load_dwordx4 v[124:127], v2, s[8:11], s27 offen sc1
    s_add_u32 s25, s25, 1024
    s_waitcnt vmcnt(18)
    v_mfma_f32_16x16x32_bf16 v[16:19], v[228:231], v[128:131], v[16:19]
    buffer_load_dwordx4 v[208:211], v2, s[8:11], s26 offen offset:0
    v_mfma_f32_16x16x32_bf16 v[20:23], v[232:235], v[128:131], v[20:23]
    v_mfma_f32_16x16x32_bf16 v[24:27], v[236:239], v[128:131], v[24:27]
    buffer_load_dwordx4 v[212:215], v2, s[8:11], s26 offen offset:1024
    v_mfma_f32_16x16x32_bf16 v[28:31], v[240:243], v[128:131], v[28:31]
    v_mfma_f32_16x16x32_bf16 v[32:35], v[244:247], v[128:131], v[32:35]
    buffer_load_dwordx4 v[128:131], v2, s[8:11], s25 offen sc1
    v_mfma_f32_16x16x32_bf16 v[36:39], v[228:231], v[132:135], v[36:39]
    v_mfma_f32_16x16x32_bf16 v[40:43], v[232:235], v[132:135], v[40:43]
    v_mfma_f32_16x16x32_bf16 v[44:47], v[236:239], v[132:135], v[44:47]
    buffer_load_dwordx4 v[216:219], v2, s[8:11], s26 offen offset:2048
    v_mfma_f32_16x16x32_bf16 v[48:51], v[240:243], v[132:135], v[48:51]
    v_mfma_f32_16x16x32_bf16 v[52:55], v[244:247], v[132:135], v[52:55]
    s_add_u32 s27, s25, 92160
    buffer_load_dwordx4 v[132:135], v2, s[8:11], s27 offen sc1
    v_mfma_f32_16x16x32_bf16 v[56:59], v[228:231], v[136:139], v[56:59]
    v_mfma_f32_16x16x32_bf16 v[60:63], v[232:235], v[136:139], v[60:63]
    v_mfma_f32_16x16x32_bf16 v[64:67], v[236:239], v[136:139], v[64:67]
    buffer_load_dwordx4 v[220:223], v2, s[8:11], s26 offen offset:3072
    v_mfma_f32_16x16x32_bf16 v[68:71], v[240:243], v[136:139], v[68:71]
    v_mfma_f32_16x16x32_bf16 v[72:75], v[244:247], v[136:139], v[72:75]
    s_add_u32 s27, s25, 184320
    buffer_load_dwordx4 v[136:139], v2, s[8:11], s27 offen sc1
    v_mfma_f32_16x16x32_bf16 v[76:79], v[228:231], v[140:143], v[76:79]
    v_mfma_f32_16x16x32_bf16 v[80:83], v[232:235], v[140:143], v[80:83]
    v_mfma_f32_16x16x32_bf16 v[84:87], v[236:239], v[140:143], v[84:87]
    buffer_load_dwordx4 v[224:227], v3, s[8:11], s26 offen
    s_add_u32 s26, s26, 4608
    v_mfma_f32_16x16x32_bf16 v[88:91], v[240:243], v[140:143], v[88:91]
    v_mfma_f32_16x16x32_bf16 v[92:95], v[244:247], v[140:143], v[92:95]
    s_add_u32 s27, s25, 276480
    buffer_load_dwordx4 v[140:143], v2, s[8:11], s27 offen sc1
    s_add_u32 s25, s25, 1024
    s_waitcnt vmcnt(18)
    v_mfma_f32_16x16x32_bf16 v[16:19], v[148:151], v[96:99], v[16:19]
    buffer_load_dwordx4 v[228:231], v2, s[8:11], s26 offen offset:0
    v_mfma_f32_16x16x32_bf16 v[20:23], v[152:155], v[96:99], v[20:23]
    v_mfma_f32_16x16x32_bf16 v[24:27], v[156:159], v[96:99], v[24:27]
    buffer_load_dwordx4 v[232:235], v2, s[8:11], s26 offen offset:1024
    v_mfma_f32_16x16x32_bf16 v[28:31], v[160:163], v[96:99], v[28:31]
    v_mfma_f32_16x16x32_bf16 v[32:35], v[164:167], v[96:99], v[32:35]
    buffer_load_dwordx4 v[96:99], v2, s[8:11], s25 offen sc1
    v_mfma_f32_16x16x32_bf16 v[36:39], v[148:151], v[100:103], v[36:39]
    v_mfma_f32_16x16x32_bf16 v[40:43], v[152:155], v[100:103], v[40:43]
    v_mfma_f32_16x16x32_bf16 v[44:47], v[156:159], v[100:103], v[44:47]
    buffer_load_dwordx4 v[236:239], v2, s[8:11], s26 offen offset:2048
    v_mfma_f32_16x16x32_bf16 v[48:51], v[160:163], v[100:103], v[48:51]
    v_mfma_f32_16x16x32_bf16 v[52:55], v[164:167], v[100:103], v[52:55]
    s_add_u32 s27, s25, 92160
    buffer_load_dwordx4 v[100:103], v2, s[8:11], s27 offen sc1
    v_mfma_f32_16x16x32_bf16 v[56:59], v[148:151], v[104:107], v[56:59]
    v_mfma_f32_16x16x32_bf16 v[60:63], v[152:155], v[104:107], v[60:63]
    v_mfma_f32_16x16x32_bf16 v[64:67], v[156:159], v[104:107], v[64:67]
    buffer_load_dwordx4 v[240:243], v2, s[8:11], s26 offen offset:3072
    v_mfma_f32_16x16x32_bf16 v[68:71], v[160:163], v[104:107], v[68:71]
    v_mfma_f32_16x16x32_bf16 v[72:75], v[164:167], v[104:107], v[72:75]
    s_add_u32 s27, s25, 184320
    buffer_load_dwordx4 v[104:107], v2, s[8:11], s27 offen sc1
    v_mfma_f32_16x16x32_bf16 v[76:79], v[148:151], v[108:111], v[76:79]
    v_mfma_f32_16x16x32_bf16 v[80:83], v[152:155], v[108:111], v[80:83]
    v_mfma_f32_16x16x32_bf16 v[84:87], v[156:159], v[108:111], v[84:87]
    buffer_load_dwordx4 v[244:247], v3, s[8:11], s26 offen
    s_add_u32 s26, s26, 4608
    v_mfma_f32_16x16x32_bf16 v[88:91], v[160:163], v[108:111], v[88:91]
    v_mfma_f32_16x16x32_bf16 v[92:95], v[164:167], v[108:111], v[92:95]
    s_add_u32 s27, s25, 276480
    buffer_load_dwordx4 v[108:111], v2, s[8:11], s27 offen sc1
    s_add_u32 s25, s25, 1024
    s_waitcnt vmcnt(18)
    v_mfma_f32_16x16x32_bf16 v[16:19], v[168:171], v[112:115], v[16:19]
    buffer_load_dwordx4 v[148:151], v2, s[8:11], s26 offen offset:0
    v_mfma_f32_16x16x32_bf16 v[20:23], v[172:175], v[112:115], v[20:23]
    v_mfma_f32_16x16x32_bf16 v[24:27], v[176:179], v[112:115], v[24:27]
    buffer_load_dwordx4 v[152:155], v2, s[8:11], s26 offen offset:1024
    v_mfma_f32_16x16x32_bf16 v[28:31], v[180:183], v[112:115], v[28:31]
    v_mfma_f32_16x16x32_bf16 v[32:35], v[184:187], v[112:115], v[32:35]
    buffer_load_dwordx4 v[112:115], v2, s[8:11], s25 offen sc1
    v_mfma_f32_16x16x32_bf16 v[36:39], v[168:171], v[116:119], v[36:39]
    v_mfma_f32_16x16x32_bf16 v[40:43], v[172:175], v[116:119], v[40:43]
    v_mfma_f32_16x16x32_bf16 v[44:47], v[176:179], v[116:119], v[44:47]
    buffer_load_dwordx4 v[156:159], v2, s[8:11], s26 offen offset:2048
    v_mfma_f32_16x16x32_bf16 v[48:51], v[180:183], v[116:119], v[48:51]
    v_mfma_f32_16x16x32_bf16 v[52:55], v[184:187], v[116:119], v[52:55]
    s_add_u32 s27, s25, 92160
    buffer_load_dwordx4 v[116:119], v2, s[8:11], s27 offen sc1
    v_mfma_f32_16x16x32_bf16 v[56:59], v[168:171], v[120:123], v[56:59]
    v_mfma_f32_16x16x32_bf16 v[60:63], v[172:175], v[120:123], v[60:63]
    v_mfma_f32_16x16x32_bf16 v[64:67], v[176:179], v[120:123], v[64:67]
    buffer_load_dwordx4 v[160:163], v2, s[8:11], s26 offen offset:3072
    v_mfma_f32_16x16x32_bf16 v[68:71], v[180:183], v[120:123], v[68:71]
    v_mfma_f32_16x16x32_bf16 v[72:75], v[184:187], v[120:123], v[72:75]
    s_add_u32 s27, s25, 184320
    buffer_load_dwordx4 v[120:123], v2, s[8:11], s27 offen sc1
    v_mfma_f32_16x16x32_bf16 v[76:79], v[168:171], v[124:127], v[76:79]
    v_mfma_f32_16x16x32_bf16 v[80:83], v[172:175], v[124:127], v[80:83]
    v_mfma_f32_16x16x32_bf16 v[84:87], v[176:179], v[124:127], v[84:87]
    buffer_load_dwordx4 v[164:167], v3, s[8:11], s26 offen
    s_add_u32 s26, s26, 4608
    v_mfma_f32_16x16x32_bf16 v[88:91], v[180:183], v[124:127], v[88:91]
    v_mfma_f32_16x16x32_bf16 v[92:95], v[184:187], v[124:127], v[92:95]
    s_add_u32 s27, s25, 276480
    buffer_load_dwordx4 v[124:127], v2, s[8:11], s27 offen sc1
    s_add_u32 s25, s25, 1024
    s_waitcnt vmcnt(18)
    v_mfma_f32_16x16x32_bf16 v[16:19], v[188:191], v[128:131], v[16:19]
    buffer_load_dwordx4 v[168:171], v2, s[8:11], s26 offen offset:0
    v_mfma_f32_16x16x32_bf16 v[20:23], v[192:195], v[128:131], v[20:23]
    v_mfma_f32_16x16x32_bf16 v[24:27], v[196:199], v[128:131], v[24:27]
    buffer_load_dwordx4 v[172:175], v2, s[8:11], s26 offen offset:1024
    v_mfma_f32_16x16x32_bf16 v[28:31], v[200:203], v[128:131], v[28:31]
    v_mfma_f32_16x16x32_bf16 v[32:35], v[204:207], v[128:131], v[32:35]
    buffer_load_dwordx4 v[128:131], v2, s[8:11], s25 offen sc1
    v_mfma_f32_16x16x32_bf16 v[36:39], v[188:191], v[132:135], v[36:39]
    v_mfma_f32_16x16x32_bf16 v[40:43], v[192:195], v[132:135], v[40:43]
    v_mfma_f32_16x16x32_bf16 v[44:47], v[196:199], v[132:135], v[44:47]
    buffer_load_dwordx4 v[176:179], v2, s[8:11], s26 offen offset:2048
    v_mfma_f32_16x16x32_bf16 v[48:51], v[200:203], v[132:135], v[48:51]
    v_mfma_f32_16x16x32_bf16 v[52:55], v[204:207], v[132:135], v[52:55]
    s_add_u32 s27, s25, 92160
    buffer_load_dwordx4 v[132:135], v2, s[8:11], s27 offen sc1
    v_mfma_f32_16x16x32_bf16 v[56:59], v[188:191], v[136:139], v[56:59]
    v_mfma_f32_16x16x32_bf16 v[60:63], v[192:195], v[136:139], v[60:63]
    v_mfma_f32_16x16x32_bf16 v[64:67], v[196:199], v[136:139], v[64:67]
    buffer_load_dwordx4 v[180:183], v2, s[8:11], s26 offen offset:3072
    v_mfma_f32_16x16x32_bf16 v[68:71], v[200:203], v[136:139], v[68:71]
    v_mfma_f32_16x16x32_bf16 v[72:75], v[204:207], v[136:139], v[72:75]
    s_add_u32 s27, s25, 184320
    buffer_load_dwordx4 v[136:139], v2, s[8:11], s27 offen sc1
    v_mfma_f32_16x16x32_bf16 v[76:79], v[188:191], v[140:143], v[76:79]
    v_mfma_f32_16x16x32_bf16 v[80:83], v[192:195], v[140:143], v[80:83]
    v_mfma_f32_16x16x32_bf16 v[84:87], v[196:199], v[140:143], v[84:87]
    buffer_load_dwordx4 v[184:187], v3, s[8:11], s26 offen
    s_add_u32 s26, s26, 4608
    v_mfma_f32_16x16x32_bf16 v[88:91], v[200:203], v[140:143], v[88:91]
    v_mfma_f32_16x16x32_bf16 v[92:95], v[204:207], v[140:143], v[92:95]
    s_add_u32 s27, s25, 276480
    buffer_load_dwordx4 v[140:143], v2, s[8:11], s27 offen sc1
    s_add_u32 s25, s25, 1024
    s_waitcnt vmcnt(18)
    v_mfma_f32_16x16x32_bf16 v[16:19], v[208:211], v[96:99], v[16:19]
    buffer_load_dwordx4 v[188:191], v2, s[8:11], s26 offen offset:0
    v_mfma_f32_16x16x32_bf16 v[20:23], v[212:215], v[96:99], v[20:23]
    v_mfma_f32_16x16x32_bf16 v[24:27], v[216:219], v[96:99], v[24:27]
    buffer_load_dwordx4 v[192:195], v2, s[8:11], s26 offen offset:1024
    v_mfma_f32_16x16x32_bf16 v[28:31], v[220:223], v[96:99], v[28:31]
    v_mfma_f32_16x16x32_bf16 v[32:35], v[224:227], v[96:99], v[32:35]
    buffer_load_dwordx4 v[96:99], v2, s[8:11], s25 offen sc1
    v_mfma_f32_16x16x32_bf16 v[36:39], v[208:211], v[100:103], v[36:39]
    v_mfma_f32_16x16x32_bf16 v[40:43], v[212:215], v[100:103], v[40:43]
    v_mfma_f32_16x16x32_bf16 v[44:47], v[216:219], v[100:103], v[44:47]
    buffer_load_dwordx4 v[196:199], v2, s[8:11], s26 offen offset:2048
    v_mfma_f32_16x16x32_bf16 v[48:51], v[220:223], v[100:103], v[48:51]
    v_mfma_f32_16x16x32_bf16 v[52:55], v[224:227], v[100:103], v[52:55]
    s_add_u32 s27, s25, 92160
    buffer_load_dwordx4 v[100:103], v2, s[8:11], s27 offen sc1
    v_mfma_f32_16x16x32_bf16 v[56:59], v[208:211], v[104:107], v[56:59]
    v_mfma_f32_16x16x32_bf16 v[60:63], v[212:215], v[104:107], v[60:63]
    v_mfma_f32_16x16x32_bf16 v[64:67], v[216:219], v[104:107], v[64:67]
    buffer_load_dwordx4 v[200:203], v2, s[8:11], s26 offen offset:3072
    v_mfma_f32_16x16x32_bf16 v[68:71], v[220:223], v[104:107], v[68:71]
    v_mfma_f32_16x16x32_bf16 v[72:75], v[224:227], v[104:107], v[72:75]
    s_add_u32 s27, s25, 184320
    buffer_load_dwordx4 v[104:107], v2, s[8:11], s27 offen sc1
    v_mfma_f32_16x16x32_bf16 v[76:79], v[208:211], v[108:111], v[76:79]
    v_mfma_f32_16x16x32_bf16 v[80:83], v[212:215], v[108:111], v[80:83]
    v_mfma_f32_16x16x32_bf16 v[84:87], v[216:219], v[108:111], v[84:87]
    buffer_load_dwordx4 v[204:207], v3, s[8:11], s26 offen
    s_add_u32 s26, s26, 4608
    v_mfma_f32_16x16x32_bf16 v[88:91], v[220:223], v[108:111], v[88:91]
    v_mfma_f32_16x16x32_bf16 v[92:95], v[224:227], v[108:111], v[92:95]
    s_add_u32 s27, s25, 276480
    buffer_load_dwordx4 v[108:111], v2, s[8:11], s27 offen sc1
    s_add_u32 s25, s25, 1024
    s_waitcnt vmcnt(18)
    v_mfma_f32_16x16x32_bf16 v[16:19], v[228:231], v[112:115], v[16:19]
    buffer_load_dwordx4 v[208:211], v2, s[8:11], s26 offen offset:0
    v_mfma_f32_16x16x32_bf16 v[20:23], v[232:235], v[112:115], v[20:23]
    v_mfma_f32_16x16x32_bf16 v[24:27], v[236:239], v[112:115], v[24:27]
    buffer_load_dwordx4 v[212:215], v2, s[8:11], s26 offen offset:1024
    v_mfma_f32_16x16x32_bf16 v[28:31], v[240:243], v[112:115], v[28:31]
    v_mfma_f32_16x16x32_bf16 v[32:35], v[244:247], v[112:115], v[32:35]
    buffer_load_dwordx4 v[112:115], v2, s[8:11], s25 offen sc1
    v_mfma_f32_16x16x32_bf16 v[36:39], v[228:231], v[116:119], v[36:39]
    v_mfma_f32_16x16x32_bf16 v[40:43], v[232:235], v[116:119], v[40:43]
    v_mfma_f32_16x16x32_bf16 v[44:47], v[236:239], v[116:119], v[44:47]
    buffer_load_dwordx4 v[216:219], v2, s[8:11], s26 offen offset:2048
    v_mfma_f32_16x16x32_bf16 v[48:51], v[240:243], v[116:119], v[48:51]
    v_mfma_f32_16x16x32_bf16 v[52:55], v[244:247], v[116:119], v[52:55]
    s_add_u32 s27, s25, 92160
    buffer_load_dwordx4 v[116:119], v2, s[8:11], s27 offen sc1
    v_mfma_f32_16x16x32_bf16 v[56:59], v[228:231], v[120:123], v[56:59]
    v_mfma_f32_16x16x32_bf16 v[60:63], v[232:235], v[120:123], v[60:63]
    v_mfma_f32_16x16x32_bf16 v[64:67], v[236:239], v[120:123], v[64:67]
    buffer_load_dwordx4 v[220:223], v2, s[8:11], s26 offen offset:3072
    v_mfma_f32_16x16x32_bf16 v[68:71], v[240:243], v[120:123], v[68:71]
    v_mfma_f32_16x16x32_bf16 v[72:75], v[244:247], v[120:123], v[72:75]
    s_add_u32 s27, s25, 184320
    buffer_load_dwordx4 v[120:123], v2, s[8:11], s27 offen sc1
    v_mfma_f32_16x16x32_bf16 v[76:79], v[228:231], v[124:127], v[76:79]
    v_mfma_f32_16x16x32_bf16 v[80:83], v[232:235], v[124:127], v[80:83]
    v_mfma_f32_16x16x32_bf16 v[84:87], v[236:239], v[124:127], v[84:87]
    buffer_load_dwordx4 v[224:227], v3, s[8:11], s26 offen
    s_add_u32 s26, s26, 4608
    v_mfma_f32_16x16x32_bf16 v[88:91], v[240:243], v[124:127], v[88:91]
    v_mfma_f32_16x16x32_bf16 v[92:95], v[244:247], v[124:127], v[92:95]
    s_add_u32 s27, s25, 276480
    buffer_load_dwordx4 v[124:127], v2, s[8:11], s27 offen sc1
    s_add_u32 s25, s25, 1024
    s_waitcnt vmcnt(18)
    v_mfma_f32_16x16x32_bf16 v[16:19], v[148:151], v[128:131], v[16:19]
    v_mfma_f32_16x16x32_bf16 v[20:23], v[152:155], v[128:131], v[20:23]
    v_mfma_f32_16x16x32_bf16 v[24:27], v[156:159], v[128:131], v[24:27]
    v_mfma_f32_16x16x32_bf16 v[28:31], v[160:163], v[128:131], v[28:31]
    v_mfma_f32_16x16x32_bf16 v[32:35], v[164:167], v[128:131], v[32:35]
    buffer_load_dwordx4 v[128:131], v2, s[8:11], s25 offen sc1
    v_mfma_f32_16x16x32_bf16 v[36:39], v[148:151], v[132:135], v[36:39]
    v_mfma_f32_16x16x32_bf16 v[40:43], v[152:155], v[132:135], v[40:43]
    v_mfma_f32_16x16x32_bf16 v[44:47], v[156:159], v[132:135], v[44:47]
    v_mfma_f32_16x16x32_bf16 v[48:51], v[160:163], v[132:135], v[48:51]
    v_mfma_f32_16x16x32_bf16 v[52:55], v[164:167], v[132:135], v[52:55]
    s_add_u32 s27, s25, 92160
    buffer_load_dwordx4 v[132:135], v2, s[8:11], s27 offen sc1
    v_mfma_f32_16x16x32_bf16 v[56:59], v[148:151], v[136:139], v[56:59]
    v_mfma_f32_16x16x32_bf16 v[60:63], v[152:155], v[136:139], v[60:63]
    v_mfma_f32_16x16x32_bf16 v[64:67], v[156:159], v[136:139], v[64:67]
    v_mfma_f32_16x16x32_bf16 v[68:71], v[160:163], v[136:139], v[68:71]
    v_mfma_f32_16x16x32_bf16 v[72:75], v[164:167], v[136:139], v[72:75]
    s_add_u32 s27, s25, 184320
    buffer_load_dwordx4 v[136:139], v2, s[8:11], s27 offen sc1
    v_mfma_f32_16x16x32_bf16 v[76:79], v[148:151], v[140:143], v[76:79]
    v_mfma_f32_16x16x32_bf16 v[80:83], v[152:155], v[140:143], v[80:83]
    v_mfma_f32_16x16x32_bf16 v[84:87], v[156:159], v[140:143], v[84:87]
    v_mfma_f32_16x16x32_bf16 v[88:91], v[160:163], v[140:143], v[88:91]
    v_mfma_f32_16x16x32_bf16 v[92:95], v[164:167], v[140:143], v[92:95]
    s_add_u32 s27, s25, 276480
    buffer_load_dwordx4 v[140:143], v2, s[8:11], s27 offen sc1
    s_add_u32 s25, s25, 1024
    s_waitcnt vmcnt(13)
    v_mfma_f32_16x16x32_bf16 v[16:19], v[168:171], v[96:99], v[16:19]
    v_mfma_f32_16x16x32_bf16 v[20:23], v[172:175], v[96:99], v[20:23]
    v_mfma_f32_16x16x32_bf16 v[24:27], v[176:179], v[96:99], v[24:27]
    v_mfma_f32_16x16x32_bf16 v[28:31], v[180:183], v[96:99], v[28:31]
    v_mfma_f32_16x16x32_bf16 v[32:35], v[184:187], v[96:99], v[32:35]
    v_mfma_f32_16x16x32_bf16 v[36:39], v[168:171], v[100:103], v[36:39]
    v_mfma_f32_16x16x32_bf16 v[40:43], v[172:175], v[100:103], v[40:43]
    v_mfma_f32_16x16x32_bf16 v[44:47], v[176:179], v[100:103], v[44:47]
    v_mfma_f32_16x16x32_bf16 v[48:51], v[180:183], v[100:103], v[48:51]
    v_mfma_f32_16x16x32_bf16 v[52:55], v[184:187], v[100:103], v[52:55]
    v_mfma_f32_16x16x32_bf16 v[56:59], v[168:171], v[104:107], v[56:59]
    v_mfma_f32_16x16x32_bf16 v[60:63], v[172:175], v[104:107], v[60:63]
    v_mfma_f32_16x16x32_bf16 v[64:67], v[176:179], v[104:107], v[64:67]
    v_mfma_f32_16x16x32_bf16 v[68:71], v[180:183], v[104:107], v[68:71]
    v_mfma_f32_16x16x32_bf16 v[72:75], v[184:187], v[104:107], v[72:75]
    v_mfma_f32_16x16x32_bf16 v[76:79], v[168:171], v[108:111], v[76:79]
    v_mfma_f32_16x16x32_bf16 v[80:83], v[172:175], v[108:111], v[80:83]
    v_mfma_f32_16x16x32_bf16 v[84:87], v[176:179], v[108:111], v[84:87]
    v_mfma_f32_16x16x32_bf16 v[88:91], v[180:183], v[108:111], v[88:91]
    v_mfma_f32_16x16x32_bf16 v[92:95], v[184:187], v[108:111], v[92:95]
    s_waitcnt vmcnt(4)
    v_mfma_f32_16x16x32_bf16 v[16:19], v[188:191], v[112:115], v[16:19]
    v_mfma_f32_16x16x32_bf16 v[20:23], v[192:195], v[112:115], v[20:23]
    v_mfma_f32_16x16x32_bf16 v[24:27], v[196:199], v[112:115], v[24:27]
    v_mfma_f32_16x16x32_bf16 v[28:31], v[200:203], v[112:115], v[28:31]
    v_mfma_f32_16x16x32_bf16 v[32:35], v[204:207], v[112:115], v[32:35]
    v_mfma_f32_16x16x32_bf16 v[36:39], v[188:191], v[116:119], v[36:39]
    v_mfma_f32_16x16x32_bf16 v[40:43], v[192:195], v[116:119], v[40:43]
    v_mfma_f32_16x16x32_bf16 v[44:47], v[196:199], v[116:119], v[44:47]
    v_mfma_f32_16x16x32_bf16 v[48:51], v[200:203], v[116:119], v[48:51]
    v_mfma_f32_16x16x32_bf16 v[52:55], v[204:207], v[116:119], v[52:55]
    v_mfma_f32_16x16x32_bf16 v[56:59], v[188:191], v[120:123], v[56:59]
    v_mfma_f32_16x16x32_bf16 v[60:63], v[192:195], v[120:123], v[60:63]
    v_mfma_f32_16x16x32_bf16 v[64:67], v[196:199], v[120:123], v[64:67]
    v_mfma_f32_16x16x32_bf16 v[68:71], v[200:203], v[120:123], v[68:71]
    v_mfma_f32_16x16x32_bf16 v[72:75], v[204:207], v[120:123], v[72:75]
    v_mfma_f32_16x16x32_bf16 v[76:79], v[188:191], v[124:127], v[76:79]
    v_mfma_f32_16x16x32_bf16 v[80:83], v[192:195], v[124:127], v[80:83]
    v_mfma_f32_16x16x32_bf16 v[84:87], v[196:199], v[124:127], v[84:87]
    v_mfma_f32_16x16x32_bf16 v[88:91], v[200:203], v[124:127], v[88:91]
    v_mfma_f32_16x16x32_bf16 v[92:95], v[204:207], v[124:127], v[92:95]
    s_waitcnt vmcnt(0)
    v_mfma_f32_16x16x32_bf16 v[16:19], v[208:211], v[128:131], v[16:19]
    v_mfma_f32_16x16x32_bf16 v[20:23], v[212:215], v[128:131], v[20:23]
    v_mfma_f32_16x16x32_bf16 v[24:27], v[216:219], v[128:131], v[24:27]
    v_mfma_f32_16x16x32_bf16 v[28:31], v[220:223], v[128:131], v[28:31]
    v_mfma_f32_16x16x32_bf16 v[32:35], v[224:227], v[128:131], v[32:35]
    v_mfma_f32_16x16x32_bf16 v[36:39], v[208:211], v[132:135], v[36:39]
    v_mfma_f32_16x16x32_bf16 v[40:43], v[212:215], v[132:135], v[40:43]
    v_mfma_f32_16x16x32_bf16 v[44:47], v[216:219], v[132:135], v[44:47]
    v_mfma_f32_16x16x32_bf16 v[48:51], v[220:223], v[132:135], v[48:51]
    v_mfma_f32_16x16x32_bf16 v[52:55], v[224:227], v[132:135], v[52:55]
    v_mfma_f32_16x16x32_bf16 v[56:59], v[208:211], v[136:139], v[56:59]
    v_mfma_f32_16x16x32_bf16 v[60:63], v[212:215], v[136:139], v[60:63]
    v_mfma_f32_16x16x32_bf16 v[64:67], v[216:219], v[136:139], v[64:67]
    v_mfma_f32_16x16x32_bf16 v[68:71], v[220:223], v[136:139], v[68:71]
    v_mfma_f32_16x16x32_bf16 v[72:75], v[224:227], v[136:139], v[72:75]
    v_mfma_f32_16x16x32_bf16 v[76:79], v[208:211], v[140:143], v[76:79]
    v_mfma_f32_16x16x32_bf16 v[80:83], v[212:215], v[140:143], v[80:83]
    v_mfma_f32_16x16x32_bf16 v[84:87], v[216:219], v[140:143], v[84:87]
    v_mfma_f32_16x16x32_bf16 v[88:91], v[220:223], v[140:143], v[88:91]
    v_mfma_f32_16x16x32_bf16 v[92:95], v[224:227], v[140:143], v[92:95]
    s_setprio 2
    s_nop 7
    s_branch p3j_136
p3t_135:
    s_cmp_ge_u32 s22, 6
    s_cbranch_scc1 p3t_137
    buffer_load_dwordx4 v[96:99], v2, s[8:11], s25 offen sc1
    s_add_u32 s27, s25, 92160
    buffer_load_dwordx4 v[100:103], v2, s[8:11], s27 offen sc1
    s_add_u32 s27, s25, 184320
    buffer_load_dwordx4 v[104:107], v2, s[8:11], s27 offen sc1
    s_add_u32 s27, s25, 276480
    buffer_load_dwordx4 v[108:111], v2, s[8:11], s27 offen sc1
    s_add_u32 s25, s25, 1024
    buffer_load_dwordx4 v[112:115], v2, s[8:11], s25 offen sc1
    s_add_u32 s27, s25, 92160
    buffer_load_dwordx4 v[116:119], v2, s[8:11], s27 offen sc1
    s_add_u32 s27, s25, 184320
    buffer_load_dwordx4 v[120:123], v2, s[8:11], s27 offen sc1
    s_add_u32 s27, s25, 276480
    buffer_load_dwordx4 v[124:127], v2, s[8:11], s27 offen sc1
    s_add_u32 s25, s25, 1024
    buffer_load_dwordx4 v[128:131], v2, s[8:11], s25 offen sc1
    s_add_u32 s27, s25, 92160
    buffer_load_dwordx4 v[132:135], v2, s[8:11], s27 offen sc1
    s_add_u32 s27, s25, 184320
    buffer_load_dwordx4 v[136:139], v2, s[8:11], s27 offen sc1
    s_add_u32 s27, s25, 276480
    buffer_load_dwordx4 v[140:143], v2, s[8:11], s27 offen sc1
    s_add_u32 s25, s25, 1024
    s_waitcnt vmcnt(8)
    v_mfma_f32_16x16x32_bf16 v[16:19], v[184:187], v[96:99], v[16:19]
    v_mfma_f32_16x16x32_bf16 v[20:23], v[188:191], v[96:99], v[20:23]
    v_mfma_f32_16x16x32_bf16 v[24:27], v[192:195], v[96:99], v[24:27]
    v_mfma_f32_16x16x32_bf16 v[28:31], v[196:199], v[96:99], v[28:31]
    v_mfma_f32_16x16x32_bf16 v[32:35], v[200:203], v[96:99], v[32:35]
    buffer_load_dwordx4 v[96:99], v2, s[8:11], s25 offen sc1
    v_mfma_f32_16x16x32_bf16 v[36:39], v[184:187], v[100:103], v[36:39]
    v_mfma_f32_16x16x32_bf16 v[40:43], v[188:191], v[100:103], v[40:43]
    v_mfma_f32_16x16x32_bf16 v[44:47], v[192:195], v[100:103], v[44:47]
    v_mfma_f32_16x16x32_bf16 v[48:51], v[196:199], v[100:103], v[48:51]
    v_mfma_f32_16x16x32_bf16 v[52:55], v[200:203], v[100:103], v[52:55]
    s_add_u32 s27, s25, 92160
    buffer_load_dwordx4 v[100:103], v2, s[8:11], s27 offen sc1
    v_mfma_f32_16x16x32_bf16 v[56:59], v[184:187], v[104:107], v[56:59]
    v_mfma_f32_16x16x32_bf16 v[60:63], v[188:191], v[104:107], v[60:63]
    v_mfma_f32_16x16x32_bf16 v[64:67], v[192:195], v[104:107], v[64:67]
    v_mfma_f32_16x16x32_bf16 v[68:71], v[196:199], v[104:107], v[68:71]
    v_mfma_f32_16x16x32_bf16 v[72:75], v[200:203], v[104:107], v[72:75]
    s_add_u32 s27, s25, 184320
    buffer_load_dwordx4 v[104:107], v2, s[8:11], s27 offen sc1
    v_mfma_f32_16x16x32_bf16 v[76:79], v[184:187], v[108:111], v[76:79]
    v_mfma_f32_16x16x32_bf16 v[80:83], v[188:191], v[108:111], v[80:83]
    v_mfma_f32_16x16x32_bf16 v[84:87], v[192:195], v[108:111], v[84:87]
    v_mfma_f32_16x16x32_bf16 v[88:91], v[196:199], v[108:111], v[88:91]
    v_mfma_f32_16x16x32_bf16 v[92:95], v[200:203], v[108:111], v[92:95]
    s_add_u32 s27, s25, 276480
    buffer_load_dwordx4 v[108:111], v2, s[8:11], s27 offen sc1
    s_add_u32 s25, s25, 1024
    s_waitcnt vmcnt(8)
    v_mfma_f32_16x16x32_bf16 v[16:19], v[204:207], v[112:115], v[16:19]
    v_mfma_f32_16x16x32_bf16 v[20:23], v[208:211], v[112:115], v[20:23]
    v_mfma_f32_16x16x32_bf16 v[24:27], v[212:215], v[112:115], v[24:27]
    v_mfma_f32_16x16x32_bf16 v[28:31], v[216:219], v[112:115], v[28:31]
    v_mfma_f32_16x16x32_bf16 v[32:35], v[220:223], v[112:115], v[32:35]
    buffer_load_dwordx4 v[112:115], v2, s[8:11], s25 offen sc1
    v_mfma_f32_16x16x32_bf16 v[36:39], v[204:207], v[116:119], v[36:39]
    v_mfma_f32_16x16x32_bf16 v[40:43], v[208:211], v[116:119], v[40:43]
    v_mfma_f32_16x16x32_bf16 v[44:47], v[212:215], v[116:119], v[44:47]
    v_mfma_f32_16x16x32_bf16 v[48:51], v[216:219], v[116:119], v[48:51]
    v_mfma_f32_16x16x32_bf16 v[52:55], v[220:223], v[116:119], v[52:55]
    s_add_u32 s27, s25, 92160
    buffer_load_dwordx4 v[116:119], v2, s[8:11], s27 offen sc1
    v_mfma_f32_16x16x32_bf16 v[56:59], v[204:207], v[120:123], v[56:59]
    v_mfma_f32_16x16x32_bf16 v[60:63], v[208:211], v[120:123], v[60:63]
    v_mfma_f32_16x16x32_bf16 v[64:67], v[212:215], v[120:123], v[64:67]
    v_mfma_f32_16x16x32_bf16 v[68:71], v[216:219], v[120:123], v[68:71]
    v_mfma_f32_16x16x32_bf16 v[72:75], v[220:223], v[120:123], v[72:75]
    s_add_u32 s27, s25, 184320
    buffer_load_dwordx4 v[120:123], v2, s[8:11], s27 offen sc1
    v_mfma_f32_16x16x32_bf16 v[76:79], v[204:207], v[124:127], v[76:79]
    v_mfma_f32_16x16x32_bf16 v[80:83], v[208:211], v[124:127], v[80:83]
    v_mfma_f32_16x16x32_bf16 v[84:87], v[212:215], v[124:127], v[84:87]
    v_mfma_f32_16x16x32_bf16 v[88:91], v[216:219], v[124:127], v[88:91]
    v_mfma_f32_16x16x32_bf16 v[92:95], v[220:223], v[124:127], v[92:95]
    s_add_u32 s27, s25, 276480
    buffer_load_dwordx4 v[124:127], v2, s[8:11], s27 offen sc1
    s_add_u32 s25, s25, 1024
    s_waitcnt vmcnt(8)
    v_mfma_f32_16x16x32_bf16 v[16:19], v[224:227], v[128:131], v[16:19]
    v_mfma_f32_16x16x32_bf16 v[20:23], v[228:231], v[128:131], v[20:23]
    v_mfma_f32_16x16x32_bf16 v[24:27], v[232:235], v[128:131], v[24:27]
    v_mfma_f32_16x16x32_bf16 v[28:31], v[236:239], v[128:131], v[28:31]
    v_mfma_f32_16x16x32_bf16 v[32:35], v[240:243], v[128:131], v[32:35]
    v_mfma_f32_16x16x32_bf16 v[36:39], v[224:227], v[132:135], v[36:39]
    v_mfma_f32_16x16x32_bf16 v[40:43], v[228:231], v[132:135], v[40:43]
    v_mfma_f32_16x16x32_bf16 v[44:47], v[232:235], v[132:135], v[44:47]
    v_mfma_f32_16x16x32_bf16 v[48:51], v[236:239], v[132:135], v[48:51]
    v_mfma_f32_16x16x32_bf16 v[52:55], v[240:243], v[132:135], v[52:55]
    v_mfma_f32_16x16x32_bf16 v[56:59], v[224:227], v[136:139], v[56:59]
    v_mfma_f32_16x16x32_bf16 v[60:63], v[228:231], v[136:139], v[60:63]
    v_mfma_f32_16x16x32_bf16 v[64:67], v[232:235], v[136:139], v[64:67]
    v_mfma_f32_16x16x32_bf16 v[68:71], v[236:239], v[136:139], v[68:71]
    v_mfma_f32_16x16x32_bf16 v[72:75], v[240:243], v[136:139], v[72:75]
    v_mfma_f32_16x16x32_bf16 v[76:79], v[224:227], v[140:143], v[76:79]
    v_mfma_f32_16x16x32_bf16 v[80:83], v[228:231], v[140:143], v[80:83]
    v_mfma_f32_16x16x32_bf16 v[84:87], v[232:235], v[140:143], v[84:87]
    v_mfma_f32_16x16x32_bf16 v[88:91], v[236:239], v[140:143], v[88:91]
    v_mfma_f32_16x16x32_bf16 v[92:95], v[240:243], v[140:143], v[92:95]
    s_waitcnt vmcnt(4)
    v_mfma_f32_16x16x32_bf16 v[16:19], v[144:147], v[96:99], v[16:19]
    v_mfma_f32_16x16x32_bf16 v[20:23], v[148:151], v[96:99], v[20:23]
    v_mfma_f32_16x16x32_bf16 v[24:27], v[152:155], v[96:99], v[24:27]
    v_mfma_f32_16x16x32_bf16 v[28:31], v[156:159], v[96:99], v[28:31]
    v_mfma_f32_16x16x32_bf16 v[32:35], v[160:163], v[96:99], v[32:35]
    v_mfma_f32_16x16x32_bf16 v[36:39], v[144:147], v[100:103], v[36:39]
    v_mfma_f32_16x16x32_bf16 v[40:43], v[148:151], v[100:103], v[40:43]
    v_mfma_f32_16x16x32_bf16 v[44:47], v[152:155], v[100:103], v[44:47]
    v_mfma_f32_16x16x32_bf16 v[48:51], v[156:159], v[100:103], v[48:51]
    v_mfma_f32_16x16x32_bf16 v[52:55], v[160:163], v[100:103], v[52:55]
    v_mfma_f32_16x16x32_bf16 v[56:59], v[144:147], v[104:107], v[56:59]
    v_mfma_f32_16x16x32_bf16 v[60:63], v[148:151], v[104:107], v[60:63]
    v_mfma_f32_16x16x32_bf16 v[64:67], v[152:155], v[104:107], v[64:67]
    v_mfma_f32_16x16x32_bf16 v[68:71], v[156:159], v[104:107], v[68:71]
    v_mfma_f32_16x16x32_bf16 v[72:75], v[160:163], v[104:107], v[72:75]
    v_mfma_f32_16x16x32_bf16 v[76:79], v[144:147], v[108:111], v[76:79]
    v_mfma_f32_16x16x32_bf16 v[80:83], v[148:151], v[108:111], v[80:83]
    v_mfma_f32_16x16x32_bf16 v[84:87], v[152:155], v[108:111], v[84:87]
    v_mfma_f32_16x16x32_bf16 v[88:91], v[156:159], v[108:111], v[88:91]
    v_mfma_f32_16x16x32_bf16 v[92:95], v[160:163], v[108:111], v[92:95]
    s_waitcnt vmcnt(0)
    v_mfma_f32_16x16x32_bf16 v[16:19], v[164:167], v[112:115], v[16:19]
    v_mfma_f32_16x16x32_bf16 v[20:23], v[168:171], v[112:115], v[20:23]
    v_mfma_f32_16x16x32_bf16 v[24:27], v[172:175], v[112:115], v[24:27]
    v_mfma_f32_16x16x32_bf16 v[28:31], v[176:179], v[112:115], v[28:31]
    v_mfma_f32_16x16x32_bf16 v[32:35], v[180:183], v[112:115], v[32:35]
    v_mfma_f32_16x16x32_bf16 v[36:39], v[164:167], v[116:119], v[36:39]
    v_mfma_f32_16x16x32_bf16 v[40:43], v[168:171], v[116:119], v[40:43]
    v_mfma_f32_16x16x32_bf16 v[44:47], v[172:175], v[116:119], v[44:47]
    v_mfma_f32_16x16x32_bf16 v[48:51], v[176:179], v[116:119], v[48:51]
    v_mfma_f32_16x16x32_bf16 v[52:55], v[180:183], v[116:119], v[52:55]
    v_mfma_f32_16x16x32_bf16 v[56:59], v[164:167], v[120:123], v[56:59]
    v_mfma_f32_16x16x32_bf16 v[60:63], v[168:171], v[120:123], v[60:63]
    v_mfma_f32_16x16x32_bf16 v[64:67], v[172:175], v[120:123], v[64:67]
    v_mfma_f32_16x16x32_bf16 v[68:71], v[176:179], v[120:123], v[68:71]
    v_mfma_f32_16x16x32_bf16 v[72:75], v[180:183], v[120:123], v[72:75]
    v_mfma_f32_16x16x32_bf16 v[76:79], v[164:167], v[124:127], v[76:79]
    v_mfma_f32_16x16x32_bf16 v[80:83], v[168:171], v[124:127], v[80:83]
    v_mfma_f32_16x16x32_bf16 v[84:87], v[172:175], v[124:127], v[84:87]
    v_mfma_f32_16x16x32_bf16 v[88:91], v[176:179], v[124:127], v[88:91]
    v_mfma_f32_16x16x32_bf16 v[92:95], v[180:183], v[124:127], v[92:95]
    s_nop 7
    s_branch p3j_136
p3t_137:
    buffer_load_dwordx4 v[96:99], v2, s[8:11], s25 offen sc1
    s_add_u32 s27, s25, 92160
    buffer_load_dwordx4 v[100:103], v2, s[8:11], s27 offen sc1
    s_add_u32 s27, s25, 184320
    buffer_load_dwordx4 v[104:107], v2, s[8:11], s27 offen sc1
    s_add_u32 s27, s25, 276480
    buffer_load_dwordx4 v[108:111], v2, s[8:11], s27 offen sc1
    s_add_u32 s25, s25, 1024
    buffer_load_dwordx4 v[112:115], v2, s[8:11], s25 offen sc1
    s_add_u32 s27, s25, 92160
    buffer_load_dwordx4 v[116:119], v2, s[8:11], s27 offen sc1
    s_add_u32 s27, s25, 184320
    buffer_load_dwordx4 v[120:123], v2, s[8:11], s27 offen sc1
    s_add_u32 s27, s25, 276480
    buffer_load_dwordx4 v[124:127], v2, s[8:11], s27 offen sc1
    s_add_u32 s25, s25, 1024
    buffer_load_dwordx4 v[128:131], v2, s[8:11], s25 offen sc1
    s_add_u32 s27, s25, 92160
    buffer_load_dwordx4 v[132:135], v2, s[8:11], s27 offen sc1
    s_add_u32 s27, s25, 184320
    buffer_load_dwordx4 v[136:139], v2, s[8:11], s27 offen sc1
    s_add_u32 s27, s25, 276480
    buffer_load_dwordx4 v[140:143], v2, s[8:11], s27 offen sc1
    s_add_u32 s25, s25, 1024
    s_waitcnt vmcnt(8)
    v_mfma_f32_16x16x32_bf16 v[16:19], v[184:187], v[96:99], v[16:19]
    v_mfma_f32_16x16x32_bf16 v[20:23], v[188:191], v[96:99], v[20:23]
    v_mfma_f32_16x16x32_bf16 v[24:27], v[192:195], v[96:99], v[24:27]
    v_mfma_f32_16x16x32_bf16 v[28:31], v[196:199], v[96:99], v[28:31]
    v_mfma_f32_16x16x32_bf16 v[32:35], v[200:203], v[96:99], v[32:35]
    buffer_load_dwordx4 v[96:99], v2, s[8:11], s25 offen sc1
    v_mfma_f32_16x16x32_bf16 v[36:39], v[184:187], v[100:103], v[36:39]
    v_mfma_f32_16x16x32_bf16 v[40:43], v[188:191], v[100:103], v[40:43]
    v_mfma_f32_16x16x32_bf16 v[44:47], v[192:195], v[100:103], v[44:47]
    v_mfma_f32_16x16x32_bf16 v[48:51], v[196:199], v[100:103], v[48:51]
    v_mfma_f32_16x16x32_bf16 v[52:55], v[200:203], v[100:103], v[52:55]
    s_add_u32 s27, s25, 92160
    buffer_load_dwordx4 v[100:103], v2, s[8:11], s27 offen sc1
    v_mfma_f32_16x16x32_bf16 v[56:59], v[184:187], v[104:107], v[56:59]
    v_mfma_f32_16x16x32_bf16 v[60:63], v[188:191], v[104:107], v[60:63]
    v_mfma_f32_16x16x32_bf16 v[64:67], v[192:195], v[104:107], v[64:67]
    v_mfma_f32_16x16x32_bf16 v[68:71], v[196:199], v[104:107], v[68:71]
    v_mfma_f32_16x16x32_bf16 v[72:75], v[200:203], v[104:107], v[72:75]
    s_add_u32 s27, s25, 184320
    buffer_load_dwordx4 v[104:107], v2, s[8:11], s27 offen sc1
    v_mfma_f32_16x16x32_bf16 v[76:79], v[184:187], v[108:111], v[76:79]
    v_mfma_f32_16x16x32_bf16 v[80:83], v[188:191], v[108:111], v[80:83]
    v_mfma_f32_16x16x32_bf16 v[84:87], v[192:195], v[108:111], v[84:87]
    v_mfma_f32_16x16x32_bf16 v[88:91], v[196:199], v[108:111], v[88:91]
    v_mfma_f32_16x16x32_bf16 v[92:95], v[200:203], v[108:111], v[92:95]
    s_add_u32 s27, s25, 276480
    buffer_load_dwordx4 v[108:111], v2, s[8:11], s27 offen sc1
    s_add_u32 s25, s25, 1024
    s_waitcnt vmcnt(8)
    v_mfma_f32_16x16x32_bf16 v[16:19], v[204:207], v[112:115], v[16:19]
    v_mfma_f32_16x16x32_bf16 v[20:23], v[208:211], v[112:115], v[20:23]
    v_mfma_f32_16x16x32_bf16 v[24:27], v[212:215], v[112:115], v[24:27]
    v_mfma_f32_16x16x32_bf16 v[28:31], v[216:219], v[112:115], v[28:31]
    v_mfma_f32_16x16x32_bf16 v[32:35], v[220:223], v[112:115], v[32:35]
    v_mfma_f32_16x16x32_bf16 v[36:39], v[204:207], v[116:119], v[36:39]
    v_mfma_f32_16x16x32_bf16 v[40:43], v[208:211], v[116:119], v[40:43]
    v_mfma_f32_16x16x32_bf16 v[44:47], v[212:215], v[116:119], v[44:47]
    v_mfma_f32_16x16x32_bf16 v[48:51], v[216:219], v[116:119], v[48:51]
    v_mfma_f32_16x16x32_bf16 v[52:55], v[220:223], v[116:119], v[52:55]
    v_mfma_f32_16x16x32_bf16 v[56:59], v[204:207], v[120:123], v[56:59]
    v_mfma_f32_16x16x32_bf16 v[60:63], v[208:211], v[120:123], v[60:63]
    v_mfma_f32_16x16x32_bf16 v[64:67], v[212:215], v[120:123], v[64:67]
    v_mfma_f32_16x16x32_bf16 v[68:71], v[216:219], v[120:123], v[68:71]
    v_mfma_f32_16x16x32_bf16 v[72:75], v[220:223], v[120:123], v[72:75]
    v_mfma_f32_16x16x32_bf16 v[76:79], v[204:207], v[124:127], v[76:79]
    v_mfma_f32_16x16x32_bf16 v[80:83], v[208:211], v[124:127], v[80:83]
    v_mfma_f32_16x16x32_bf16 v[84:87], v[212:215], v[124:127], v[84:87]
    v_mfma_f32_16x16x32_bf16 v[88:91], v[216:219], v[124:127], v[88:91]
    v_mfma_f32_16x16x32_bf16 v[92:95], v[220:223], v[124:127], v[92:95]
    s_waitcnt vmcnt(4)
    v_mfma_f32_16x16x32_bf16 v[16:19], v[224:227], v[128:131], v[16:19]
    v_mfma_f32_16x16x32_bf16 v[20:23], v[228:231], v[128:131], v[20:23]
    v_mfma_f32_16x16x32_bf16 v[24:27], v[232:235], v[128:131], v[24:27]
    v_mfma_f32_16x16x32_bf16 v[28:31], v[236:239], v[128:131], v[28:31]
    v_mfma_f32_16x16x32_bf16 v[32:35], v[240:243], v[128:131], v[32:35]
    v_mfma_f32_16x16x32_bf16 v[36:39], v[224:227], v[132:135], v[36:39]
    v_mfma_f32_16x16x32_bf16 v[40:43], v[228:231], v[132:135], v[40:43]
    v_mfma_f32_16x16x32_bf16 v[44:47], v[232:235], v[132:135], v[44:47]
    v_mfma_f32_16x16x32_bf16 v[48:51], v[236:239], v[132:135], v[48:51]
    v_mfma_f32_16x16x32_bf16 v[52:55], v[240:243], v[132:135], v[52:55]
    v_mfma_f32_16x16x32_bf16 v[56:59], v[224:227], v[136:139], v[56:59]
    v_mfma_f32_16x16x32_bf16 v[60:63], v[228:231], v[136:139], v[60:63]
    v_mfma_f32_16x16x32_bf16 v[64:67], v[232:235], v[136:139], v[64:67]
    v_mfma_f32_16x16x32_bf16 v[68:71], v[236:239], v[136:139], v[68:71]
    v_mfma_f32_16x16x32_bf16 v[72:75], v[240:243], v[136:139], v[72:75]
    v_mfma_f32_16x16x32_bf16 v[76:79], v[224:227], v[140:143], v[76:79]
    v_mfma_f32_16x16x32_bf16 v[80:83], v[228:231], v[140:143], v[80:83]
    v_mfma_f32_16x16x32_bf16 v[84:87], v[232:235], v[140:143], v[84:87]
    v_mfma_f32_16x16x32_bf16 v[88:91], v[236:239], v[140:143], v[88:91]
    v_mfma_f32_16x16x32_bf16 v[92:95], v[240:243], v[140:143], v[92:95]
    s_waitcnt vmcnt(0)
    v_mfma_f32_16x16x32_bf16 v[16:19], v[144:147], v[96:99], v[16:19]
    v_mfma_f32_16x16x32_bf16 v[20:23], v[148:151], v[96:99], v[20:23]
    v_mfma_f32_16x16x32_bf16 v[24:27], v[152:155], v[96:99], v[24:27]
    v_mfma_f32_16x16x32_bf16 v[28:31], v[156:159], v[96:99], v[28:31]
    v_mfma_f32_16x16x32_bf16 v[32:35], v[160:163], v[96:99], v[32:35]
    v_mfma_f32_16x16x32_bf16 v[36:39], v[144:147], v[100:103], v[36:39]
    v_mfma_f32_16x16x32_bf16 v[40:43], v[148:151], v[100:103], v[40:43]
    v_mfma_f32_16x16x32_bf16 v[44:47], v[152:155], v[100:103], v[44:47]
    v_mfma_f32_16x16x32_bf16 v[48:51], v[156:159], v[100:103], v[48:51]
    v_mfma_f32_16x16x32_bf16 v[52:55], v[160:163], v[100:103], v[52:55]
    v_mfma_f32_16x16x32_bf16 v[56:59], v[144:147], v[104:107], v[56:59]
    v_mfma_f32_16x16x32_bf16 v[60:63], v[148:151], v[104:107], v[60:63]
    v_mfma_f32_16x16x32_bf16 v[64:67], v[152:155], v[104:107], v[64:67]
    v_mfma_f32_16x16x32_bf16 v[68:71], v[156:159], v[104:107], v[68:71]
    v_mfma_f32_16x16x32_bf16 v[72:75], v[160:163], v[104:107], v[72:75]
    v_mfma_f32_16x16x32_bf16 v[76:79], v[144:147], v[108:111], v[76:79]
    v_mfma_f32_16x16x32_bf16 v[80:83], v[148:151], v[108:111], v[80:83]
    v_mfma_f32_16x16x32_bf16 v[84:87], v[152:155], v[108:111], v[84:87]
    v_mfma_f32_16x16x32_bf16 v[88:91], v[156:159], v[108:111], v[88:91]
    v_mfma_f32_16x16x32_bf16 v[92:95], v[160:163], v[108:111], v[92:95]
    s_nop 7
p3j_136:
    v_mov_b32 v96, 163328
    s_cmp_ge_u32 s22, 4
    s_cselect_b32 s28, 4, 0
p3w_138:
    ds_read_b64 v[12:13], v96
    s_waitcnt lgkmcnt(0)
    v_readfirstlane_b32 s27, v12
    v_readfirstlane_b32 s29, v13
    s_sub_u32 s31, s31, 1
    s_cmp_lt_i32 s31, 0
    s_cbranch_scc1 p3wd_139
    s_cmp_lt_u32 s27, s28
    s_cbranch_scc1 p3w_138
    s_cmp_lt_u32 s29, 4
    s_cbranch_scc1 p3w_138
p3wd_139:
    ds_write_b128 v4, v[16:19] offset:0
    ds_write_b128 v4, v[20:23] offset:1088
    ds_write_b128 v4, v[24:27] offset:2176
    ds_write_b128 v4, v[28:31] offset:3264
    ds_write_b128 v4, v[36:39] offset:4896
    ds_write_b128 v4, v[40:43] offset:5984
    ds_write_b128 v4, v[44:47] offset:7072
    ds_write_b128 v4, v[48:51] offset:8160
    ds_write_b128 v4, v[56:59] offset:9792
    ds_write_b128 v4, v[60:63] offset:10880
    ds_write_b128 v4, v[64:67] offset:11968
    ds_write_b128 v4, v[68:71] offset:13056
    ds_write_b128 v4, v[76:79] offset:14688
    ds_write_b128 v4, v[80:83] offset:15776
    ds_write_b128 v4, v[84:87] offset:16864
    ds_write_b128 v4, v[88:91] offset:17952
    s_mov_b64 exec, 0xffffffff
    ds_write_b128 v4, v[32:35] offset:4352
    ds_write_b128 v4, v[52:55] offset:9248
    ds_write_b128 v4, v[72:75] offset:14144
    ds_write_b128 v4, v[92:95] offset:19040
    s_mov_b64 exec, -1
    v_add_u32 v244, 58752, v8
    v_add_u32 v245, 117504, v8
    v_add_u32 v246, 58752, v9
    v_add_u32 v247, 117504, v9
    v_add_u32 v248, 58752, v10
    v_add_u32 v249, 117504, v10
    v_lshlrev_b32 v200, 16, v250
    v_and_b32 v201, 0xffff0000, v250
    v_lshlrev_b32 v202, 16, v251
    v_and_b32 v203, 0xffff0000, v251
    v_lshlrev_b32 v204, 16, v252
    v_and_b32 v205, 0xffff0000, v252
    v_lshlrev_b32 v206, 16, v253
    v_and_b32 v207, 0xffff0000, v253
    v_lshlrev_b32 v208, 16, v254
    v_and_b32 v209, 0xffff0000, v254
    v_lshlrev_b32 v210, 16, v255
    v_and_b32 v211, 0xffff0000, v255
    s_waitcnt lgkmcnt(0)
    s_barrier
    s_cmp_ge_u32 s22, 2
    s_cbranch_scc1 p3f_140
    ds_read_b128 v[96:99], v8 offset:39168
    ds_read_b128 v[100:103], v9 offset:39168
    ds_read_b128 v[104:107], v10 offset:39168
    ds_read_b128 v[108:111], v244 offset:0
    ds_read_b128 v[112:115], v246 offset:0
    ds_read_b128 v[116:119], v248 offset:0
    ds_read_b128 v[120:123], v244 offset:19584
    ds_read_b128 v[124:127], v246 offset:19584
    ds_read_b128 v[128:131], v248 offset:19584
    ds_read_b128 v[132:135], v244 offset:39168
    ds_read_b128 v[136:139], v246 offset:39168
    ds_read_b128 v[140:143], v248 offset:39168
    s_waitcnt lgkmcnt(3)
    ds_read_b128 v[144:147], v8 offset:0
    ds_read_b128 v[148:151], v9 offset:0
    ds_read_b128 v[152:155], v10 offset:0
    ds_read_b128 v[156:159], v8 offset:19584
    ds_read_b128 v[160:163], v9 offset:19584
    ds_read_b128 v[164:167], v10 offset:19584
    ds_read_b128 v[168:171], v245 offset:0
    ds_read_b128 v[172:175], v247 offset:0
    ds_read_b128 v[176:179], v249 offset:0
    ds_read_b128 v[180:183], v245 offset:19584
    ds_read_b128 v[184:187], v247 offset:19584
    ds_read_b128 v[188:191], v249 offset:19584
    s_waitcnt lgkmcnt(12)
    v_add_f32 v96, v96, v108
    v_add_f32 v120, v120, v132
    v_add_f32 v97, v97, v109
    v_add_f32 v121, v121, v133
    v_add_f32 v98, v98, v110
    v_add_f32 v122, v122, v134
    v_add_f32 v99, v99, v111
    v_add_f32 v123, v123, v135
    v_add_f32 v100, v100, v112
    v_add_f32 v124, v124, v136
    v_add_f32 v101, v101, v113
    v_add_f32 v125, v125, v137
    v_add_f32 v102, v102, v114
    v_add_f32 v126, v126, v138
    v_add_f32 v103, v103, v115
    v_add_f32 v127, v127, v139
    v_add_f32 v104, v104, v116
    v_add_f32 v128, v128, v140
    v_add_f32 v105, v105, v117
    v_add_f32 v129, v129, v141
    v_add_f32 v106, v106, v118
    v_add_f32 v130, v130, v142
    v_add_f32 v107, v107, v119
    v_add_f32 v131, v131, v143
    v_add_f32 v96, v96, v120
    v_add_f32 v97, v97, v121
    v_add_f32 v98, v98, v122
    v_add_f32 v99, v99, v123
    v_add_f32 v100, v100, v124
    v_add_f32 v101, v101, v125
    v_add_f32 v102, v102, v126
    v_add_f32 v103, v103, v127
    v_add_f32 v104, v104, v128
    v_add_f32 v105, v105, v129
    v_add_f32 v106, v106, v130
    v_add_f32 v107, v107, v131
    v_mul_f32 v16, 0xbfb8aa3b, v96
    v_mul_f32 v17, 0xbfb8aa3b, v97
    v_mul_f32 v18, 0xbfb8aa3b, v98
    v_mul_f32 v19, 0xbfb8aa3b, v99
    v_mul_f32 v20, 0xbfb8aa3b, v100
    v_mul_f32 v21, 0xbfb8aa3b, v101
    v_mul_f32 v22, 0xbfb8aa3b, v102
    v_mul_f32 v23, 0xbfb8aa3b, v103
    v_mul_f32 v24, 0xbfb8aa3b, v104
    v_mul_f32 v25, 0xbfb8aa3b, v105
    v_mul_f32 v26, 0xbfb8aa3b, v106
    v_mul_f32 v27, 0xbfb8aa3b, v107
    v_exp_f32 v16, v16
    v_exp_f32 v17, v17
    v_exp_f32 v18, v18
    v_exp_f32 v19, v19
    v_exp_f32 v20, v20
    v_exp_f32 v21, v21
    v_exp_f32 v22, v22
    v_exp_f32 v23, v23
    v_exp_f32 v24, v24
    v_exp_f32 v25, v25
    v_exp_f32 v26, v26
    v_exp_f32 v27, v27
    s_waitcnt lgkmcnt(0)
    v_add_f32 v144, v144, v156
    v_add_f32 v168, v168, v180
    v_add_f32 v145, v145, v157
    v_add_f32 v169, v169, v181
    v_add_f32 v146, v146, v158
    v_add_f32 v170, v170, v182
    v_add_f32 v147, v147, v159
    v_add_f32 v171, v171, v183
    v_add_f32 v148, v148, v160
    v_add_f32 v172, v172, v184
    v_add_f32 v149, v149, v161
    v_add_f32 v173, v173, v185
    v_add_f32 v150, v150, v162
    v_add_f32 v174, v174, v186
    v_add_f32 v151, v151, v163
    v_add_f32 v175, v175, v187
    v_add_f32 v152, v152, v164
    v_add_f32 v176, v176, v188
    v_add_f32 v153, v153, v165
    v_add_f32 v177, v177, v189
    v_add_f32 v154, v154, v166
    v_add_f32 v178, v178, v190
    v_add_f32 v155, v155, v167
    v_add_f32 v179, v179, v191
    v_add_f32 v16, 1.0, v16
    v_add_f32 v17, 1.0, v17
    v_add_f32 v18, 1.0, v18
    v_add_f32 v19, 1.0, v19
    v_add_f32 v20, 1.0, v20
    v_add_f32 v21, 1.0, v21
    v_add_f32 v22, 1.0, v22
    v_add_f32 v23, 1.0, v23
    v_add_f32 v24, 1.0, v24
    v_add_f32 v25, 1.0, v25
    v_add_f32 v26, 1.0, v26
    v_add_f32 v27, 1.0, v27
    v_rcp_f32 v16, v16
    v_rcp_f32 v17, v17
    v_rcp_f32 v18, v18
    v_rcp_f32 v19, v19
    v_rcp_f32 v20, v20
    v_rcp_f32 v21, v21
    v_rcp_f32 v22, v22
    v_rcp_f32 v23, v23
    v_rcp_f32 v24, v24
    v_rcp_f32 v25, v25
    v_rcp_f32 v26, v26
    v_rcp_f32 v27, v27
    v_add_f32 v144, v144, v168
    v_add_f32 v145, v145, v169
    v_add_f32 v146, v146, v170
    v_add_f32 v147, v147, v171
    v_add_f32 v148, v148, v172
    v_add_f32 v149, v149, v173
    v_add_f32 v150, v150, v174
    v_add_f32 v151, v151, v175
    v_add_f32 v152, v152, v176
    v_add_f32 v153, v153, v177
    v_add_f32 v154, v154, v178
    v_add_f32 v155, v155, v179
    v_mul_f32 v96, v96, v16
    v_mul_f32 v97, v97, v17
    v_mul_f32 v98, v98, v18
    v_mul_f32 v99, v99, v19
    v_mul_f32 v100, v100, v20
    v_mul_f32 v101, v101, v21
    v_mul_f32 v102, v102, v22
    v_mul_f32 v103, v103, v23
    v_mul_f32 v104, v104, v24
    v_mul_f32 v105, v105, v25
    v_mul_f32 v106, v106, v26
    v_mul_f32 v107, v107, v27
    v_fma_f32 v96, v96, v144, v200
    v_fma_f32 v97, v97, v145, v201
    v_fma_f32 v98, v98, v146, v202
    v_fma_f32 v99, v99, v147, v203
    v_fma_f32 v100, v100, v148, v204
    v_fma_f32 v101, v101, v149, v205
    v_fma_f32 v102, v102, v150, v206
    v_fma_f32 v103, v103, v151, v207
    v_fma_f32 v104, v104, v152, v208
    v_fma_f32 v105, v105, v153, v209
    v_fma_f32 v106, v106, v154, v210
    v_fma_f32 v107, v107, v155, v211
    v_cvt_pk_bf16_f32 v32, v96, v97
    v_cvt_pk_bf16_f32 v33, v98, v99
    v_cvt_pk_bf16_f32 v34, v100, v101
    v_cvt_pk_bf16_f32 v35, v102, v103
    v_cvt_pk_bf16_f32 v36, v104, v105
    v_cvt_pk_bf16_f32 v37, v106, v107
    buffer_store_dwordx2 v[32:33], v5, s[16:19], s30 offen
    buffer_store_dwordx2 v[34:35], v6, s[16:19], s30 offen
    buffer_store_dwordx2 v[36:37], v7, s[16:19], s30 offen
    s_branch p3z_141
p3f_140:
    ds_read_b128 v[96:99], v8 offset:39168
    ds_read_b128 v[100:103], v9 offset:39168
    ds_read_b128 v[104:107], v244 offset:0
    ds_read_b128 v[108:111], v246 offset:0
    ds_read_b128 v[112:115], v244 offset:19584
    ds_read_b128 v[116:119], v246 offset:19584
    ds_read_b128 v[120:123], v244 offset:39168
    ds_read_b128 v[124:127], v246 offset:39168
    ds_read_b128 v[128:131], v8 offset:0
    ds_read_b128 v[132:135], v9 offset:0
    ds_read_b128 v[136:139], v8 offset:19584
    ds_read_b128 v[140:143], v9 offset:19584
    ds_read_b128 v[144:147], v245 offset:0
    ds_read_b128 v[148:151], v247 offset:0
    ds_read_b128 v[152:155], v245 offset:19584
    ds_read_b128 v[156:159], v247 offset:19584
    s_waitcnt lgkmcnt(8)
    v_add_f32 v96, v96, v104
    v_add_f32 v112, v112, v120
    v_add_f32 v97, v97, v105
    v_add_f32 v113, v113, v121
    v_add_f32 v98, v98, v106
    v_add_f32 v114, v114, v122
    v_add_f32 v99, v99, v107
    v_add_f32 v115, v115, v123
    v_add_f32 v100, v100, v108
    v_add_f32 v116, v116, v124
    v_add_f32 v101, v101, v109
    v_add_f32 v117, v117, v125
    v_add_f32 v102, v102, v110
    v_add_f32 v118, v118, v126
    v_add_f32 v103, v103, v111
    v_add_f32 v119, v119, v127
    v_add_f32 v96, v96, v112
    v_add_f32 v97, v97, v113
    v_add_f32 v98, v98, v114
    v_add_f32 v99, v99, v115
    v_add_f32 v100, v100, v116
    v_add_f32 v101, v101, v117
    v_add_f32 v102, v102, v118
    v_add_f32 v103, v103, v119
    v_mul_f32 v16, 0xbfb8aa3b, v96
    v_mul_f32 v17, 0xbfb8aa3b, v97
    v_mul_f32 v18, 0xbfb8aa3b, v98
    v_mul_f32 v19, 0xbfb8aa3b, v99
    v_mul_f32 v20, 0xbfb8aa3b, v100
    v_mul_f32 v21, 0xbfb8aa3b, v101
    v_mul_f32 v22, 0xbfb8aa3b, v102
    v_mul_f32 v23, 0xbfb8aa3b, v103
    v_exp_f32 v16, v16
    v_exp_f32 v17, v17
    v_exp_f32 v18, v18
    v_exp_f32 v19, v19
    v_exp_f32 v20, v20
    v_exp_f32 v21, v21
    v_exp_f32 v22, v22
    v_exp_f32 v23, v23
    s_waitcnt lgkmcnt(0)
    v_add_f32 v128, v128, v136
    v_add_f32 v144, v144, v152
    v_add_f32 v129, v129, v137
    v_add_f32 v145, v145, v153
    v_add_f32 v130, v130, v138
    v_add_f32 v146, v146, v154
    v_add_f32 v131, v131, v139
    v_add_f32 v147, v147, v155
    v_add_f32 v132, v132, v140
    v_add_f32 v148, v148, v156
    v_add_f32 v133, v133, v141
    v_add_f32 v149, v149, v157
    v_add_f32 v134, v134, v142
    v_add_f32 v150, v150, v158
    v_add_f32 v135, v135, v143
    v_add_f32 v151, v151, v159
    v_add_f32 v16, 1.0, v16
    v_add_f32 v17, 1.0, v17
    v_add_f32 v18, 1.0, v18
    v_add_f32 v19, 1.0, v19
    v_add_f32 v20, 1.0, v20
    v_add_f32 v21, 1.0, v21
    v_add_f32 v22, 1.0, v22
    v_add_f32 v23, 1.0, v23
    v_rcp_f32 v16, v16
    v_rcp_f32 v17, v17
    v_rcp_f32 v18, v18
    v_rcp_f32 v19, v19
    v_rcp_f32 v20, v20
    v_rcp_f32 v21, v21
    v_rcp_f32 v22, v22
    v_rcp_f32 v23, v23
    v_add_f32 v128, v128, v144
    v_add_f32 v129, v129, v145
    v_add_f32 v130, v130, v146
    v_add_f32 v131, v131, v147
    v_add_f32 v132, v132, v148
    v_add_f32 v133, v133, v149
    v_add_f32 v134, v134, v150
    v_add_f32 v135, v135, v151
    v_mul_f32 v96, v96, v16
    v_mul_f32 v97, v97, v17
    v_mul_f32 v98, v98, v18
    v_mul_f32 v99, v99, v19
    v_mul_f32 v100, v100, v20
    v_mul_f32 v101, v101, v21
    v_mul_f32 v102, v102, v22
    v_mul_f32 v103, v103, v23
    v_fma_f32 v96, v96, v128, v200
    v_fma_f32 v97, v97, v129, v201
    v_fma_f32 v98, v98, v130, v202
    v_fma_f32 v99, v99, v131, v203
    v_fma_f32 v100, v100, v132, v204
    v_fma_f32 v101, v101, v133, v205
    v_fma_f32 v102, v102, v134, v206
    v_fma_f32 v103, v103, v135, v207
    v_cvt_pk_bf16_f32 v32, v96, v97
    v_cvt_pk_bf16_f32 v33, v98, v99
    v_cvt_pk_bf16_f32 v34, v100, v101
    v_cvt_pk_bf16_f32 v35, v102, v103
    buffer_store_dwordx2 v[32:33], v5, s[16:19], s30 offen
    buffer_store_dwordx2 v[34:35], v6, s[16:19], s30 offen
p3z_141:
p2_kernel_end_x:
    s_endpgm
text_end:
.section .rodata,"a"
.p2align 6
.amdhsa_kernel p1_kernel
  .amdhsa_next_free_vgpr 252
  .amdhsa_next_free_sgpr 102
  .amdhsa_accum_offset 252
  .amdhsa_group_segment_fixed_size 0
  .amdhsa_kernarg_size 88
  .amdhsa_user_sgpr_count 2
  .amdhsa_user_sgpr_kernarg_segment_ptr 1
  .amdhsa_system_sgpr_workgroup_id_x 1
  .amdhsa_float_denorm_mode_32 3
  .amdhsa_float_denorm_mode_16_64 3
.end_amdhsa_kernel
.p2align 6
.amdhsa_kernel p2_kernel
  .amdhsa_next_free_vgpr 256
  .amdhsa_next_free_sgpr 102
  .amdhsa_accum_offset 256
  .amdhsa_group_segment_fixed_size 0
  .amdhsa_kernarg_size 88
  .amdhsa_user_sgpr_count 2
  .amdhsa_user_sgpr_kernarg_segment_ptr 1
  .amdhsa_system_sgpr_workgroup_id_x 1
  .amdhsa_float_denorm_mode_32 3
  .amdhsa_float_denorm_mode_16_64 3
.end_amdhsa_kernel
```
